```python
import torch

def _softmax(x, axis=-1):
    return torch.softmax(x, dim=axis)
def _gelu(x):
    return torch.nn.functional.gelu(x, approximate="tanh")
def _silu(x):
    return torch.nn.functional.silu(x)
def _sigmoid(x):
    return torch.sigmoid(x)
def _layernorm(x, axis=-1, eps=1e-5):
    m = x.mean(dim=axis, keepdim=True)
    v = x.var(dim=axis, keepdim=True, unbiased=False)
    return (x - m) / torch.sqrt(v + eps)
def _scatter_add(tgt, idx, src, axis=0):
    return tgt.clone().index_add_(axis, idx, src)
def _segment_sum(src, seg, n):
    out = torch.zeros((n,) + src.shape[1:], dtype=src.dtype)
    return out.index_add_(0, seg, src)
def _pad(x, pw):
    flat = tuple(v for pair in reversed(pw) for v in pair)
    return torch.nn.functional.pad(x, flat)

kernel_name = 'gated_mix__sliding_block__dense_activation_silu__prompt'

def setup_inputs():

    _w = (lambda a: (lambda t: t.to(torch.bfloat16) if t.is_floating_point() else t)(torch.as_tensor(a)))
    def _A_setup():
        B, S, D = 1, 2048, 576
        return {
            "x": _w((lambda *s: torch.randn(*s, dtype=torch.bfloat16) * 0.2)(B, S, D)),
            "wqkv": _w((lambda *s: torch.randn(*s, dtype=torch.bfloat16) * 0.2)(D, 3 * D)),
            "wo": _w((lambda *s: torch.randn(*s, dtype=torch.bfloat16) * 0.2)(D, D)),
        }
    _A_in = _A_setup()

    def _B_setup():
        B, S, D, F = 1, 2048, 576, 4608
        return {
            "x": _w((lambda *s: torch.randn(*s, dtype=torch.bfloat16) * 0.2)(B, S, D)),
            "w1": _w((lambda *s: torch.randn(*s, dtype=torch.bfloat16) * 3.2)(D, F) * (D ** -0.5)),
            "w2": _w((lambda *s: torch.randn(*s, dtype=torch.bfloat16) * 3.2)(F, D) * (F ** -0.5)),
        }
    _B_in = _B_setup()

    return {
        "A_x": _A_in["x"],
        "A_wqkv": _A_in["wqkv"],
        "A_wo": _A_in["wo"],
        "B_x": _B_in["x"],
        "B_w1": _B_in["w1"],
        "B_w2": _B_in["w2"],
        "gate_w": _w((lambda *s: torch.randn(*s, dtype=torch.bfloat16) * 0.2)(576) * 16.0),
    }

def reference(A_x, A_wqkv, A_wo, B_x, B_w1, B_w2, gate_w):
    def _A_ref(x, wqkv, wo):
        B, S, D = x.shape
        H = 32; Dh = D // H; W = 256
        qkv = (lambda x, *d: x.permute(*d))((x @ wqkv).reshape(B, S, 3, H, Dh), 2, 0, 3, 1, 4)
        q, k, v = qkv[0], qkv[1], qkv[2]
        scores = torch.einsum("bhqd,bhkd->bhqk", q, k) * (Dh ** -0.5)
        idx = torch.arange(S)
        mask = (idx[:, None] - idx[None, :] >= 0) & (idx[:, None] - idx[None, :] < W)
        scores = torch.where(mask[None, None], scores, -1e9)
        p = _softmax(scores, axis=-1)
        o = torch.einsum("bhqk,bhkd->bhqd", p, v)
        return (lambda x, *d: x.permute(*d))(o, 0, 2, 1, 3).reshape(B, S, D) @ wo

    def _B_ref(x, w1, w2):
        h = torch.einsum("bsd,df->bsf", x, w1)
        h = _silu(h)
        out = torch.einsum("bsf,fd->bsd", h, w2)
        return out

    x = A_x
    g = _sigmoid((x * gate_w).sum(-1, keepdims=True))
    a = _A_ref(x, A_wqkv, A_wo)
    b = _B_ref(x, B_w1, B_w2)
    return g * a + (1 - g) * b
```

```asm
; @launch grid=(256,1,1) block=(256,1,1) lds=152064
.amdgcn_target "amdgcn-amd-amdhsa--gfx950"
.text
.globl gated_mix__sliding_block__dense_activation_silu__prompt_kernel
.p2align 8
.type gated_mix__sliding_block__dense_activation_silu__prompt_kernel,@function
gated_mix__sliding_block__dense_activation_silu__prompt_kernel:
    s_cmp_ge_u32 s2, 256
    s_cbranch_scc1 L_end

    s_load_dwordx4 s[56:59], s[0:1], 0
    s_load_dwordx2 s[60:61], s[0:1], 16
    s_load_dwordx4 s[64:67], s[0:1], 32
    s_load_dwordx4 s[68:71], s[0:1], 48
    s_load_dwordx4 s[72:75], s[0:1], 64
    v_lshrrev_b32 v1, 6, v0
    v_and_b32 v60, 63, v0
    s_and_b32 s3, s2, 7
    s_lshr_b32 s4, s2, 3
    v_readfirstlane_b32 s50, v1
    s_and_b32 s5, s3, 3

    s_lshr_b32 s6, s3, 2
    s_lshl_b32 s48, s6, 3
    s_and_b32 s7, s4, 7
    s_add_u32 s48, s48, s7
    s_lshl_b32 s49, s5, 2
    s_lshr_b32 s7, s4, 3
    s_add_u32 s49, s49, s7
    s_lshl_b32 s51, s50, 11
    s_mul_i32 s52, s50, 6144
    s_mul_i32 s53, s50, 5120
    s_mul_i32 s54, s50, 1152
    s_mul_i32 s87, s48, 147456
    s_mul_i32 s3, s48, 1
    s_mul_i32 s4, s49, 2
    s_add_u32 s3, s3, s4
    s_mul_i32 s4, s3, 7282
    s_lshr_b32 s4, s4, 16
    s_mul_i32 s4, s4, 9
    s_sub_u32 s88, s3, s4
    s_mov_b32 s11, 0x00020000
    s_mov_b32 s15, 0x00020000
    s_mov_b32 s19, 0x00020000
    s_mov_b32 s23, 0x00020000
    s_mov_b32 s27, 0x00020000
    s_mov_b32 s31, 0x00020000
    s_mov_b32 s35, 0x00020000
    s_mov_b32 s39, 0x00020000
    s_mov_b32 s43, 0x00020000
    s_mov_b32 s47, 0x00020000
    s_mov_b32 s10, 2359296
    s_mov_b32 s14, 1990656
    s_mov_b32 s18, 5308416
    s_mov_b32 s22, 5308416
    s_mov_b32 s26, 663552
    s_mov_b32 s30, 9437184
    s_mov_b32 s34, 2555904
    s_mov_b32 s38, 1152
    s_mov_b32 s42, 256
    s_mov_b32 s46, 2359296
    s_mul_i32 s76, s48, 2555904
    s_add_u32 s76, s76, 16777216
    s_mov_b32 s86, 0xbfb8aa3b
    s_lshl_b32 s3, s88, 7
    s_add_u32 s4, s3, 0x80
    s_cmp_ge_u32 s4, 0x480
    s_cselect_b32 s4, 0, s4
    s_add_u32 s5, s4, 0x80
    s_cmp_ge_u32 s5, 0x480
    s_cselect_b32 s5, 0, s5
    s_add_u32 s6, s5, 0x80
    s_cmp_ge_u32 s6, 0x480
    s_cselect_b32 s6, 0, s6
    s_add_u32 s7, s6, 0x80
    s_cmp_ge_u32 s7, 0x480
    s_cselect_b32 s7, 0, s7
    s_add_u32 s90, s7, 0x80
    s_cmp_ge_u32 s90, 0x480
    s_cselect_b32 s90, 0, s90
    s_add_u32 s91, s90, 0x80
    s_cmp_ge_u32 s91, 0x480
    s_cselect_b32 s91, 0, s91
    s_add_u32 s92, s91, 0x80
    s_cmp_ge_u32 s92, 0x480
    s_cselect_b32 s92, 0, s92
    s_add_u32 s93, s92, 0x80
    s_cmp_ge_u32 s93, 0x480
    s_cselect_b32 s93, 0, s93
    v_cmp_eq_u32 vcc, 0, v0
    v_mov_b32 v2, 0x7ffffff0
    v_lshlrev_b32 v3, 4, s48
    v_cndmask_b32 v63, v2, v3, vcc
    v_lshrrev_b32 v3, 3, v60
    v_lshrrev_b32 v4, 2, v60
    v_and_b32 v4, 4, v4
    v_and_b32 v5, 7, v60
    v_xor_b32 v4, v4, v5
    v_lshlrev_b32 v4, 4, v4
    v_lshl_add_u32 v6, s50, 4, v3
    s_mov_b32 s77, 0xd80
    v_mad_u32_u24 v16, v6, s77, v4
    v_add_u32 v17, 0x6800, v16
    v_mul_u32_u24 v6, 0x2400, v3
    v_add_u32 v18, v6, v4
    v_add_u32 v19, 0x11c00, v18
    v_lshl_add_u32 v7, s50, 5, v3
    v_mul_u32_u24 v7, 0x480, v7
    v_lshrrev_b32 v6, 4, v60
    v_xor_b32 v6, v6, v5
    v_lshl_add_u32 v8, v6, 4, v7
    v_xor_b32 v6, 4, v6
    v_lshl_add_u32 v9, v6, 4, v7
    v_add_u32 v9, 0x2000, v9
    v_add_u32 v10, 0x4800, v8
    v_add_u32 v11, 0x4800, v9
    s_waitcnt lgkmcnt(0)
    s_mov_b32 s8, s56
    s_mov_b32 s9, s57
    s_mov_b32 s12, s58
    s_mov_b32 s13, s59
    s_mov_b32 s36, s68
    s_mov_b32 s37, s69
    s_mov_b32 s24, s60
    s_mov_b32 s25, s61
    s_mov_b32 s16, s64
    s_mov_b32 s17, s65
    s_mov_b32 s20, s66
    s_mov_b32 s21, s67
    s_mov_b32 s44, s70
    s_mov_b32 s45, s71
    s_mov_b32 s40, s72
    s_mov_b32 s41, s73
    s_mov_b32 s28, s74
    s_mov_b32 s29, s75
    s_add_u32 s32, s74, s76
    s_addc_u32 s33, s75, 0
    s_branch L_wskip
L_warm:
    s_lshr_b32 s99, s2, 3
    s_lshl2_add_u32 s97, s99, s97
    s_add_u32 s97, s97, s50
    s_mov_b64 exec, 0
L_wloop:
    s_cmpk_ge_u32 s97, 117
    s_cbranch_scc1 L_wret
    s_getpc_b64 vcc
L_where:
    s_lshl_b32 s99, s97, 9
    s_add_u32 s99, s99, L_pad0-L_where
    s_add_u32 vcc_lo, vcc_lo, s99
    s_addc_u32 vcc_hi, vcc_hi, 0
    s_setpc_b64 vcc
L_wret:
    s_addk_i32 s97, 128
    s_sub_u32 s96, s96, 1
    s_cbranch_scc0 L_wloop
    s_mov_b64 exec, -1
    s_setpc_b64 s[0:1]
L_wskip:
    s_cmp_ge_u32 s49, 11
    s_cbranch_scc1 L_var_none
    s_cmp_ge_u32 s49, 2
    s_cbranch_scc1 L_var_v
    s_lshl_b32 s71, s49, 7
    s_add_u32 s70, s71, 0x800
    s_add_u32 m0, s51, 0x18000
    s_mul_i32 s84, s3, 0x6c0
    s_add_u32 s84, s84, s70
    buffer_load_dwordx4 v16, s[12:15], s84 offen lds
    buffer_load_dwordx4 v17, s[12:15], s84 offen offset:1024 lds
    s_add_u32 m0, s51, 0xc000
    s_add_u32 s83, s3, s87
    buffer_load_dwordx4 v8, s[8:11], s83 offen lds
    buffer_load_dwordx4 v9, s[8:11], s83 offen offset:1024 lds
    s_add_u32 m0, s51, 0x12000
    s_add_u32 s84, s3, s87
    buffer_load_dwordx4 v10, s[8:11], s84 offen lds
    buffer_load_dwordx4 v11, s[8:11], s84 offen offset:1024 lds
    s_add_u32 m0, s51, 0x1a000
    s_mul_i32 s83, s4, 0x6c0
    s_add_u32 s83, s83, s70
    buffer_load_dwordx4 v16, s[12:15], s83 offen lds
    buffer_load_dwordx4 v17, s[12:15], s83 offen offset:1024 lds
    s_add_u32 m0, s51, 0xe000
    s_add_u32 s84, s4, s87
    buffer_load_dwordx4 v8, s[8:11], s84 offen lds
L_pad0:
    s_cbranch_execz L_wret
    buffer_load_dwordx4 v9, s[8:11], s84 offen offset:1024 lds
    s_add_u32 m0, s51, 0x14000
    s_add_u32 s83, s4, s87
    buffer_load_dwordx4 v10, s[8:11], s83 offen lds
    buffer_load_dwordx4 v11, s[8:11], s83 offen offset:1024 lds
    s_add_u32 m0, s51, 0x1c000
    s_mul_i32 s84, s5, 0x6c0
    s_add_u32 s84, s84, s70
    buffer_load_dwordx4 v16, s[12:15], s84 offen lds
    v_bfe_u32 v1, v60, 4, 1
    v_mul_u32_u24 v1, 0x6000, v1
    v_and_b32 v2, 15, v60
    v_lshl_add_u32 v1, v2, 7, v1
    v_add_u32 v1, s51, v1
    v_add_u32 v1, 0xc000, v1
    v_bfe_u32 v2, v60, 1, 3
    v_lshrrev_b32 v3, 5, v60
    v_xor_b32 v2, v2, v3
    v_lshl_add_u32 v12, v2, 4, v1
    v_xor_b32 v4, 2, v2
    v_lshl_add_u32 v13, v4, 4, v1
    v_xor_b32 v4, 4, v2
    v_lshl_add_u32 v14, v4, 4, v1
    v_xor_b32 v4, 6, v2
    v_lshl_add_u32 v15, v4, 4, v1
    v_bfe_u32 v1, v60, 2, 2
    v_and_b32 v2, 3, v60
    v_bfe_u32 v3, v60, 4, 1
    v_lshrrev_b32 v4, 5, v60
    v_lshlrev_b32 v5, 3, v2
    v_lshl_add_u32 v5, v3, 5, v5
    v_bfe_u32 v6, v60, 3, 1
    v_lshlrev_b32 v6, 6, v6
    v_lshl_add_u32 v7, v4, 3, v1
    buffer_load_dwordx4 v17, s[12:15], s84 offen offset:1024 lds
    v_lshl_add_u32 v7, v7, 7, v5
    v_add_u32 v30, v6, v7
    v_add_u32 v31, 0xc000, v30
    v_add_u32 v32, 0x18000, v30
    v_lshl_add_u32 v7, v4, 3, v1
    v_lshl_add_u32 v7, v7, 7, v5
    v_xor_b32 v33, 64, v6
    v_add_u32 v33, v33, v7
    v_add_u32 v34, 0xc000, v33
    v_add_u32 v35, 0x18000, v33
    v_lshl_add_u32 v7, v4, 3, v1
    v_lshl_add_u32 v36, v7, 6, v5
    v_add_u32 v37, 0xc000, v36
    v_add_u32 v38, 0x18000, v36
    s_mul_i32 s76, s50, 0x24000
    s_mul_i32 s56, s3, 0x1200
    s_add_u32 s56, s56, s76
    s_mul_i32 s57, s4, 0x1200
    s_add_u32 s57, s57, s76
    s_mul_i32 s58, s5, 0x1200
    s_add_u32 s58, s58, s76
    s_mul_i32 s59, s6, 0x1200
    s_add_u32 s59, s59, s76
    s_mul_i32 s60, s7, 0x1200
    s_add_u32 s60, s60, s76
    s_add_u32 m0, s51, 0x10000
    s_add_u32 s83, s5, s87
    buffer_load_dwordx4 v8, s[8:11], s83 offen lds
    s_mul_i32 s61, s90, 0x1200
    s_add_u32 s61, s61, s76
    s_mul_i32 s62, s91, 0x1200
    s_add_u32 s62, s62, s76
    s_mul_i32 s63, s92, 0x1200
    s_add_u32 s63, s63, s76
    s_mul_i32 s64, s93, 0x1200
    s_add_u32 s64, s64, s76
    s_mul_i32 s76, s49, 0x240
    s_and_b32 s77, s49, 1
    s_cselect_b32 s78, 64, 0
    s_cselect_b32 s79, 0, 0x200
    s_add_u32 s78, s78, s76
    s_add_u32 s69, s79, s76
    s_add_u32 s81, s48, 0
    s_and_b32 s81, s81, 3
    s_lshl_b32 s81, s81, 7
L_pad1:
    s_cbranch_execz L_wret
    s_add_u32 s65, s81, s78
    s_add_u32 s81, s48, 1
    s_and_b32 s81, s81, 3
    s_lshl_b32 s81, s81, 7
    s_add_u32 s66, s81, s78
    s_add_u32 s81, s48, 2
    s_and_b32 s81, s81, 3
    s_lshl_b32 s81, s81, 7
    buffer_load_dwordx4 v9, s[8:11], s83 offen offset:1024 lds
    s_add_u32 s67, s81, s78
    s_add_u32 s81, s48, 3
    s_and_b32 s81, s81, 3
    s_lshl_b32 s81, s81, 7
    s_add_u32 s68, s81, s78
    v_lshrrev_b32 v3, 2, v60
    v_mul_u32_u24 v3, 0x2400, v3
    v_and_b32 v4, 3, v60
    v_lshl_add_u32 v20, v4, 4, v3
    s_lshl_b32 s89, s48, 2
    s_add_u32 s89, s89, s50
    s_mul_i32 s76, s89, 0x1b200
    s_lshl_b32 s77, s49, 12
    s_add_u32 s74, s76, s77
    s_mov_b32 s78, 0x3eae1a93
    s_cmp_lt_u32 s49, 9
    s_cselect_b32 s75, s78, 1.0
    v_lshlrev_b32 v45, 4, v60
    v_add_u32 v1, 0, v60
    v_mul_u32_u24 v2, 0xab, v1
    v_lshrrev_b32 v2, 11, v2
    v_mul_u32_u24 v2, 0x3c0, v2
    v_lshl_add_u32 v21, v60, 4, v2
    v_add_u32 v1, 64, v60
    v_mul_u32_u24 v2, 0xab, v1
    s_add_u32 m0, s51, 0x16000
    s_add_u32 s84, s5, s87
    buffer_load_dwordx4 v10, s[8:11], s84 offen lds
    v_lshrrev_b32 v2, 11, v2
    v_mul_u32_u24 v2, 0x3c0, v2
    v_lshl_add_u32 v22, v60, 4, v2
    v_add_u32 v1, 0x80, v60
    v_mul_u32_u24 v2, 0xab, v1
    v_lshrrev_b32 v2, 11, v2
    v_mul_u32_u24 v2, 0x3c0, v2
    v_lshl_add_u32 v23, v60, 4, v2
    v_lshlrev_b32 v28, 4, v60
    s_mul_i32 s77, s49, 0x27000
    s_add_u32 s78, s77, s51
    v_bfe_u32 v1, v60, 2, 3
    v_lshl_add_u32 v1, v1, 8, s78
    v_lshrrev_b32 v2, 5, v60
    v_lshl_add_u32 v1, v2, 6, v1
    v_and_b32 v2, 3, v60
    v_lshl_add_u32 v57, v2, 4, v1
    s_mul_i32 s79, s50, 0x5400
    s_add_u32 s79, s79, 0x12000
    s_add_u32 s78, s77, s79
    v_add_u32 v24, s78, v28
    s_xor_b32 s80, s49, 1
    s_mul_i32 s77, s80, 0x27000
    s_add_u32 s78, s77, s79
    v_add_u32 v25, s78, v28
    buffer_load_dwordx4 v11, s[8:11], s84 offen offset:1024 lds
    s_mul_i32 s76, s49, 9
    s_lshr_b32 s76, s76, 1
    s_lshl_b32 s76, s76, 9
    v_lshrrev_b32 v1, 5, v60
    v_and_b32 v5, 19, v60
    v_bfe_u32 v6, v60, 2, 1
    v_lshl_add_u32 v5, v6, 3, v5
    v_bfe_u32 v6, v60, 3, 1
    v_lshl_add_u32 v5, v6, 2, v5
    v_lshl_add_u32 v5, v5, 4, s76
    v_lshl_add_u32 v6, v1, 9, v5
    v_add_u32 v48, 0x9000, v6
    v_add_u32 v49, 0x9200, v6
    v_add_u32 v5, 0x8c00, v5
    s_mul_i32 s77, s49, 36
    v_add_u32 v2, 0xffffffe0, v60
    v_max_i32 v2, 0, v2
    v_mul_u32_u24 v3, 0xcd, v2
    v_lshrrev_b32 v3, 13, v3
    v_mul_u32_u24 v4, 40, v3
    v_sub_u32 v4, v2, v4
    v_cmp_gt_u32 vcc, 36, v4
    v_mov_b32 v6, 0x21c
    v_mov_b32 v7, s77
    v_cndmask_b32 v6, v6, v7, vcc
    s_nop 0
L_pad2:
    s_cbranch_execz L_wret
    s_add_u32 m0, s51, 0x1e000
    s_mul_i32 s83, s3, 0x6c0
    s_add_u32 s83, s83, s71
    buffer_load_dwordx4 v16, s[12:15], s83 offen lds
    v_add_u32 v4, v4, v6
    v_mul_u32_u24 v3, 0x2480, v3
    v_lshl_add_u32 v4, v4, 4, v3
    v_add_u32 v50, 0x11800, v4
    v_cmp_gt_u32 vcc, 32, v60
    v_add_u32 v2, 32, v60
    v_mul_u32_u24 v3, 0xcd, v2
    v_cndmask_b32 v50, v50, v5, vcc
    v_lshrrev_b32 v3, 13, v3
    v_mul_u32_u24 v4, 40, v3
    v_sub_u32 v4, v2, v4
    v_cmp_gt_u32 vcc, 36, v4
    v_mov_b32 v6, 0x21c
    v_mov_b32 v7, s77
    v_cndmask_b32 v6, v6, v7, vcc
    v_add_u32 v4, v4, v6
    v_mul_u32_u24 v3, 0x2480, v3
    v_lshl_add_u32 v4, v4, 4, v3
    v_add_u32 v51, 0x11400, v4
    v_add_u32 v2, 0x60, v60
    v_mul_u32_u24 v3, 0xcd, v2
    v_lshrrev_b32 v3, 13, v3
    v_mul_u32_u24 v4, 40, v3
    v_sub_u32 v4, v2, v4
    v_cmp_gt_u32 vcc, 36, v4
    buffer_load_dwordx4 v17, s[12:15], s83 offen offset:1024 lds
    v_mov_b32 v6, 0x21c
    v_mov_b32 v7, s77
    v_cndmask_b32 v6, v6, v7, vcc
    v_add_u32 v4, v4, v6
    v_mul_u32_u24 v3, 0x2480, v3
    v_lshl_add_u32 v4, v4, 4, v3
    v_add_u32 v52, 0x12000, v4
    s_add_u32 s78, s53, 0xc000
    v_lshl_add_u32 v53, v60, 4, s78
    v_and_b32 v2, 31, v60
    v_lshl_add_u32 v54, v2, 4, s78
    v_cmp_gt_u32 vcc, 18, v2
    v_mul_u32_u24 v3, 0x280, v1
    v_add_u32 v3, s78, v3
    v_add_u32 v4, 0, v2
    v_mov_b32 v6, 36
    v_cndmask_b32 v4, v6, v4, vcc
    v_lshl_add_u32 v55, v4, 4, v3
    v_add_u32 v4, 18, v2
    v_mov_b32 v6, 36
    v_cndmask_b32 v4, v6, v4, vcc
    v_lshl_add_u32 v56, v4, 4, v3
    v_lshlrev_b32 v3, 3, v1
    v_sub_u32 v61, v2, v3
    s_mov_b32 s94, 0
    s_add_u32 m0, s51, 0x20000
    s_mul_i32 s84, s4, 0x6c0
    s_add_u32 s84, s84, s71
    buffer_load_dwordx4 v16, s[12:15], s84 offen lds
    s_mov_b32 s95, -1
    s_mov_b32 s98, 0xffff
    v_sub_u32 v224, -1, v61
    v_ashrrev_i32 v224, 31, v224
    v_sub_u32 v225, 0, v61
    v_ashrrev_i32 v225, 31, v225
    v_sub_u32 v226, 1, v61
    v_ashrrev_i32 v226, 31, v226
    v_sub_u32 v227, 2, v61
    v_ashrrev_i32 v227, 31, v227
    v_sub_u32 v228, 3, v61
    v_ashrrev_i32 v228, 31, v228
    v_sub_u32 v229, 4, v61
    v_ashrrev_i32 v229, 31, v229
    v_sub_u32 v230, 5, v61
    v_ashrrev_i32 v230, 31, v230
    v_sub_u32 v231, 6, v61
    v_ashrrev_i32 v231, 31, v231
    v_sub_u32 v232, 15, v61
    v_ashrrev_i32 v232, 31, v232
    v_sub_u32 v233, 16, v61
    v_ashrrev_i32 v233, 31, v233
    v_sub_u32 v234, 17, v61
    v_ashrrev_i32 v234, 31, v234
    v_sub_u32 v235, 18, v61
    buffer_load_dwordx4 v17, s[12:15], s84 offen offset:1024 lds
    v_ashrrev_i32 v235, 31, v235
    v_sub_u32 v236, 19, v61
    v_ashrrev_i32 v236, 31, v236
    v_sub_u32 v237, 20, v61
    v_ashrrev_i32 v237, 31, v237
    v_sub_u32 v238, 21, v61
    v_ashrrev_i32 v238, 31, v238
    v_sub_u32 v239, 22, v61
    v_ashrrev_i32 v239, 31, v239
    s_lshl_b32 s79, s89, 4
    s_add_u32 s80, s79, s49
    s_lshl_b32 s80, s80, 7
    s_nop 0
L_pad3:
    s_cbranch_execz L_wret
    s_add_u32 s80, s80, 0x800000
    v_bfe_u32 v5, v60, 3, 1
    v_mul_u32_u24 v5, 0x1ffe0, v5
    v_lshl_add_u32 v5, v60, 2, v5
    v_cmp_gt_u32 vcc, 16, v60
    v_mov_b32 v6, 0x7ffffff0
    v_mov_b32 v7, 0
    v_cndmask_b32 v5, v6, v5, vcc
    s_add_u32 s81, s80, 0x20000
    v_mov_b32 v26, s81
    s_xor_b32 s81, s81, 0x80
    v_cmp_eq_u32 vcc, 0, v60
    s_add_u32 s72, s74, 0x10000
    s_add_u32 m0, s51, 0x22000
    s_mul_i32 s83, s5, 0x6c0
    s_add_u32 s83, s83, s71
    buffer_load_dwordx4 v16, s[12:15], s83 offen lds
    buffer_load_dwordx4 v17, s[12:15], s83 offen offset:1024 lds
    buffer_store_dword v7, v5, s[28:31], s80 offen sc1
    v_mov_b32 v5, s81
    v_cndmask_b32 v29, v6, v5, vcc
    s_and_b32 s81, s49, 1
    s_add_u32 s79, s79, s81
    s_lshl_b32 s79, s79, 7
    s_lshr_b32 s81, s49, 1
    s_lshl_b32 s81, s81, 2
    s_add_u32 s79, s79, s81
    s_add_u32 s79, s79, 0x800000
    v_lshl_add_u32 v5, v60, 8, s79
    v_cmp_gt_u32 vcc, 8, v60
    s_nop 1
    v_cndmask_b32 v61, v6, v5, vcc
    v_and_b32 v5, 3, v60
    v_min_u32 v5, 2, v5
    v_sub_u32 v5, s48, v5
    v_max_i32 v5, 0, v5
    v_lshlrev_b32 v59, 4, v5
    s_mov_b32 s96, 0
    s_movk_i32 s97, 0
    s_call_b64 s[0:1], L_warm
    s_waitcnt vmcnt(19)
    ds_read_b128 a[0:3], v12 offset:0
    ds_read_b128 a[4:7], v13 offset:0
    ds_read_b128 a[8:11], v14 offset:0
    ds_read_b128 a[12:15], v15 offset:0
    s_barrier
    s_add_u32 m0, s51, 0
    s_add_u32 s84, s6, s87
    buffer_load_dwordx4 v8, s[8:11], s84 offen lds
    ds_read_b64_tr_b16 a[144:145], v32 offset:0
    ds_read_b64_tr_b16 a[146:147], v32 offset:512
    ds_read_b64_tr_b16 a[148:149], v35 offset:0
    ds_read_b64_tr_b16 a[150:151], v35 offset:512
    ds_read_b64_tr_b16 a[152:153], v32 offset:2048
    ds_read_b64_tr_b16 a[154:155], v32 offset:2560
    ds_read_b64_tr_b16 a[156:157], v35 offset:2048
    ds_read_b64_tr_b16 a[158:159], v35 offset:2560
    buffer_load_dwordx4 v9, s[8:11], s84 offen offset:1024 lds
    ds_read_b64_tr_b16 a[160:161], v32 offset:4096
    ds_read_b64_tr_b16 a[162:163], v32 offset:4608
    ds_read_b64_tr_b16 a[164:165], v35 offset:4096
    ds_read_b64_tr_b16 a[166:167], v35 offset:4608
    ds_read_b64_tr_b16 a[168:169], v32 offset:6144
    ds_read_b64_tr_b16 a[170:171], v32 offset:6656
    ds_read_b64_tr_b16 a[172:173], v35 offset:6144
    ds_read_b64_tr_b16 a[174:175], v35 offset:6656
    s_add_u32 m0, s51, 0x6000
    s_add_u32 s83, s6, s87
    buffer_load_dwordx4 v10, s[8:11], s83 offen lds
    s_mul_i32 s76, s49, 0x120
    s_and_b32 s77, s49, 1
    s_cselect_b32 s78, 32, 0
    s_cselect_b32 s79, 0, 0x100
    s_add_u32 s80, s78, s76
    s_add_u32 s81, s79, s76
    s_lshr_b32 s76, s50, 1
    s_add_u32 s76, s76, 0
    buffer_load_dwordx4 v11, s[8:11], s83 offen offset:1024 lds
    s_add_u32 s76, s76, s48
    s_waitcnt lgkmcnt(14)
    v_mfma_f32_32x32x16_bf16 v[64:79], a[144:147], a[0:3], 0
    s_and_b32 s76, s76, 3
    s_lshl_b32 s76, s76, 6
    s_and_b32 s77, s50, 1
L_pad4:
    s_cbranch_execz L_wret
    s_lshl_b32 s77, s77, 5
    s_add_u32 s76, s76, s77
    s_add_u32 s3, s76, s80
    s_waitcnt lgkmcnt(8)
    v_mfma_f32_32x32x16_bf16 v[80:95], a[148:151], a[0:3], 0
    s_add_u32 m0, s51, 0x2000
    s_add_u32 s84, s7, s87
    buffer_load_dwordx4 v8, s[8:11], s84 offen lds
    s_lshr_b32 s76, s50, 1
    v_mfma_f32_32x32x16_bf16 v[64:79], a[152:155], a[4:7], v[64:79]
    s_add_u32 s76, s76, 2
    s_add_u32 s76, s76, s48
    s_and_b32 s76, s76, 3
    s_lshl_b32 s76, s76, 6
    s_and_b32 s77, s50, 1
    s_lshl_b32 s77, s77, 5
    v_mfma_f32_32x32x16_bf16 v[80:95], a[156:159], a[4:7], v[80:95]
    buffer_load_dwordx4 v9, s[8:11], s84 offen offset:1024 lds
    s_add_u32 s76, s76, s77
    s_add_u32 s4, s76, s80
    s_xor_b32 s82, s49, 1
    s_waitcnt lgkmcnt(0)
    v_mfma_f32_32x32x16_bf16 v[64:79], a[160:163], a[8:11], v[64:79]
    s_waitcnt vmcnt(19)
    ds_read_b128 a[16:19], v12 offset:8192
    ds_read_b128 a[20:23], v13 offset:8192
    ds_read_b128 a[24:27], v14 offset:8192
    ds_read_b128 a[28:31], v15 offset:8192
    s_barrier
    v_mfma_f32_32x32x16_bf16 v[80:95], a[164:167], a[8:11], v[80:95]
    s_add_u32 m0, s51, 0x8000
    s_add_u32 s83, s7, s87
    buffer_load_dwordx4 v10, s[8:11], s83 offen lds
    ds_read_b64_tr_b16 a[144:145], v32 offset:8192
    v_mfma_f32_32x32x16_bf16 v[64:79], a[168:171], a[12:15], v[64:79]
    ds_read_b64_tr_b16 a[146:147], v32 offset:8704
    ds_read_b64_tr_b16 a[148:149], v35 offset:8192
    ds_read_b64_tr_b16 a[150:151], v35 offset:8704
    ds_read_b64_tr_b16 a[152:153], v32 offset:10240
    ds_read_b64_tr_b16 a[154:155], v32 offset:10752
    ds_read_b64_tr_b16 a[156:157], v35 offset:10240
    v_mfma_f32_32x32x16_bf16 v[80:95], a[172:175], a[12:15], v[80:95]
    buffer_load_dwordx4 v11, s[8:11], s83 offen offset:1024 lds
    ds_read_b64_tr_b16 a[158:159], v35 offset:10752
    ds_read_b64_tr_b16 a[160:161], v32 offset:12288
    ds_read_b64_tr_b16 a[162:163], v32 offset:12800
    ds_read_b64_tr_b16 a[164:165], v35 offset:12288
    ds_read_b64_tr_b16 a[166:167], v35 offset:12800
    ds_read_b64_tr_b16 a[168:169], v32 offset:14336
    ds_read_b64_tr_b16 a[170:171], v32 offset:14848
    ds_read_b64_tr_b16 a[172:173], v35 offset:14336
    s_add_u32 m0, s51, 0x4000
    s_add_u32 s84, s90, s87
    buffer_load_dwordx4 v8, s[8:11], s84 offen lds
    ds_read_b64_tr_b16 a[174:175], v35 offset:14848
    s_mul_i32 s76, s82, 0x120
    s_and_b32 s77, s82, 1
    s_cselect_b32 s78, 32, 0
    s_cselect_b32 s79, 0, 0x100
    s_add_u32 s80, s78, s76
    s_and_b32 s77, s50, 1
    s_lshl_b32 s77, s77, 5
    buffer_load_dwordx4 v9, s[8:11], s84 offen offset:1024 lds
    s_waitcnt lgkmcnt(14)
    v_mfma_f32_32x32x16_bf16 v[64:79], a[144:147], a[16:19], v[64:79]
    s_mul_i32 s3, s3, 0x480
    s_mul_i32 s4, s4, 0x480
    s_waitcnt lgkmcnt(9)
    v_mfma_f32_32x32x16_bf16 v[80:95], a[148:151], a[16:19], v[80:95]
    s_add_u32 m0, s51, 0xa000
    s_add_u32 s83, s90, s87
    buffer_load_dwordx4 v10, s[8:11], s83 offen lds
    v_mfma_f32_32x32x16_bf16 v[64:79], a[152:155], a[20:23], v[64:79]
    s_waitcnt lgkmcnt(0)
    v_mfma_f32_32x32x16_bf16 v[80:95], a[156:159], a[20:23], v[80:95]
    buffer_load_dwordx4 v11, s[8:11], s83 offen offset:1024 lds
    v_mfma_f32_32x32x16_bf16 v[64:79], a[160:163], a[24:27], v[64:79]
    s_waitcnt vmcnt(19)
    s_nop 0
L_pad5:
    s_cbranch_execz L_wret
    ds_read_b128 a[32:35], v12 offset:16384
    ds_read_b128 a[36:39], v13 offset:16384
    ds_read_b128 a[40:43], v14 offset:16384
    ds_read_b128 a[44:47], v15 offset:16384
    v_add_u32 v12, 0xffff4000, v12
    v_mfma_f32_32x32x16_bf16 v[80:95], a[164:167], a[24:27], v[80:95]
    v_add_u32 v13, 0xffff4000, v13
    v_add_u32 v14, 0xffff4000, v14
    v_add_u32 v15, 0xffff4000, v15
    s_barrier
    ds_read_b64_tr_b16 a[144:145], v32 offset:16384
    ds_read_b64_tr_b16 a[146:147], v32 offset:16896
    v_mfma_f32_32x32x16_bf16 v[64:79], a[168:171], a[28:31], v[64:79]
    ds_read_b64_tr_b16 a[148:149], v35 offset:16384
    ds_read_b64_tr_b16 a[150:151], v35 offset:16896
    ds_read_b64_tr_b16 a[152:153], v32 offset:18432
    ds_read_b64_tr_b16 a[154:155], v32 offset:18944
    ds_read_b64_tr_b16 a[156:157], v35 offset:18432
    ds_read_b64_tr_b16 a[158:159], v35 offset:18944
    v_mfma_f32_32x32x16_bf16 v[80:95], a[172:175], a[28:31], v[80:95]
    ds_read_b64_tr_b16 a[160:161], v32 offset:20480
    ds_read_b64_tr_b16 a[162:163], v32 offset:20992
    ds_read_b64_tr_b16 a[164:165], v35 offset:20480
    ds_read_b64_tr_b16 a[166:167], v35 offset:20992
    ds_read_b64_tr_b16 a[168:169], v32 offset:22528
    ds_read_b64_tr_b16 a[170:171], v32 offset:23040
    ds_read_b64_tr_b16 a[172:173], v35 offset:22528
    ds_read_b64_tr_b16 a[174:175], v35 offset:23040
    s_add_u32 m0, s51, 0xc000
    s_mul_i32 s84, s6, 0x6c0
    s_add_u32 s84, s84, s70
    buffer_load_dwordx4 v16, s[12:15], s84 offen lds
    buffer_load_dwordx4 v17, s[12:15], s84 offen offset:1024 lds
    s_waitcnt lgkmcnt(14)
    v_mfma_f32_32x32x16_bf16 v[64:79], a[144:147], a[32:35], v[64:79]
    s_waitcnt lgkmcnt(8)
    v_mfma_f32_32x32x16_bf16 v[80:95], a[148:151], a[32:35], v[80:95]
    s_add_u32 m0, s51, 0xe000
    s_mul_i32 s83, s7, 0x6c0
    s_add_u32 s83, s83, s70
    buffer_load_dwordx4 v16, s[12:15], s83 offen lds
    v_mfma_f32_32x32x16_bf16 v[64:79], a[152:155], a[36:39], v[64:79]
    s_waitcnt vmcnt(16)
    s_barrier
    ds_read_b64_tr_b16 a[144:145], v32 offset:24576
    ds_read_b64_tr_b16 a[146:147], v32 offset:25088
    ds_read_b64_tr_b16 a[148:149], v35 offset:24576
    ds_read_b64_tr_b16 a[150:151], v35 offset:25088
    v_mfma_f32_32x32x16_bf16 v[80:95], a[156:159], a[36:39], v[80:95]
    buffer_load_dwordx4 v17, s[12:15], s83 offen offset:1024 lds
    ds_read_b64_tr_b16 a[152:153], v32 offset:26624
    ds_read_b64_tr_b16 a[154:155], v32 offset:27136
    ds_read_b64_tr_b16 a[156:157], v35 offset:26624
    s_waitcnt lgkmcnt(7)
    v_mfma_f32_32x32x16_bf16 v[64:79], a[160:163], a[40:43], v[64:79]
    ds_read_b64_tr_b16 a[158:159], v35 offset:27136
    ds_read_b64_tr_b16 a[160:161], v32 offset:28672
    ds_read_b64_tr_b16 a[162:163], v32 offset:29184
    v_mfma_f32_32x32x16_bf16 v[80:95], a[164:167], a[40:43], v[80:95]
    s_add_u32 m0, s51, 0x10000
    s_mul_i32 s84, s90, 0x6c0
    s_add_u32 s84, s84, s70
    buffer_load_dwordx4 v16, s[12:15], s84 offen lds
    v_mfma_f32_32x32x16_bf16 v[64:79], a[168:171], a[44:47], v[64:79]
    ds_read_b64_tr_b16 a[164:165], v35 offset:28672
    ds_read_b64_tr_b16 a[166:167], v35 offset:29184
    ds_read_b64_tr_b16 a[168:169], v32 offset:30720
    ds_read_b64_tr_b16 a[170:171], v32 offset:31232
L_pad6:
    s_cbranch_execz L_wret
    v_mfma_f32_32x32x16_bf16 v[80:95], a[172:175], a[44:47], v[80:95]
    buffer_load_dwordx4 v17, s[12:15], s84 offen offset:1024 lds
    ds_read_b64_tr_b16 a[172:173], v35 offset:30720
    ds_read_b64_tr_b16 a[174:175], v35 offset:31232
    s_waitcnt lgkmcnt(10)
    v_mfma_f32_32x32x16_bf16 v[96:111], a[144:147], a[0:3], 0
    ds_read_b64_tr_b16 a[144:145], v32 offset:32768
    ds_read_b64_tr_b16 a[146:147], v32 offset:33280
    v_mfma_f32_32x32x16_bf16 v[112:127], a[148:151], a[0:3], 0
    s_add_u32 m0, s51, 0x12000
    s_mul_i32 s83, s6, 0x6c0
    s_add_u32 s83, s83, s71
    buffer_load_dwordx4 v16, s[12:15], s83 offen lds
    v_mfma_f32_32x32x16_bf16 v[96:111], a[152:155], a[4:7], v[96:111]
    ds_read_b64_tr_b16 a[148:149], v35 offset:32768
    ds_read_b64_tr_b16 a[150:151], v35 offset:33280
    ds_read_b64_tr_b16 a[152:153], v32 offset:34816
    ds_read_b64_tr_b16 a[154:155], v32 offset:35328
    s_waitcnt lgkmcnt(8)
    v_mfma_f32_32x32x16_bf16 v[112:127], a[156:159], a[4:7], v[112:127]
    buffer_load_dwordx4 v17, s[12:15], s83 offen offset:1024 lds
    ds_read_b64_tr_b16 a[156:157], v35 offset:34816
    ds_read_b64_tr_b16 a[158:159], v35 offset:35328
    v_mfma_f32_32x32x16_bf16 v[96:111], a[160:163], a[8:11], v[96:111]
    ds_read_b64_tr_b16 a[160:161], v32 offset:36864
    ds_read_b64_tr_b16 a[162:163], v32 offset:37376
    v_mfma_f32_32x32x16_bf16 v[112:127], a[164:167], a[8:11], v[112:127]
    s_add_u32 m0, s51, 0x14000
    s_mul_i32 s84, s7, 0x6c0
    s_add_u32 s84, s84, s71
    buffer_load_dwordx4 v16, s[12:15], s84 offen lds
    v_mfma_f32_32x32x16_bf16 v[96:111], a[168:171], a[12:15], v[96:111]
    ds_read_b64_tr_b16 a[164:165], v35 offset:36864
    ds_read_b64_tr_b16 a[166:167], v35 offset:37376
    ds_read_b64_tr_b16 a[168:169], v32 offset:38912
    ds_read_b64_tr_b16 a[170:171], v32 offset:39424
    s_waitcnt vmcnt(17)
    ds_read_b128 a[48:51], v12 offset:0
    s_waitcnt lgkmcnt(9)
    v_mfma_f32_32x32x16_bf16 v[112:127], a[172:175], a[12:15], v[112:127]
    buffer_load_dwordx4 v17, s[12:15], s84 offen offset:1024 lds
    ds_read_b64_tr_b16 a[172:173], v35 offset:38912
    ds_read_b64_tr_b16 a[174:175], v35 offset:39424
    ds_read_b128 a[52:55], v13 offset:0
    v_mfma_f32_32x32x16_bf16 v[96:111], a[144:147], a[16:19], v[96:111]
    ds_read_b64_tr_b16 a[144:145], v32 offset:40960
    ds_read_b64_tr_b16 a[146:147], v32 offset:41472
    ds_read_b128 a[56:59], v14 offset:0
    ds_read_b128 a[60:63], v15 offset:0
    v_mfma_f32_32x32x16_bf16 v[112:127], a[148:151], a[16:19], v[112:127]
    s_add_u32 m0, s51, 0x16000
    s_mul_i32 s83, s90, 0x6c0
    s_add_u32 s83, s83, s71
    buffer_load_dwordx4 v16, s[12:15], s83 offen lds
    v_mfma_f32_32x32x16_bf16 v[96:111], a[152:155], a[20:23], v[96:111]
    ds_read_b64_tr_b16 a[148:149], v35 offset:40960
    ds_read_b64_tr_b16 a[150:151], v35 offset:41472
    ds_read_b64_tr_b16 a[152:153], v32 offset:43008
    ds_read_b64_tr_b16 a[154:155], v32 offset:43520
    s_waitcnt lgkmcnt(11)
    v_mfma_f32_32x32x16_bf16 v[112:127], a[156:159], a[20:23], v[112:127]
    buffer_load_dwordx4 v17, s[12:15], s83 offen offset:1024 lds
    ds_read_b64_tr_b16 a[156:157], v35 offset:43008
    ds_read_b64_tr_b16 a[158:159], v35 offset:43520
    s_waitcnt vmcnt(16)
    ds_read_b128 a[64:67], v12 offset:8192
    v_mfma_f32_32x32x16_bf16 v[96:111], a[160:163], a[24:27], v[96:111]
    ds_read_b64_tr_b16 a[160:161], v32 offset:45056
L_pad7:
    s_cbranch_execz L_wret
    ds_read_b64_tr_b16 a[162:163], v32 offset:45568
    ds_read_b128 a[68:71], v13 offset:8192
    ds_read_b128 a[72:75], v14 offset:8192
    ds_read_b128 a[76:79], v15 offset:8192
    v_mfma_f32_32x32x16_bf16 v[112:127], a[164:167], a[24:27], v[112:127]
    ds_read_b64_tr_b16 a[164:165], v35 offset:45056
    ds_read_b64_tr_b16 a[166:167], v35 offset:45568
    v_mfma_f32_32x32x16_bf16 v[96:111], a[168:171], a[28:31], v[96:111]
    ds_read_b64_tr_b16 a[168:169], v32 offset:47104
    ds_read_b64_tr_b16 a[170:171], v32 offset:47616
    s_waitcnt lgkmcnt(12)
    v_mfma_f32_32x32x16_bf16 v[112:127], a[172:175], a[28:31], v[112:127]
    ds_read_b64_tr_b16 a[172:173], v35 offset:47104
    ds_read_b64_tr_b16 a[174:175], v35 offset:47616
    v_mfma_f32_32x32x16_bf16 v[96:111], a[144:147], a[32:35], v[96:111]
    s_waitcnt vmcnt(12)
    ds_read_b128 a[80:83], v12 offset:16384
    ds_read_b128 a[84:87], v13 offset:16384
    ds_read_b128 a[88:91], v14 offset:16384
    ds_read_b128 a[92:95], v15 offset:16384
    v_mfma_f32_32x32x16_bf16 v[112:127], a[148:151], a[32:35], v[112:127]
    s_add_u32 m0, s51, 0
    s_add_u32 s84, s91, s87
    buffer_load_dwordx4 v8, s[8:11], s84 offen lds
    v_mfma_f32_32x32x16_bf16 v[96:111], a[152:155], a[36:39], v[96:111]
    s_waitcnt vmcnt(7)
    s_barrier
    ds_read_b64_tr_b16 a[144:145], v31 offset:0
    ds_read_b64_tr_b16 a[146:147], v31 offset:512
    ds_read_b64_tr_b16 a[148:149], v34 offset:0
    ds_read_b64_tr_b16 a[150:151], v34 offset:512
    s_waitcnt lgkmcnt(10)
    v_mfma_f32_32x32x16_bf16 v[112:127], a[156:159], a[36:39], v[112:127]
    buffer_load_dwordx4 v9, s[8:11], s84 offen offset:1024 lds
    ds_read_b64_tr_b16 a[152:153], v31 offset:2048
    ds_read_b64_tr_b16 a[154:155], v31 offset:2560
    ds_read_b64_tr_b16 a[156:157], v34 offset:2048
    v_mfma_f32_32x32x16_bf16 v[96:111], a[160:163], a[40:43], v[96:111]
    ds_read_b64_tr_b16 a[158:159], v34 offset:2560
    ds_read_b64_tr_b16 a[160:161], v31 offset:4096
    ds_read_b64_tr_b16 a[162:163], v31 offset:4608
    v_mfma_f32_32x32x16_bf16 v[112:127], a[164:167], a[40:43], v[112:127]
    s_add_u32 m0, s51, 0x6000
    s_add_u32 s83, s91, s87
    buffer_load_dwordx4 v10, s[8:11], s83 offen lds
    ds_read_b64_tr_b16 a[164:165], v34 offset:4096
    v_mfma_f32_32x32x16_bf16 v[96:111], a[168:171], a[44:47], v[96:111]
    ds_read_b64_tr_b16 a[166:167], v34 offset:4608
    ds_read_b64_tr_b16 a[168:169], v31 offset:6144
    ds_read_b64_tr_b16 a[170:171], v31 offset:6656
    s_waitcnt lgkmcnt(11)
    v_mfma_f32_32x32x16_bf16 v[112:127], a[172:175], a[44:47], v[112:127]
    buffer_load_dwordx4 v11, s[8:11], s83 offen offset:1024 lds
    ds_read_b64_tr_b16 a[172:173], v34 offset:6144
    ds_read_b64_tr_b16 a[174:175], v34 offset:6656
    v_mfma_f32_32x32x16_bf16 v[64:79], a[144:147], a[48:51], v[64:79]
    ds_read_b64_tr_b16 a[144:145], v31 offset:8192
    ds_read_b64_tr_b16 a[146:147], v31 offset:8704
    s_waitcnt lgkmcnt(8)
    v_mfma_f32_32x32x16_bf16 v[80:95], a[148:151], a[48:51], v[80:95]
    s_add_u32 m0, s51, 0x2000
    s_add_u32 s84, s92, s87
    buffer_load_dwordx4 v8, s[8:11], s84 offen lds
    ds_read_b64_tr_b16 a[148:149], v34 offset:8192
    v_mfma_f32_32x32x16_bf16 v[64:79], a[152:155], a[52:55], v[64:79]
    ds_read_b64_tr_b16 a[150:151], v34 offset:8704
    ds_read_b64_tr_b16 a[152:153], v31 offset:10240
    ds_read_b64_tr_b16 a[154:155], v31 offset:10752
    v_mfma_f32_32x32x16_bf16 v[80:95], a[156:159], a[52:55], v[80:95]
L_pad8:
    s_cbranch_execz L_wret
    buffer_load_dwordx4 v9, s[8:11], s84 offen offset:1024 lds
    ds_read_b64_tr_b16 a[156:157], v34 offset:10240
    ds_read_b64_tr_b16 a[158:159], v34 offset:10752
    v_mfma_f32_32x32x16_bf16 v[64:79], a[160:163], a[56:59], v[64:79]
    ds_read_b64_tr_b16 a[160:161], v31 offset:12288
    ds_read_b64_tr_b16 a[162:163], v31 offset:12800
    s_waitcnt lgkmcnt(8)
    v_mfma_f32_32x32x16_bf16 v[80:95], a[164:167], a[56:59], v[80:95]
    s_add_u32 m0, s51, 0x8000
    s_add_u32 s83, s92, s87
    buffer_load_dwordx4 v10, s[8:11], s83 offen lds
    ds_read_b64_tr_b16 a[164:165], v34 offset:12288
    v_mfma_f32_32x32x16_bf16 v[64:79], a[168:171], a[60:63], v[64:79]
    ds_read_b64_tr_b16 a[166:167], v34 offset:12800
    ds_read_b64_tr_b16 a[168:169], v31 offset:14336
    ds_read_b64_tr_b16 a[170:171], v31 offset:14848
    v_mfma_f32_32x32x16_bf16 v[80:95], a[172:175], a[60:63], v[80:95]
    buffer_load_dwordx4 v11, s[8:11], s83 offen offset:1024 lds
    ds_read_b64_tr_b16 a[172:173], v34 offset:14336
    ds_read_b64_tr_b16 a[174:175], v34 offset:14848
    v_mfma_f32_32x32x16_bf16 v[64:79], a[144:147], a[64:67], v[64:79]
    ds_read_b64_tr_b16 a[144:145], v31 offset:16384
    ds_read_b64_tr_b16 a[146:147], v31 offset:16896
    s_waitcnt lgkmcnt(8)
    v_mfma_f32_32x32x16_bf16 v[80:95], a[148:151], a[64:67], v[80:95]
    s_add_u32 m0, s51, 0x4000
    s_add_u32 s84, s93, s87
    buffer_load_dwordx4 v8, s[8:11], s84 offen lds
    ds_read_b64_tr_b16 a[148:149], v34 offset:16384
    v_mfma_f32_32x32x16_bf16 v[64:79], a[152:155], a[68:71], v[64:79]
    ds_read_b64_tr_b16 a[150:151], v34 offset:16896
    ds_read_b64_tr_b16 a[152:153], v31 offset:18432
    ds_read_b64_tr_b16 a[154:155], v31 offset:18944
    v_bfi_b32 v8, s98, v224, v225
    v_mfma_f32_32x32x16_bf16 v[80:95], a[156:159], a[68:71], v[80:95]
    buffer_load_dwordx4 v9, s[8:11], s84 offen offset:1024 lds
    ds_read_b64_tr_b16 a[156:157], v34 offset:18432
    ds_read_b64_tr_b16 a[158:159], v34 offset:18944
    v_bfi_b32 v9, s98, v226, v227
    v_mfma_f32_32x32x16_bf16 v[64:79], a[160:163], a[72:75], v[64:79]
    ds_read_b64_tr_b16 a[160:161], v31 offset:20480
    ds_read_b64_tr_b16 a[162:163], v31 offset:20992
    s_waitcnt lgkmcnt(8)
    v_mfma_f32_32x32x16_bf16 v[80:95], a[164:167], a[72:75], v[80:95]
    s_add_u32 m0, s51, 0xa000
    s_add_u32 s83, s93, s87
    buffer_load_dwordx4 v10, s[8:11], s83 offen lds
    ds_read_b64_tr_b16 a[164:165], v34 offset:20480
    v_mfma_f32_32x32x16_bf16 v[64:79], a[168:171], a[76:79], v[64:79]
    ds_read_b64_tr_b16 a[166:167], v34 offset:20992
    ds_read_b64_tr_b16 a[168:169], v31 offset:22528
    ds_read_b64_tr_b16 a[170:171], v31 offset:23040
    v_bfi_b32 v10, s98, v228, v229
    v_mfma_f32_32x32x16_bf16 v[80:95], a[172:175], a[76:79], v[80:95]
    buffer_load_dwordx4 v11, s[8:11], s83 offen offset:1024 lds
    ds_read_b64_tr_b16 a[172:173], v34 offset:22528
    ds_read_b64_tr_b16 a[174:175], v34 offset:23040
    v_bfi_b32 v11, s98, v230, v231
    v_mfma_f32_32x32x16_bf16 v[64:79], a[144:147], a[80:83], v[64:79]
    s_waitcnt lgkmcnt(6)
    v_mfma_f32_32x32x16_bf16 v[80:95], a[148:151], a[80:83], v[80:95]
    s_add_u32 m0, s51, 0x18000
    s_mul_i32 s84, s91, 0x6c0
    s_add_u32 s84, s84, s70
    buffer_load_dwordx4 v16, s[12:15], s84 offen lds
    v_mfma_f32_32x32x16_bf16 v[64:79], a[152:155], a[84:87], v[64:79]
    s_waitcnt vmcnt(13)
    s_barrier
    s_nop 0
L_pad9:
    s_cbranch_execz L_wret
    ds_read_b64_tr_b16 a[144:145], v31 offset:24576
    ds_read_b64_tr_b16 a[146:147], v31 offset:25088
    ds_read_b64_tr_b16 a[148:149], v34 offset:24576
    ds_read_b64_tr_b16 a[150:151], v34 offset:25088
    v_mfma_f32_32x32x16_bf16 v[80:95], a[156:159], a[84:87], v[80:95]
    buffer_load_dwordx4 v17, s[12:15], s84 offen offset:1024 lds
    ds_read_b64_tr_b16 a[152:153], v31 offset:26624
    ds_read_b64_tr_b16 a[154:155], v31 offset:27136
    ds_read_b64_tr_b16 a[156:157], v34 offset:26624
    v_mfma_f32_32x32x16_bf16 v[64:79], a[160:163], a[88:91], v[64:79]
    ds_read_b64_tr_b16 a[158:159], v34 offset:27136
    ds_read_b64_tr_b16 a[160:161], v31 offset:28672
    ds_read_b64_tr_b16 a[162:163], v31 offset:29184
    s_waitcnt lgkmcnt(10)
    v_mfma_f32_32x32x16_bf16 v[80:95], a[164:167], a[88:91], v[80:95]
    s_add_u32 m0, s51, 0x1a000
    s_mul_i32 s83, s92, 0x6c0
    s_add_u32 s83, s83, s70
    buffer_load_dwordx4 v16, s[12:15], s83 offen lds
    v_mfma_f32_32x32x16_bf16 v[64:79], a[168:171], a[92:95], v[64:79]
    ds_read_b64_tr_b16 a[164:165], v34 offset:28672
    ds_read_b64_tr_b16 a[166:167], v34 offset:29184
    ds_read_b64_tr_b16 a[168:169], v31 offset:30720
    ds_read_b64_tr_b16 a[170:171], v31 offset:31232
    v_mfma_f32_32x32x16_bf16 v[80:95], a[172:175], a[92:95], v[80:95]
    buffer_load_dwordx4 v17, s[12:15], s83 offen offset:1024 lds
    ds_read_b64_tr_b16 a[172:173], v34 offset:30720
    ds_read_b64_tr_b16 a[174:175], v34 offset:31232
    s_waitcnt lgkmcnt(10)
    v_mfma_f32_32x32x16_bf16 v[96:111], a[144:147], a[48:51], v[96:111]
    ds_read_b64_tr_b16 a[144:145], v31 offset:32768
    ds_read_b64_tr_b16 a[146:147], v31 offset:33280
    v_mfma_f32_32x32x16_bf16 v[112:127], a[148:151], a[48:51], v[112:127]
    s_add_u32 m0, s51, 0x1c000
    s_mul_i32 s84, s93, 0x6c0
    s_add_u32 s84, s84, s70
    buffer_load_dwordx4 v16, s[12:15], s84 offen lds
    v_mfma_f32_32x32x16_bf16 v[96:111], a[152:155], a[52:55], v[96:111]
    ds_read_b64_tr_b16 a[148:149], v34 offset:32768
    ds_read_b64_tr_b16 a[150:151], v34 offset:33280
    ds_read_b64_tr_b16 a[152:153], v31 offset:34816
    ds_read_b64_tr_b16 a[154:155], v31 offset:35328
    s_mov_b32 s70, s81
    s_add_u32 s81, s79, s76
    s_waitcnt lgkmcnt(8)
    v_mfma_f32_32x32x16_bf16 v[112:127], a[156:159], a[52:55], v[112:127]
    buffer_load_dwordx4 v17, s[12:15], s84 offen offset:1024 lds
    ds_read_b64_tr_b16 a[156:157], v34 offset:34816
    ds_read_b64_tr_b16 a[158:159], v34 offset:35328
    s_mov_b32 s76, 0
    v_mfma_f32_32x32x16_bf16 v[96:111], a[160:163], a[56:59], v[96:111]
    ds_read_b64_tr_b16 a[160:161], v31 offset:36864
    ds_read_b64_tr_b16 a[162:163], v31 offset:37376
    s_waitcnt vmcnt(14)
    ds_read_b128 a[96:99], v12 offset:0
    ds_read_b128 a[100:103], v13 offset:0
    ds_read_b128 a[104:107], v14 offset:0
    v_mfma_f32_32x32x16_bf16 v[112:127], a[164:167], a[56:59], v[112:127]
    s_add_u32 m0, s51, 0x1e000
    s_mul_i32 s83, s91, 0x6c0
    s_add_u32 s83, s83, s71
    buffer_load_dwordx4 v16, s[12:15], s83 offen lds
    v_mfma_f32_32x32x16_bf16 v[96:111], a[168:171], a[60:63], v[96:111]
    ds_read_b64_tr_b16 a[164:165], v34 offset:36864
    ds_read_b64_tr_b16 a[166:167], v34 offset:37376
    ds_read_b64_tr_b16 a[168:169], v31 offset:38912
    ds_read_b64_tr_b16 a[170:171], v31 offset:39424
    ds_read_b128 a[108:111], v15 offset:0
    s_add_u32 s76, s76, s48
L_pad10:
    s_cbranch_execz L_wret
    s_waitcnt lgkmcnt(12)
    v_mfma_f32_32x32x16_bf16 v[112:127], a[172:175], a[60:63], v[112:127]
    buffer_load_dwordx4 v17, s[12:15], s83 offen offset:1024 lds
    ds_read_b64_tr_b16 a[172:173], v34 offset:38912
    ds_read_b64_tr_b16 a[174:175], v34 offset:39424
    s_and_b32 s76, s76, 3
    v_mfma_f32_32x32x16_bf16 v[96:111], a[144:147], a[64:67], v[96:111]
    ds_read_b64_tr_b16 a[144:145], v31 offset:40960
    ds_read_b64_tr_b16 a[146:147], v31 offset:41472
    s_lshl_b32 s76, s76, 6
    s_add_u32 s76, s76, s77
    s_add_u32 s5, s76, s80
    s_mul_i32 s76, s49, 36
    v_mfma_f32_32x32x16_bf16 v[112:127], a[148:151], a[64:67], v[112:127]
    s_add_u32 m0, s51, 0x20000
    s_mul_i32 s84, s92, 0x6c0
    s_add_u32 s84, s84, s71
    buffer_load_dwordx4 v16, s[12:15], s84 offen lds
    v_mfma_f32_32x32x16_bf16 v[96:111], a[152:155], a[68:71], v[96:111]
    ds_read_b64_tr_b16 a[148:149], v34 offset:40960
    ds_read_b64_tr_b16 a[150:151], v34 offset:41472
    ds_read_b64_tr_b16 a[152:153], v31 offset:43008
    ds_read_b64_tr_b16 a[154:155], v31 offset:43520
    s_waitcnt vmcnt(13)
    ds_read_b128 a[112:115], v12 offset:8192
    s_waitcnt lgkmcnt(9)
    v_mfma_f32_32x32x16_bf16 v[112:127], a[156:159], a[68:71], v[112:127]
    buffer_load_dwordx4 v17, s[12:15], s84 offen offset:1024 lds
    ds_read_b64_tr_b16 a[156:157], v34 offset:43008
    ds_read_b64_tr_b16 a[158:159], v34 offset:43520
    ds_read_b128 a[116:119], v13 offset:8192
    v_mfma_f32_32x32x16_bf16 v[96:111], a[160:163], a[72:75], v[96:111]
    ds_read_b64_tr_b16 a[160:161], v31 offset:45056
    ds_read_b64_tr_b16 a[162:163], v31 offset:45568
    ds_read_b128 a[120:123], v14 offset:8192
    ds_read_b128 a[124:127], v15 offset:8192
    s_mov_b32 s92, -1
    v_mfma_f32_32x32x16_bf16 v[112:127], a[164:167], a[72:75], v[112:127]
    s_add_u32 m0, s51, 0x22000
    s_mul_i32 s83, s93, 0x6c0
    s_add_u32 s83, s83, s71
    buffer_load_dwordx4 v16, s[12:15], s83 offen lds
    v_mfma_f32_32x32x16_bf16 v[96:111], a[168:171], a[76:79], v[96:111]
    ds_read_b64_tr_b16 a[164:165], v34 offset:45056
    ds_read_b64_tr_b16 a[166:167], v34 offset:45568
    ds_read_b64_tr_b16 a[168:169], v31 offset:47104
    ds_read_b64_tr_b16 a[170:171], v31 offset:47616
    s_waitcnt vmcnt(11)
    ds_read_b128 a[128:131], v12 offset:16384
    s_waitcnt lgkmcnt(12)
    v_mfma_f32_32x32x16_bf16 v[112:127], a[172:175], a[76:79], v[112:127]
    buffer_load_dwordx4 v17, s[12:15], s83 offen offset:1024 lds
    ds_read_b64_tr_b16 a[172:173], v34 offset:47104
    ds_read_b64_tr_b16 a[174:175], v34 offset:47616
    ds_read_b128 a[132:135], v13 offset:16384
    v_mfma_f32_32x32x16_bf16 v[96:111], a[144:147], a[80:83], v[96:111]
    ds_read_b128 a[136:139], v14 offset:16384
    ds_read_b128 a[140:143], v15 offset:16384
    s_mov_b32 s93, 0
    v_bfi_b32 v12, s98, v232, v233
    v_bfi_b32 v13, s98, v234, v235
    v_bfi_b32 v14, s98, v236, v237
    v_mfma_f32_32x32x16_bf16 v[112:127], a[148:151], a[80:83], v[112:127]
    s_add_u32 m0, s51, 0
    s_add_u32 s84, s56, s65
    buffer_load_dwordx4 v18, s[16:19], s84 offen lds
    v_bfi_b32 v15, s98, v238, v239
    v_mfma_f32_32x32x16_bf16 v[96:111], a[152:155], a[84:87], v[96:111]
    s_waitcnt vmcnt(7)
    s_barrier
    ds_read_b64_tr_b16 a[144:145], v32 offset:0
    ds_read_b64_tr_b16 a[146:147], v32 offset:512
    s_nop 0
L_pad11:
    s_cbranch_execz L_wret
    ds_read_b64_tr_b16 a[148:149], v35 offset:0
    ds_read_b64_tr_b16 a[150:151], v35 offset:512
    s_waitcnt lgkmcnt(9)
    v_mfma_f32_32x32x16_bf16 v[112:127], a[156:159], a[84:87], v[112:127]
    buffer_load_dwordx4 v19, s[16:19], s84 offen offset:1024 lds
    ds_read_b64_tr_b16 a[152:153], v32 offset:2048
    ds_read_b64_tr_b16 a[154:155], v32 offset:2560
    ds_read_b64_tr_b16 a[156:157], v35 offset:2048
    v_mfma_f32_32x32x16_bf16 v[96:111], a[160:163], a[88:91], v[96:111]
    ds_read_b64_tr_b16 a[158:159], v35 offset:2560
    ds_read_b64_tr_b16 a[160:161], v32 offset:4096
    ds_read_b64_tr_b16 a[162:163], v32 offset:4608
    s_cmp_eq_u32 s50, 0
    s_cselect_b32 s5, s70, s5
    v_mfma_f32_32x32x16_bf16 v[112:127], a[164:167], a[88:91], v[112:127]
    s_add_u32 m0, s51, 0x2000
    s_add_u32 s83, s57, s65
    buffer_load_dwordx4 v18, s[16:19], s83 offen lds
    ds_read_b64_tr_b16 a[164:165], v35 offset:4096
    v_mfma_f32_32x32x16_bf16 v[96:111], a[168:171], a[92:95], v[96:111]
    ds_read_b64_tr_b16 a[166:167], v35 offset:4608
    ds_read_b64_tr_b16 a[168:169], v32 offset:6144
    ds_read_b64_tr_b16 a[170:171], v32 offset:6656
    s_waitcnt lgkmcnt(11)
    v_mfma_f32_32x32x16_bf16 v[112:127], a[172:175], a[92:95], v[112:127]
    buffer_load_dwordx4 v19, s[16:19], s83 offen offset:1024 lds
    ds_read_b64_tr_b16 a[172:173], v35 offset:6144
    ds_read_b64_tr_b16 a[174:175], v35 offset:6656
    v_mfma_f32_32x32x16_bf16 v[64:79], a[144:147], a[96:99], v[64:79]
    ds_read_b64_tr_b16 a[144:145], v32 offset:8192
    ds_read_b64_tr_b16 a[146:147], v32 offset:8704
    s_waitcnt lgkmcnt(8)
    v_mfma_f32_32x32x16_bf16 v[80:95], a[148:151], a[96:99], v[80:95]
    s_add_u32 m0, s51, 0x4000
    s_add_u32 s84, s58, s65
    buffer_load_dwordx4 v18, s[16:19], s84 offen lds
    ds_read_b64_tr_b16 a[148:149], v35 offset:8192
    v_mfma_f32_32x32x16_bf16 v[64:79], a[152:155], a[100:103], v[64:79]
    ds_read_b64_tr_b16 a[150:151], v35 offset:8704
    ds_read_b64_tr_b16 a[152:153], v32 offset:10240
    ds_read_b64_tr_b16 a[154:155], v32 offset:10752
    v_mfma_f32_32x32x16_bf16 v[80:95], a[156:159], a[100:103], v[80:95]
    buffer_load_dwordx4 v19, s[16:19], s84 offen offset:1024 lds
    ds_read_b64_tr_b16 a[156:157], v35 offset:10240
    ds_read_b64_tr_b16 a[158:159], v35 offset:10752
    v_mfma_f32_32x32x16_bf16 v[64:79], a[160:163], a[104:107], v[64:79]
    ds_read_b64_tr_b16 a[160:161], v32 offset:12288
    ds_read_b64_tr_b16 a[162:163], v32 offset:12800
    s_waitcnt lgkmcnt(8)
    v_mfma_f32_32x32x16_bf16 v[80:95], a[164:167], a[104:107], v[80:95]
    s_add_u32 m0, s51, 0x6000
    s_add_u32 s83, s59, s65
    buffer_load_dwordx4 v18, s[16:19], s83 offen lds
    ds_read_b64_tr_b16 a[164:165], v35 offset:12288
    v_mfma_f32_32x32x16_bf16 v[64:79], a[168:171], a[108:111], v[64:79]
    ds_read_b64_tr_b16 a[166:167], v35 offset:12800
    ds_read_b64_tr_b16 a[168:169], v32 offset:14336
    ds_read_b64_tr_b16 a[170:171], v32 offset:14848
    v_mfma_f32_32x32x16_bf16 v[80:95], a[172:175], a[108:111], v[80:95]
    buffer_load_dwordx4 v19, s[16:19], s83 offen offset:1024 lds
    ds_read_b64_tr_b16 a[172:173], v35 offset:14336
    ds_read_b64_tr_b16 a[174:175], v35 offset:14848
    v_mfma_f32_32x32x16_bf16 v[64:79], a[144:147], a[112:115], v[64:79]
    ds_read_b64_tr_b16 a[144:145], v32 offset:16384
    ds_read_b64_tr_b16 a[146:147], v32 offset:16896
    s_waitcnt lgkmcnt(8)
    v_mfma_f32_32x32x16_bf16 v[80:95], a[148:151], a[112:115], v[80:95]
    s_add_u32 m0, s51, 0x8000
    s_add_u32 s84, s60, s65
L_pad12:
    s_cbranch_execz L_wret
    buffer_load_dwordx4 v18, s[16:19], s84 offen lds
    ds_read_b64_tr_b16 a[148:149], v35 offset:16384
    v_mfma_f32_32x32x16_bf16 v[64:79], a[152:155], a[116:119], v[64:79]
    ds_read_b64_tr_b16 a[150:151], v35 offset:16896
    ds_read_b64_tr_b16 a[152:153], v32 offset:18432
    ds_read_b64_tr_b16 a[154:155], v32 offset:18944
    v_mfma_f32_32x32x16_bf16 v[80:95], a[156:159], a[116:119], v[80:95]
    buffer_load_dwordx4 v19, s[16:19], s84 offen offset:1024 lds
    ds_read_b64_tr_b16 a[156:157], v35 offset:18432
    ds_read_b64_tr_b16 a[158:159], v35 offset:18944
    v_mfma_f32_32x32x16_bf16 v[64:79], a[160:163], a[120:123], v[64:79]
    ds_read_b64_tr_b16 a[160:161], v32 offset:20480
    ds_read_b64_tr_b16 a[162:163], v32 offset:20992
    s_waitcnt lgkmcnt(8)
    v_mfma_f32_32x32x16_bf16 v[80:95], a[164:167], a[120:123], v[80:95]
    s_add_u32 m0, s51, 0xa000
    s_add_u32 s83, s61, s65
    buffer_load_dwordx4 v18, s[16:19], s83 offen lds
    ds_read_b64_tr_b16 a[164:165], v35 offset:20480
    v_mfma_f32_32x32x16_bf16 v[64:79], a[168:171], a[124:127], v[64:79]
    ds_read_b64_tr_b16 a[166:167], v35 offset:20992
    ds_read_b64_tr_b16 a[168:169], v32 offset:22528
    ds_read_b64_tr_b16 a[170:171], v32 offset:23040
    v_mfma_f32_32x32x16_bf16 v[80:95], a[172:175], a[124:127], v[80:95]
    buffer_load_dwordx4 v19, s[16:19], s83 offen offset:1024 lds
    ds_read_b64_tr_b16 a[172:173], v35 offset:22528
    ds_read_b64_tr_b16 a[174:175], v35 offset:23040
    v_mfma_f32_32x32x16_bf16 v[64:79], a[144:147], a[128:131], v[64:79]
    s_cmp_eq_u32 s50, 1
    s_cselect_b32 s5, s76, s5
    s_cselect_b32 s77, 18, 16
    s_cselect_b64 s[8:9], s[24:25], s[20:21]
    s_cselect_b32 s10, s26, s22
    s_add_u32 s70, s5, s77
    s_waitcnt lgkmcnt(6)
    v_mfma_f32_32x32x16_bf16 v[80:95], a[148:151], a[128:131], v[80:95]
    s_add_u32 m0, s51, 0xc000
    s_add_u32 s84, s62, s65
    buffer_load_dwordx4 v18, s[16:19], s84 offen lds
    s_lshr_b32 s76, s50, 1
    v_mfma_f32_32x32x16_bf16 v[64:79], a[152:155], a[132:135], v[64:79]
    s_waitcnt vmcnt(13)
    s_barrier
    ds_read_b64_tr_b16 a[144:145], v32 offset:24576
    ds_read_b64_tr_b16 a[146:147], v32 offset:25088
    ds_read_b64_tr_b16 a[148:149], v35 offset:24576
    ds_read_b64_tr_b16 a[150:151], v35 offset:25088
    v_mfma_f32_32x32x16_bf16 v[80:95], a[156:159], a[132:135], v[80:95]
    buffer_load_dwordx4 v19, s[16:19], s84 offen offset:1024 lds
    ds_read_b64_tr_b16 a[152:153], v32 offset:26624
    ds_read_b64_tr_b16 a[154:155], v32 offset:27136
    ds_read_b64_tr_b16 a[156:157], v35 offset:26624
    v_mfma_f32_32x32x16_bf16 v[64:79], a[160:163], a[136:139], v[64:79]
    ds_read_b64_tr_b16 a[158:159], v35 offset:27136
    ds_read_b64_tr_b16 a[160:161], v32 offset:28672
    ds_read_b64_tr_b16 a[162:163], v32 offset:29184
    s_add_u32 s76, s76, 1
    s_add_u32 s76, s76, s48
    s_and_b32 s76, s76, 3
    s_waitcnt lgkmcnt(10)
    v_mfma_f32_32x32x16_bf16 v[80:95], a[164:167], a[136:139], v[80:95]
    s_add_u32 m0, s51, 0xe000
    s_add_u32 s83, s63, s65
    buffer_load_dwordx4 v18, s[16:19], s83 offen lds
    ds_read_b64_tr_b16 a[164:165], v35 offset:28672
    v_mfma_f32_32x32x16_bf16 v[64:79], a[168:171], a[140:143], v[64:79]
    ds_read_b64_tr_b16 a[166:167], v35 offset:29184
    ds_read_b64_tr_b16 a[168:169], v32 offset:30720
    ds_read_b64_tr_b16 a[170:171], v32 offset:31232
    s_lshl_b32 s76, s76, 6
    s_and_b32 s77, s50, 1
    s_lshl_b32 s77, s77, 5
    v_mfma_f32_32x32x16_bf16 v[80:95], a[172:175], a[140:143], v[80:95]
    buffer_load_dwordx4 v19, s[16:19], s83 offen offset:1024 lds
L_pad13:
    s_cbranch_execz L_wret
    ds_read_b64_tr_b16 a[172:173], v35 offset:30720
    ds_read_b64_tr_b16 a[174:175], v35 offset:31232
    s_add_u32 s76, s76, s77
    s_waitcnt lgkmcnt(10)
    v_mfma_f32_32x32x16_bf16 v[96:111], a[144:147], a[96:99], v[96:111]
    ds_read_b64_tr_b16 a[144:145], v32 offset:32768
    ds_read_b64_tr_b16 a[146:147], v32 offset:33280
    v_cvt_pk_bf16_f32 v240, v64, v65
    v_cvt_pk_bf16_f32 v241, v66, v67
    v_cvt_pk_bf16_f32 v242, v68, v69
    v_cvt_pk_bf16_f32 v243, v70, v71
    v_mfma_f32_32x32x16_bf16 v[112:127], a[148:151], a[96:99], v[112:127]
    s_add_u32 m0, s51, 0x10000
    s_add_u32 s84, s64, s65
    buffer_load_dwordx4 v18, s[16:19], s84 offen lds
    ds_read_b64_tr_b16 a[148:149], v35 offset:32768
    v_mfma_f32_32x32x16_bf16 v[96:111], a[152:155], a[100:103], v[96:111]
    ds_read_b64_tr_b16 a[150:151], v35 offset:33280
    ds_read_b64_tr_b16 a[152:153], v32 offset:34816
    ds_read_b64_tr_b16 a[154:155], v32 offset:35328
    v_cvt_pk_bf16_f32 v244, v72, v73
    v_cvt_pk_bf16_f32 v245, v74, v75
    v_cvt_pk_bf16_f32 v246, v76, v77
    s_waitcnt lgkmcnt(8)
    v_mfma_f32_32x32x16_bf16 v[112:127], a[156:159], a[100:103], v[112:127]
    buffer_load_dwordx4 v19, s[16:19], s84 offen offset:1024 lds
    ds_read_b64_tr_b16 a[156:157], v35 offset:34816
    ds_read_b64_tr_b16 a[158:159], v35 offset:35328
    v_cvt_pk_bf16_f32 v247, v78, v79
    v_mfma_f32_32x32x16_bf16 v[96:111], a[160:163], a[104:107], v[96:111]
    ds_read_b64_tr_b16 a[160:161], v32 offset:36864
    ds_read_b64_tr_b16 a[162:163], v32 offset:37376
    v_permlane32_swap_b32 v240, v242
    v_permlane32_swap_b32 v241, v243
    v_permlane32_swap_b32 v244, v246
    v_permlane32_swap_b32 v245, v247
    v_mfma_f32_32x32x16_bf16 v[112:127], a[164:167], a[104:107], v[112:127]
    s_add_u32 m0, s51, 0x12000
    s_add_u32 s83, s56, s66
    buffer_load_dwordx4 v18, s[16:19], s83 offen lds
    ds_read_b64_tr_b16 a[164:165], v35 offset:36864
    v_mfma_f32_32x32x16_bf16 v[96:111], a[168:171], a[108:111], v[96:111]
    ds_read_b64_tr_b16 a[166:167], v35 offset:37376
    ds_read_b64_tr_b16 a[168:169], v32 offset:38912
    ds_read_b64_tr_b16 a[170:171], v32 offset:39424
    v_cvt_pk_bf16_f32 v248, v80, v81
    v_cvt_pk_bf16_f32 v249, v82, v83
    v_cvt_pk_bf16_f32 v250, v84, v85
    s_waitcnt lgkmcnt(8)
    v_mfma_f32_32x32x16_bf16 v[112:127], a[172:175], a[108:111], v[112:127]
    buffer_load_dwordx4 v19, s[16:19], s83 offen offset:1024 lds
    ds_read_b64_tr_b16 a[172:173], v35 offset:38912
    ds_read_b64_tr_b16 a[174:175], v35 offset:39424
    v_cvt_pk_bf16_f32 v251, v86, v87
    v_mfma_f32_32x32x16_bf16 v[96:111], a[144:147], a[112:115], v[96:111]
    ds_read_b64_tr_b16 a[144:145], v32 offset:40960
    ds_read_b64_tr_b16 a[146:147], v32 offset:41472
    v_cvt_pk_bf16_f32 v252, v88, v89
    buffer_store_dwordx4 v[240:243], v45, s[28:31], s72 offen sc1
    v_mfma_f32_32x32x16_bf16 v[112:127], a[148:151], a[112:115], v[112:127]
    ds_read_b64_tr_b16 a[148:149], v35 offset:40960
    ds_read_b64_tr_b16 a[150:151], v35 offset:41472
    v_cvt_pk_bf16_f32 v253, v90, v91
    v_cvt_pk_bf16_f32 v254, v92, v93
    v_cvt_pk_bf16_f32 v255, v94, v95
    v_permlane32_swap_b32 v248, v250
    v_mfma_f32_32x32x16_bf16 v[96:111], a[152:155], a[116:119], v[96:111]
    s_add_u32 m0, s51, 0x14000
    s_add_u32 s84, s57, s66
    s_nop 0
L_pad14:
    s_cbranch_execz L_wret
    buffer_load_dwordx4 v18, s[16:19], s84 offen lds
    ds_read_b64_tr_b16 a[152:153], v32 offset:43008
    s_waitcnt lgkmcnt(7)
    v_mfma_f32_32x32x16_bf16 v[112:127], a[156:159], a[116:119], v[112:127]
    ds_read_b64_tr_b16 a[154:155], v32 offset:43520
    ds_read_b64_tr_b16 a[156:157], v35 offset:43008
    ds_read_b64_tr_b16 a[158:159], v35 offset:43520
    v_permlane32_swap_b32 v249, v251
    v_permlane32_swap_b32 v252, v254
    v_permlane32_swap_b32 v253, v255
    v_mfma_f32_32x32x16_bf16 v[96:111], a[160:163], a[120:123], v[96:111]
    buffer_load_dwordx4 v19, s[16:19], s84 offen offset:1024 lds
    ds_read_b64_tr_b16 a[160:161], v32 offset:45056
    ds_read_b64_tr_b16 a[162:163], v32 offset:45568
    s_add_u32 s6, s76, s80
    v_mfma_f32_32x32x16_bf16 v[112:127], a[164:167], a[120:123], v[112:127]
    ds_read_b64_tr_b16 a[164:165], v35 offset:45056
    ds_read_b64_tr_b16 a[166:167], v35 offset:45568
    s_mov_b32 s76, 3
    buffer_store_dwordx4 v[244:247], v45, s[28:31], s72 offen offset:1024 sc1
    v_mfma_f32_32x32x16_bf16 v[96:111], a[168:171], a[124:127], v[96:111]
    ds_read_b64_tr_b16 a[168:169], v32 offset:47104
    ds_read_b64_tr_b16 a[170:171], v32 offset:47616
    s_add_u32 s76, s76, s48
    s_and_b32 s76, s76, 3
    s_lshl_b32 s76, s76, 6
    s_and_b32 s77, s50, 1
    s_waitcnt lgkmcnt(10)
    v_mfma_f32_32x32x16_bf16 v[112:127], a[172:175], a[124:127], v[112:127]
    s_add_u32 m0, s51, 0x16000
    s_add_u32 s83, s58, s66
    buffer_load_dwordx4 v18, s[16:19], s83 offen lds
    ds_read_b64_tr_b16 a[172:173], v35 offset:47104
    v_mfma_f32_32x32x16_bf16 v[96:111], a[144:147], a[128:131], v[96:111]
    ds_read_b64_tr_b16 a[174:175], v35 offset:47616
    s_waitcnt vmcnt(19)
    s_barrier
    ds_read_b64_tr_b16 a[144:145], v30 offset:0
    ds_read_b64_tr_b16 a[146:147], v30 offset:512
    s_lshl_b32 s77, s77, 5
    v_mfma_f32_32x32x16_bf16 v[112:127], a[148:151], a[128:131], v[112:127]
    buffer_load_dwordx4 v19, s[16:19], s83 offen offset:1024 lds
    ds_read_b64_tr_b16 a[148:149], v33 offset:0
    ds_read_b64_tr_b16 a[150:151], v33 offset:512
    s_add_u32 s76, s76, s77
    s_waitcnt lgkmcnt(8)
    v_mfma_f32_32x32x16_bf16 v[96:111], a[152:155], a[132:135], v[96:111]
    ds_read_b64_tr_b16 a[152:153], v30 offset:2048
    ds_read_b64_tr_b16 a[154:155], v30 offset:2560
    buffer_store_dwordx4 v[248:251], v45, s[28:31], s72 offen offset:2048 sc1
    s_add_u32 s7, s76, s80
    v_mfma_f32_32x32x16_bf16 v[112:127], a[156:159], a[132:135], v[112:127]
    ds_read_b64_tr_b16 a[156:157], v33 offset:2048
    ds_read_b64_tr_b16 a[158:159], v33 offset:2560
    s_cmp_eq_u32 s50, 2
    s_cselect_b32 s7, s81, s7
    s_mul_i32 s76, s82, 36
    s_mul_i32 s5, s5, 0x480
    v_mfma_f32_32x32x16_bf16 v[96:111], a[160:163], a[136:139], v[96:111]
    ds_read_b64_tr_b16 a[160:161], v30 offset:4096
    ds_read_b64_tr_b16 a[162:163], v30 offset:4608
    buffer_store_dwordx4 v[252:255], v45, s[28:31], s72 offen offset:3072 sc1
    s_mul_i32 s6, s6, 0x480
    v_mfma_f32_32x32x16_bf16 v[112:127], a[164:167], a[136:139], v[112:127]
    ds_read_b64_tr_b16 a[164:165], v33 offset:4096
    ds_read_b64_tr_b16 a[166:167], v33 offset:4608
    s_mul_i32 s70, s70, 0x480
    s_waitcnt lgkmcnt(8)
    v_mfma_f32_32x32x16_bf16 v[96:111], a[168:171], a[140:143], v[96:111]
    s_cmp_eq_u32 s50, 3
    s_cselect_b32 s7, s76, s7
    s_cselect_b32 s77, 18, 16
    s_cselect_b64 s[12:13], s[24:25], s[20:21]
    s_cselect_b32 s14, s26, s22
    s_add_u32 s71, s7, s77
    v_mfma_f32_32x32x16_bf16 v[112:127], a[172:175], a[140:143], v[112:127]
    s_mul_i32 s7, s7, 0x480
    s_nop 0
L_pad15:
    s_cbranch_execz L_wret
    s_mul_i32 s71, s71, 0x480
    s_and_b32 s76, s49, 1
    s_mul_i32 s76, s76, 0x240
    s_mul_i32 s77, s48, 11
    s_lshr_b32 s77, s77, 5
    s_mul_i32 s77, s77, 3
    s_sub_u32 s77, s48, s77
    s_mul_i32 s97, s77, 0xc0
    s_mov_b32 s78, s97
    s_add_u32 s87, s78, s76
    s_add_u32 s78, s78, 0xc0
    s_cmp_ge_u32 s78, 0x240
    s_cselect_b32 s78, 0, s78
    s_add_u32 s88, s78, s76
    s_add_u32 s78, s78, 0xc0
    s_cmp_ge_u32 s78, 0x240
    s_cselect_b32 s78, 0, s78
    s_add_u32 s73, s78, s76
    s_lshr_b32 s77, s50, 1
    s_xor_b32 s77, s77, s49
    s_mul_i32 s77, s77, 36
    s_and_b32 s78, s50, 1
    s_mul_i32 s78, s78, 18
    s_add_u32 s77, s77, s78
    s_add_u32 s77, s77, 16
    s_mul_i32 s77, s77, 0x480
    s_add_u32 s55, s77, s76
    s_waitcnt lgkmcnt(0)
    s_nop 0
    s_nop 15
    s_branch L_join
L_var_none:
    s_lshl_b32 s71, s49, 7
    s_add_u32 s70, s71, 0x800
    s_add_u32 m0, s51, 0x1e000
    s_mul_i32 s84, s3, 0x6c0
    s_add_u32 s84, s84, s71
    buffer_load_dwordx4 v16, s[12:15], s84 offen lds
    buffer_load_dwordx4 v17, s[12:15], s84 offen offset:1024 lds
    s_add_u32 m0, s51, 0xc000
    s_add_u32 s83, s3, s87
    buffer_load_dwordx4 v8, s[8:11], s83 offen lds
    buffer_load_dwordx4 v9, s[8:11], s83 offen offset:1024 lds
    s_add_u32 m0, s51, 0x12000
    s_add_u32 s84, s3, s87
    buffer_load_dwordx4 v10, s[8:11], s84 offen lds
    buffer_load_dwordx4 v11, s[8:11], s84 offen offset:1024 lds
    s_add_u32 m0, s51, 0x20000
    s_mul_i32 s83, s4, 0x6c0
    s_add_u32 s83, s83, s71
    buffer_load_dwordx4 v16, s[12:15], s83 offen lds
    buffer_load_dwordx4 v17, s[12:15], s83 offen offset:1024 lds
    s_add_u32 m0, s51, 0xe000
    s_add_u32 s84, s4, s87
    buffer_load_dwordx4 v8, s[8:11], s84 offen lds
    buffer_load_dwordx4 v9, s[8:11], s84 offen offset:1024 lds
    s_add_u32 m0, s51, 0x14000
    s_add_u32 s83, s4, s87
    buffer_load_dwordx4 v10, s[8:11], s83 offen lds
    buffer_load_dwordx4 v11, s[8:11], s83 offen offset:1024 lds
    s_add_u32 m0, s51, 0x22000
    s_mul_i32 s84, s5, 0x6c0
    s_add_u32 s84, s84, s71
    buffer_load_dwordx4 v16, s[12:15], s84 offen lds
    s_sub_u32 s76, s49, 11
    s_min_u32 s76, s76, 3
    s_lshl_b32 s77, s76, 2
    v_lshrrev_b32 v65, 4, v60
    v_add_u32 v65, s77, v65
    v_xor_b32 v65, v65, v60
    v_and_b32 v65, 7, v65
    v_lshlrev_b32 v65, 4, v65
    s_lshl_b32 s77, s76, 3
    s_lshl_b32 s78, s50, 5
    s_add_u32 s77, s77, s78
    v_lshrrev_b32 v64, 3, v60
    v_add_u32 v64, s77, v64
    s_lshr_b32 s77, s76, 1
    s_mul_i32 s77, s77, 0x6000
    s_and_b32 s78, s76, 1
    s_lshl_b32 s78, s78, 10
    s_add_u32 s77, s77, s78
    s_add_u32 s77, s77, s51
    s_add_u32 s77, s77, 0xc000
    v_lshl_add_u32 v66, v60, 4, s77
    v_bfe_u32 v1, v60, 4, 1
    v_mul_u32_u24 v1, 0x6000, v1
    v_and_b32 v2, 15, v60
    v_lshl_add_u32 v1, v2, 7, v1
    s_nop 0
L_pad16:
    s_cbranch_execz L_wret
    buffer_load_dwordx4 v17, s[12:15], s84 offen offset:1024 lds
    v_add_u32 v1, s51, v1
    v_add_u32 v1, 0xc000, v1
    v_bfe_u32 v2, v60, 1, 3
    v_lshrrev_b32 v3, 5, v60
    v_xor_b32 v2, v2, v3
    v_lshl_add_u32 v12, v2, 4, v1
    v_xor_b32 v4, 2, v2
    v_lshl_add_u32 v13, v4, 4, v1
    v_xor_b32 v4, 4, v2
    v_lshl_add_u32 v14, v4, 4, v1
    v_xor_b32 v4, 6, v2
    v_lshl_add_u32 v15, v4, 4, v1
    v_bfe_u32 v1, v60, 2, 2
    v_and_b32 v2, 3, v60
    v_bfe_u32 v3, v60, 4, 1
    v_lshrrev_b32 v4, 5, v60
    v_lshlrev_b32 v5, 3, v2
    v_lshl_add_u32 v5, v3, 5, v5
    v_bfe_u32 v6, v60, 3, 1
    v_lshlrev_b32 v6, 6, v6
    v_lshl_add_u32 v7, v4, 3, v1
    v_lshl_add_u32 v7, v7, 7, v5
    v_add_u32 v30, v6, v7
    v_add_u32 v31, 0xc000, v30
    v_add_u32 v32, 0x18000, v30
    s_add_u32 m0, s51, 0x10000
    s_add_u32 s83, s5, s87
    buffer_load_dwordx4 v8, s[8:11], s83 offen lds
    v_lshl_add_u32 v7, v4, 3, v1
    v_lshl_add_u32 v7, v7, 7, v5
    v_xor_b32 v33, 64, v6
    v_add_u32 v33, v33, v7
    v_add_u32 v34, 0xc000, v33
    v_add_u32 v35, 0x18000, v33
    v_lshl_add_u32 v7, v4, 3, v1
    v_lshl_add_u32 v36, v7, 6, v5
    v_add_u32 v37, 0xc000, v36
    v_add_u32 v38, 0x18000, v36
    s_mul_i32 s76, s50, 0x24000
    s_mul_i32 s56, s3, 0x1200
    s_add_u32 s56, s56, s76
    s_mul_i32 s57, s4, 0x1200
    s_add_u32 s57, s57, s76
    s_mul_i32 s58, s5, 0x1200
    s_add_u32 s58, s58, s76
    s_mul_i32 s59, s6, 0x1200
    s_add_u32 s59, s59, s76
    s_mul_i32 s60, s7, 0x1200
    s_add_u32 s60, s60, s76
    s_mul_i32 s61, s90, 0x1200
    s_add_u32 s61, s61, s76
    s_mul_i32 s62, s91, 0x1200
    s_add_u32 s62, s62, s76
    buffer_load_dwordx4 v9, s[8:11], s83 offen offset:1024 lds
    s_mul_i32 s63, s92, 0x1200
    s_add_u32 s63, s63, s76
    s_mul_i32 s64, s93, 0x1200
    s_add_u32 s64, s64, s76
    s_mul_i32 s76, s49, 0x240
    s_and_b32 s77, s49, 1
    s_cselect_b32 s78, 64, 0
    s_cselect_b32 s79, 0, 0x200
    s_add_u32 s78, s78, s76
    s_add_u32 s69, s79, s76
    s_add_u32 s81, s48, 0
    s_and_b32 s81, s81, 3
    s_lshl_b32 s81, s81, 7
    s_add_u32 s65, s81, s78
    s_add_u32 s81, s48, 1
    s_and_b32 s81, s81, 3
    s_lshl_b32 s81, s81, 7
    s_add_u32 s66, s81, s78
    s_add_u32 s81, s48, 2
    s_and_b32 s81, s81, 3
    s_lshl_b32 s81, s81, 7
    s_add_u32 s67, s81, s78
    s_add_u32 s81, s48, 3
    s_and_b32 s81, s81, 3
    s_lshl_b32 s81, s81, 7
    s_add_u32 m0, s51, 0x16000
    s_add_u32 s84, s5, s87
    buffer_load_dwordx4 v10, s[8:11], s84 offen lds
    s_add_u32 s68, s81, s78
    v_lshrrev_b32 v3, 2, v60
    v_mul_u32_u24 v3, 0x2400, v3
L_pad17:
    s_cbranch_execz L_wret
    v_and_b32 v4, 3, v60
    v_lshl_add_u32 v20, v4, 4, v3
    s_lshl_b32 s89, s48, 2
    s_add_u32 s89, s89, s50
    s_mul_i32 s76, s89, 0x1b200
    s_lshl_b32 s77, s49, 12
    s_add_u32 s74, s76, s77
    s_mov_b32 s78, 0x3eae1a93
    s_cmp_lt_u32 s49, 9
    s_cselect_b32 s75, s78, 1.0
    v_lshlrev_b32 v45, 4, v60
    v_add_u32 v1, 0, v60
    v_mul_u32_u24 v2, 0xab, v1
    v_lshrrev_b32 v2, 11, v2
    v_mul_u32_u24 v2, 0x3c0, v2
    v_lshl_add_u32 v21, v60, 4, v2
    v_add_u32 v1, 64, v60
    v_mul_u32_u24 v2, 0xab, v1
    v_lshrrev_b32 v2, 11, v2
    v_mul_u32_u24 v2, 0x3c0, v2
    v_lshl_add_u32 v22, v60, 4, v2
    v_add_u32 v1, 0x80, v60
    buffer_load_dwordx4 v11, s[8:11], s84 offen offset:1024 lds
    v_mul_u32_u24 v2, 0xab, v1
    v_lshrrev_b32 v2, 11, v2
    v_mul_u32_u24 v2, 0x3c0, v2
    v_lshl_add_u32 v23, v60, 4, v2
    v_lshlrev_b32 v28, 4, v60
    s_mul_i32 s77, s49, 0x27000
    s_add_u32 s78, s77, s51
    v_bfe_u32 v1, v60, 2, 3
    v_lshl_add_u32 v1, v1, 8, s78
    v_lshrrev_b32 v2, 5, v60
    v_lshl_add_u32 v1, v2, 6, v1
    v_and_b32 v2, 3, v60
    v_lshl_add_u32 v57, v2, 4, v1
    s_mul_i32 s79, s50, 0x5400
    s_add_u32 s79, s79, 0x12000
    s_add_u32 s78, s77, s79
    v_add_u32 v24, s78, v28
    s_xor_b32 s80, s49, 1
    s_mul_i32 s77, s80, 0x27000
    s_add_u32 s78, s77, s79
    v_add_u32 v25, s78, v28
    s_mul_i32 s76, s49, 9
    s_lshr_b32 s76, s76, 1
    s_lshl_b32 s76, s76, 9
    v_lshrrev_b32 v1, 5, v60
    s_add_u32 m0, s51, 0
    s_add_u32 s83, s6, s87
    buffer_load_dwordx4 v8, s[8:11], s83 offen lds
    v_and_b32 v5, 19, v60
    v_bfe_u32 v6, v60, 2, 1
    v_lshl_add_u32 v5, v6, 3, v5
    v_bfe_u32 v6, v60, 3, 1
    v_lshl_add_u32 v5, v6, 2, v5
    v_lshl_add_u32 v5, v5, 4, s76
    v_lshl_add_u32 v6, v1, 9, v5
    v_add_u32 v48, 0x9000, v6
    v_add_u32 v49, 0x9200, v6
    v_add_u32 v5, 0x8c00, v5
    s_mul_i32 s77, s49, 36
    v_add_u32 v2, 0xffffffe0, v60
    v_max_i32 v2, 0, v2
    v_mul_u32_u24 v3, 0xcd, v2
    v_lshrrev_b32 v3, 13, v3
    v_mul_u32_u24 v4, 40, v3
    v_sub_u32 v4, v2, v4
    v_cmp_gt_u32 vcc, 36, v4
    v_mov_b32 v6, 0x21c
    v_mov_b32 v7, s77
    v_cndmask_b32 v6, v6, v7, vcc
    v_add_u32 v4, v4, v6
    v_mul_u32_u24 v3, 0x2480, v3
    v_lshl_add_u32 v4, v4, 4, v3
    v_add_u32 v50, 0x11800, v4
    buffer_load_dwordx4 v9, s[8:11], s83 offen offset:1024 lds
    v_cmp_gt_u32 vcc, 32, v60
    v_add_u32 v2, 32, v60
    v_mul_u32_u24 v3, 0xcd, v2
    v_cndmask_b32 v50, v50, v5, vcc
    v_lshrrev_b32 v3, 13, v3
    v_mul_u32_u24 v4, 40, v3
    v_sub_u32 v4, v2, v4
    v_cmp_gt_u32 vcc, 36, v4
    v_mov_b32 v6, 0x21c
L_pad18:
    s_cbranch_execz L_wret
    v_mov_b32 v7, s77
    v_cndmask_b32 v6, v6, v7, vcc
    v_add_u32 v4, v4, v6
    v_mul_u32_u24 v3, 0x2480, v3
    v_lshl_add_u32 v4, v4, 4, v3
    v_add_u32 v51, 0x11400, v4
    v_add_u32 v2, 0x60, v60
    v_mul_u32_u24 v3, 0xcd, v2
    v_lshrrev_b32 v3, 13, v3
    v_mul_u32_u24 v4, 40, v3
    v_sub_u32 v4, v2, v4
    v_cmp_gt_u32 vcc, 36, v4
    v_mov_b32 v6, 0x21c
    v_mov_b32 v7, s77
    v_cndmask_b32 v6, v6, v7, vcc
    v_add_u32 v4, v4, v6
    s_add_u32 m0, s51, 0x6000
    s_add_u32 s84, s6, s87
    buffer_load_dwordx4 v10, s[8:11], s84 offen lds
    v_mul_u32_u24 v3, 0x2480, v3
    v_lshl_add_u32 v4, v4, 4, v3
    v_add_u32 v52, 0x12000, v4
    s_add_u32 s78, s53, 0xc000
    v_lshl_add_u32 v53, v60, 4, s78
    v_and_b32 v2, 31, v60
    v_lshl_add_u32 v54, v2, 4, s78
    v_cmp_gt_u32 vcc, 18, v2
    v_mul_u32_u24 v3, 0x280, v1
    v_add_u32 v3, s78, v3
    v_add_u32 v4, 0, v2
    v_mov_b32 v6, 36
    v_cndmask_b32 v4, v6, v4, vcc
    v_lshl_add_u32 v55, v4, 4, v3
    v_add_u32 v4, 18, v2
    v_mov_b32 v6, 36
    v_cndmask_b32 v4, v6, v4, vcc
    v_lshl_add_u32 v56, v4, 4, v3
    v_lshlrev_b32 v3, 3, v1
    v_sub_u32 v61, v2, v3
    s_mov_b32 s94, 0
    s_mov_b32 s95, -1
    s_mov_b32 s98, 0xffff
    v_sub_u32 v224, -1, v61
    v_ashrrev_i32 v224, 31, v224
    buffer_load_dwordx4 v11, s[8:11], s84 offen offset:1024 lds
    v_sub_u32 v225, 0, v61
    v_ashrrev_i32 v225, 31, v225
    v_sub_u32 v226, 1, v61
    v_ashrrev_i32 v226, 31, v226
    v_sub_u32 v227, 2, v61
    v_ashrrev_i32 v227, 31, v227
    v_sub_u32 v228, 3, v61
    v_ashrrev_i32 v228, 31, v228
    v_sub_u32 v229, 4, v61
    v_ashrrev_i32 v229, 31, v229
    v_sub_u32 v230, 5, v61
    v_ashrrev_i32 v230, 31, v230
    v_sub_u32 v231, 6, v61
    v_ashrrev_i32 v231, 31, v231
    v_sub_u32 v232, 15, v61
    v_ashrrev_i32 v232, 31, v232
    v_sub_u32 v233, 16, v61
    v_ashrrev_i32 v233, 31, v233
    v_sub_u32 v234, 17, v61
    v_ashrrev_i32 v234, 31, v234
    v_sub_u32 v235, 18, v61
    v_ashrrev_i32 v235, 31, v235
    v_sub_u32 v236, 19, v61
    v_ashrrev_i32 v236, 31, v236
    v_sub_u32 v237, 20, v61
    buffer_load_dwordx4 v[164:167], v65, s[36:39], s3 offen
    v_ashrrev_i32 v237, 31, v237
    v_sub_u32 v238, 21, v61
    v_ashrrev_i32 v238, 31, v238
    v_sub_u32 v239, 22, v61
    v_ashrrev_i32 v239, 31, v239
    s_lshl_b32 s79, s89, 4
    s_add_u32 s80, s79, s49
    s_lshl_b32 s80, s80, 7
    s_add_u32 s80, s80, 0x800000
    v_bfe_u32 v5, v60, 3, 1
    v_mul_u32_u24 v5, 0x1ffe0, v5
    v_lshl_add_u32 v5, v60, 2, v5
    v_cmp_gt_u32 vcc, 16, v60
    v_mov_b32 v6, 0x7ffffff0
    v_mov_b32 v7, 0
    v_cndmask_b32 v5, v6, v5, vcc
    s_add_u32 s81, s80, 0x20000
    v_mov_b32 v26, s81
    s_xor_b32 s81, s81, 0x80
    v_cmp_eq_u32 vcc, 0, v60
    v_mov_b32 v240, 0x3f803f80
    v_mov_b32 v241, 0x3f803f80
    v_mov_b32 v242, 0x3f803f80
    v_mov_b32 v243, 0x3f803f80
    s_nop 0
L_pad19:
    s_cbranch_execz L_wret
    v_bfe_u32 v3, v60, 3, 2
    buffer_load_dwordx4 v[168:171], v65, s[36:39], s4 offen
    v_mul_u32_u24 v3, 0x2480, v3
    v_and_b32 v1, 7, v60
    v_lshl_add_u32 v44, v1, 4, v3
    s_mul_i32 s76, s89, 0x1b200
    s_add_u32 s72, s76, 0x14400
    s_cmp_eq_u32 s49, 11
    s_cselect_b32 s72, s72, 0x40000000
    buffer_load_dwordx4 v[172:175], v65, s[36:39], s5 offen
    buffer_load_dwordx4 v[176:179], v65, s[36:39], s6 offen
    buffer_load_dwordx4 v[180:183], v65, s[36:39], s7 offen
    buffer_load_dwordx4 v[184:187], v65, s[36:39], s90 offen
    buffer_load_dwordx4 v[188:191], v65, s[36:39], s91 offen
    buffer_load_dwordx4 v[192:195], v65, s[36:39], s92 offen
    buffer_load_dwordx4 v[196:199], v65, s[36:39], s93 offen
    buffer_store_dword v7, v5, s[28:31], s80 offen sc1
    v_mov_b32 v5, s81
    v_cndmask_b32 v29, v6, v5, vcc
    s_and_b32 s81, s49, 1
    s_add_u32 s79, s79, s81
    s_lshl_b32 s79, s79, 7
    s_lshr_b32 s81, s49, 1
    s_lshl_b32 s81, s81, 2
    s_add_u32 s79, s79, s81
    s_add_u32 s79, s79, 0x800000
    v_lshl_add_u32 v5, v60, 8, s79
    v_cmp_gt_u32 vcc, 8, v60
    buffer_store_dwordx4 v[240:243], v44, s[28:31], s72 offen sc1
    s_nop 0
    v_cndmask_b32 v61, v6, v5, vcc
    v_and_b32 v5, 3, v60
    v_min_u32 v5, 2, v5
    v_sub_u32 v5, s48, v5
    v_max_i32 v5, 0, v5
    v_lshlrev_b32 v59, 4, v5
    s_mov_b32 s96, 0
    s_movk_i32 s97, 0
    s_call_b64 s[0:1], L_warm
    s_waitcnt vmcnt(27)
    ds_read_b128 a[0:3], v12 offset:0
    ds_read_b128 a[4:7], v13 offset:0
    ds_read_b128 a[8:11], v14 offset:0
    ds_read_b128 a[12:15], v15 offset:0
    ds_read_b128 v[128:131], v66 offset:0
    s_barrier
    s_add_u32 m0, s51, 0x2000
    s_add_u32 s83, s7, s87
    buffer_load_dwordx4 v8, s[8:11], s83 offen lds
    ds_read_b64_tr_b16 a[144:145], v32 offset:24576
    ds_read_b64_tr_b16 a[146:147], v32 offset:25088
    ds_read_b64_tr_b16 a[148:149], v35 offset:24576
    ds_read_b64_tr_b16 a[150:151], v35 offset:25088
    ds_read_b64_tr_b16 a[152:153], v32 offset:26624
    ds_read_b64_tr_b16 a[154:155], v32 offset:27136
    ds_read_b64_tr_b16 a[156:157], v35 offset:26624
    ds_read_b64_tr_b16 a[158:159], v35 offset:27136
    buffer_load_dwordx4 v9, s[8:11], s83 offen offset:1024 lds
    ds_read_b64_tr_b16 a[160:161], v32 offset:28672
    ds_read_b64_tr_b16 a[162:163], v32 offset:29184
    ds_read_b64_tr_b16 a[164:165], v35 offset:28672
    ds_read_b64_tr_b16 a[166:167], v35 offset:29184
    ds_read_b64_tr_b16 a[168:169], v32 offset:30720
    ds_read_b64_tr_b16 a[170:171], v32 offset:31232
    ds_read_b64_tr_b16 a[172:173], v35 offset:30720
    ds_read_b64_tr_b16 a[174:175], v35 offset:31232
    s_add_u32 m0, s51, 0x8000
    s_add_u32 s84, s7, s87
    buffer_load_dwordx4 v10, s[8:11], s84 offen lds
    s_mul_i32 s76, s49, 0x120
    s_and_b32 s77, s49, 1
    s_cselect_b32 s78, 32, 0
    s_cselect_b32 s79, 0, 0x100
    s_add_u32 s80, s78, s76
    s_add_u32 s81, s79, s76
    s_lshr_b32 s76, s50, 1
    s_add_u32 s76, s76, 0
    buffer_load_dwordx4 v11, s[8:11], s84 offen offset:1024 lds
    s_add_u32 s76, s76, s48
    s_waitcnt lgkmcnt(14)
    s_nop 0
L_pad20:
    s_cbranch_execz L_wret
    v_mfma_f32_32x32x16_bf16 v[96:111], a[144:147], a[0:3], 0
    s_and_b32 s76, s76, 3
    s_lshl_b32 s76, s76, 6
    s_and_b32 s77, s50, 1
    s_lshl_b32 s77, s77, 5
    s_add_u32 s76, s76, s77
    s_add_u32 s3, s76, s80
    s_waitcnt lgkmcnt(8)
    v_mfma_f32_32x32x16_bf16 v[112:127], a[148:151], a[0:3], 0
    s_add_u32 m0, s51, 0x4000
    s_add_u32 s83, s90, s87
    buffer_load_dwordx4 v8, s[8:11], s83 offen lds
    s_lshr_b32 s76, s50, 1
    v_mfma_f32_32x32x16_bf16 v[96:111], a[152:155], a[4:7], v[96:111]
    s_add_u32 s76, s76, 2
    s_add_u32 s76, s76, s48
    s_and_b32 s76, s76, 3
    s_lshl_b32 s76, s76, 6
    s_and_b32 s77, s50, 1
    s_lshl_b32 s77, s77, 5
    v_mfma_f32_32x32x16_bf16 v[112:127], a[156:159], a[4:7], v[112:127]
    buffer_load_dwordx4 v9, s[8:11], s83 offen offset:1024 lds
    s_add_u32 s76, s76, s77
    s_add_u32 s4, s76, s80
    s_mov_b32 s70, s81
    s_waitcnt lgkmcnt(0)
    v_mfma_f32_32x32x16_bf16 v[96:111], a[160:163], a[8:11], v[96:111]
    s_waitcnt vmcnt(27)
    ds_read_b128 a[16:19], v12 offset:8192
    ds_read_b128 a[20:23], v13 offset:8192
    ds_read_b128 a[24:27], v14 offset:8192
    ds_read_b128 a[28:31], v15 offset:8192
    ds_read_b128 v[132:135], v66 offset:8192
    v_mfma_f32_32x32x16_bf16 v[112:127], a[164:167], a[8:11], v[112:127]
    s_add_u32 m0, s51, 0xa000
    s_add_u32 s84, s90, s87
    buffer_load_dwordx4 v10, s[8:11], s84 offen lds
    s_barrier
    v_mfma_f32_32x32x16_bf16 v[96:111], a[168:171], a[12:15], v[96:111]
    ds_read_b64_tr_b16 a[144:145], v32 offset:32768
    ds_read_b64_tr_b16 a[146:147], v32 offset:33280
    ds_read_b64_tr_b16 a[148:149], v35 offset:32768
    ds_read_b64_tr_b16 a[150:151], v35 offset:33280
    ds_read_b64_tr_b16 a[152:153], v32 offset:34816
    ds_read_b64_tr_b16 a[154:155], v32 offset:35328
    v_mfma_f32_32x32x16_bf16 v[112:127], a[172:175], a[12:15], v[112:127]
    buffer_load_dwordx4 v11, s[8:11], s84 offen offset:1024 lds
    ds_read_b64_tr_b16 a[156:157], v35 offset:34816
    ds_read_b64_tr_b16 a[158:159], v35 offset:35328
    ds_read_b64_tr_b16 a[160:161], v32 offset:36864
    ds_read_b64_tr_b16 a[162:163], v32 offset:37376
    ds_read_b64_tr_b16 a[164:165], v35 offset:36864
    ds_read_b64_tr_b16 a[166:167], v35 offset:37376
    ds_read_b64_tr_b16 a[168:169], v32 offset:38912
    ds_read_b64_tr_b16 a[170:171], v32 offset:39424
    s_add_u32 m0, s51, 0x18000
    s_mul_i32 s83, s6, 0x6c0
    s_add_u32 s83, s83, s71
    buffer_load_dwordx4 v16, s[12:15], s83 offen lds
    ds_read_b64_tr_b16 a[172:173], v35 offset:38912
    ds_read_b64_tr_b16 a[174:175], v35 offset:39424
    s_xor_b32 s82, s49, 1
    s_mul_i32 s76, s82, 0x120
    s_and_b32 s77, s82, 1
    s_cselect_b32 s78, 32, 0
    s_cselect_b32 s79, 0, 0x100
    s_add_u32 s80, s78, s76
    buffer_load_dwordx4 v17, s[12:15], s83 offen offset:1024 lds
    s_waitcnt lgkmcnt(14)
    v_mfma_f32_32x32x16_bf16 v[96:111], a[144:147], a[16:19], v[96:111]
    s_add_u32 s81, s79, s76
    s_mov_b32 s76, 0
    s_add_u32 s76, s76, s48
    s_and_b32 s76, s76, 3
    s_lshl_b32 s76, s76, 6
    s_and_b32 s77, s50, 1
    s_waitcnt lgkmcnt(10)
    v_mfma_f32_32x32x16_bf16 v[112:127], a[148:151], a[16:19], v[112:127]
    s_add_u32 m0, s51, 0x1a000
    s_mul_i32 s84, s7, 0x6c0
    s_add_u32 s84, s84, s71
    s_nop 0
L_pad21:
    s_cbranch_execz L_wret
    buffer_load_dwordx4 v16, s[12:15], s84 offen lds
    v_mfma_f32_32x32x16_bf16 v[96:111], a[152:155], a[20:23], v[96:111]
    s_lshl_b32 s77, s77, 5
    s_add_u32 s76, s76, s77
    s_add_u32 s5, s76, s80
    s_cmp_eq_u32 s50, 0
    s_cselect_b32 s5, s70, s5
    s_mul_i32 s76, s49, 36
    s_waitcnt lgkmcnt(0)
    v_mfma_f32_32x32x16_bf16 v[112:127], a[156:159], a[20:23], v[112:127]
    buffer_load_dwordx4 v17, s[12:15], s84 offen offset:1024 lds
    s_mul_i32 s3, s3, 0x480
    s_mul_i32 s4, s4, 0x480
    v_mov_b32 v68, 0
    v_mfma_f32_32x32x16_bf16 v[96:111], a[160:163], a[24:27], v[96:111]
    s_waitcnt vmcnt(27)
    ds_read_b128 a[32:35], v12 offset:16384
    ds_read_b128 a[36:39], v13 offset:16384
    ds_read_b128 a[40:43], v14 offset:16384
    ds_read_b128 a[44:47], v15 offset:16384
    ds_read_b128 v[136:139], v66 offset:16384
    v_mfma_f32_32x32x16_bf16 v[112:127], a[164:167], a[24:27], v[112:127]
    s_add_u32 m0, s51, 0x1c000
    s_mul_i32 s83, s90, 0x6c0
    s_add_u32 s83, s83, s71
    buffer_load_dwordx4 v16, s[12:15], s83 offen lds
    v_mfma_f32_32x32x16_bf16 v[96:111], a[168:171], a[28:31], v[96:111]
    v_add_u32 v12, 0xffff4000, v12
    v_add_u32 v13, 0xffff4000, v13
    v_add_u32 v14, 0xffff4000, v14
    v_add_u32 v15, 0xffff4000, v15
    v_add_u32 v66, 0xffff4000, v66
    s_barrier
    v_mfma_f32_32x32x16_bf16 v[112:127], a[172:175], a[28:31], v[112:127]
    buffer_load_dwordx4 v17, s[12:15], s83 offen offset:1024 lds
    ds_read_b64_tr_b16 a[144:145], v32 offset:40960
    ds_read_b64_tr_b16 a[146:147], v32 offset:41472
    ds_read_b64_tr_b16 a[148:149], v35 offset:40960
    ds_read_b64_tr_b16 a[150:151], v35 offset:41472
    ds_read_b64_tr_b16 a[152:153], v32 offset:43008
    ds_read_b64_tr_b16 a[154:155], v32 offset:43520
    ds_read_b64_tr_b16 a[156:157], v35 offset:43008
    ds_read_b64_tr_b16 a[158:159], v35 offset:43520
    s_add_u32 m0, s51, 0xc000
    s_add_u32 s84, s91, s87
    buffer_load_dwordx4 v8, s[8:11], s84 offen lds
    ds_read_b64_tr_b16 a[160:161], v32 offset:45056
    ds_read_b64_tr_b16 a[162:163], v32 offset:45568
    ds_read_b64_tr_b16 a[164:165], v35 offset:45056
    ds_read_b64_tr_b16 a[166:167], v35 offset:45568
    ds_read_b64_tr_b16 a[168:169], v32 offset:47104
    ds_read_b64_tr_b16 a[170:171], v32 offset:47616
    ds_read_b64_tr_b16 a[172:173], v35 offset:47104
    ds_read_b64_tr_b16 a[174:175], v35 offset:47616
    buffer_load_dwordx4 v9, s[8:11], s84 offen offset:1024 lds
    v_mov_b32 v69, 0
    v_lshlrev_b32 v72, 16, v128
    v_and_b32 v73, 0xffff0000, v128
    s_waitcnt vmcnt(26)
    v_lshlrev_b32 v74, 16, v164
    v_and_b32 v75, 0xffff0000, v164
    v_mul_f32 v72, v72, v74
    v_mul_f32 v73, v73, v75
    s_add_u32 m0, s51, 0x12000
    s_add_u32 s83, s91, s87
    buffer_load_dwordx4 v10, s[8:11], s83 offen lds
    s_waitcnt lgkmcnt(13)
    v_mfma_f32_32x32x16_bf16 v[96:111], a[144:147], a[32:35], v[96:111]
    ds_read_b128 a[48:51], v12 offset:0
    ds_read_b128 a[52:55], v13 offset:0
    ds_read_b128 a[56:59], v14 offset:0
    ds_read_b128 a[60:63], v15 offset:0
    ds_read_b128 v[140:143], v66 offset:0
    s_nop 0
L_pad22:
    s_cbranch_execz L_wret
    v_cvt_pk_bf16_f32 v76, v72, v73
    s_waitcnt lgkmcnt(13)
    v_mfma_f32_32x32x16_bf16 v[112:127], a[148:151], a[32:35], v[112:127]
    buffer_load_dwordx4 v11, s[8:11], s83 offen offset:1024 lds
    v_lshlrev_b32 v72, 16, v76
    v_and_b32 v73, 0xffff0000, v76
    v_add_f32 v68, v68, v72
    v_mfma_f32_32x32x16_bf16 v[96:111], a[152:155], a[36:39], v[96:111]
    s_waitcnt vmcnt(14)
    ds_read_b128 a[64:67], v12 offset:8192
    ds_read_b128 a[68:71], v13 offset:8192
    ds_read_b128 a[72:75], v14 offset:8192
    ds_read_b128 a[76:79], v15 offset:8192
    ds_read_b128 v[144:147], v66 offset:8192
    v_mfma_f32_32x32x16_bf16 v[112:127], a[156:159], a[36:39], v[112:127]
    s_add_u32 m0, s51, 0xe000
    s_add_u32 s84, s92, s87
    buffer_load_dwordx4 v8, s[8:11], s84 offen lds
    s_waitcnt vmcnt(5) lgkmcnt(10)
    s_barrier
    v_mfma_f32_32x32x16_bf16 v[96:111], a[160:163], a[40:43], v[96:111]
    ds_read_b128 a[80:83], v12 offset:16384
    ds_read_b128 a[84:87], v13 offset:16384
    ds_read_b128 a[88:91], v14 offset:16384
    ds_read_b128 a[92:95], v15 offset:16384
    ds_read_b128 v[148:151], v66 offset:16384
    v_add_u32 v12, 0xc000, v12
    v_mfma_f32_32x32x16_bf16 v[112:127], a[164:167], a[40:43], v[112:127]
    buffer_load_dwordx4 v9, s[8:11], s84 offen offset:1024 lds
    v_add_u32 v13, 0xc000, v13
    v_add_u32 v14, 0xc000, v14
    v_add_u32 v15, 0xc000, v15
    v_mfma_f32_32x32x16_bf16 v[96:111], a[168:171], a[44:47], v[96:111]
    v_add_u32 v66, 0xc000, v66
    ds_read_b64_tr_b16 a[144:145], v32 offset:0
    ds_read_b64_tr_b16 a[146:147], v32 offset:512
    ds_read_b64_tr_b16 a[148:149], v35 offset:0
    ds_read_b64_tr_b16 a[150:151], v35 offset:512
    ds_read_b64_tr_b16 a[152:153], v32 offset:2048
    v_mfma_f32_32x32x16_bf16 v[112:127], a[172:175], a[44:47], v[112:127]
    s_add_u32 m0, s51, 0x14000
    s_add_u32 s83, s92, s87
    buffer_load_dwordx4 v10, s[8:11], s83 offen lds
    ds_read_b64_tr_b16 a[154:155], v32 offset:2560
    ds_read_b64_tr_b16 a[156:157], v35 offset:2048
    ds_read_b64_tr_b16 a[158:159], v35 offset:2560
    ds_read_b64_tr_b16 a[160:161], v32 offset:4096
    ds_read_b64_tr_b16 a[162:163], v32 offset:4608
    ds_read_b64_tr_b16 a[164:165], v35 offset:4096
    ds_read_b64_tr_b16 a[166:167], v35 offset:4608
    ds_read_b64_tr_b16 a[168:169], v32 offset:6144
    buffer_load_dwordx4 v11, s[8:11], s83 offen offset:1024 lds
    ds_read_b64_tr_b16 a[170:171], v32 offset:6656
    ds_read_b64_tr_b16 a[172:173], v35 offset:6144
    ds_read_b64_tr_b16 a[174:175], v35 offset:6656
    v_add_f32 v69, v69, v73
    v_lshlrev_b32 v77, 16, v129
    v_and_b32 v78, 0xffff0000, v129
    v_lshlrev_b32 v79, 16, v165
    v_and_b32 v80, 0xffff0000, v165
    s_add_u32 m0, s51, 0x10000
    s_add_u32 s84, s93, s87
    buffer_load_dwordx4 v8, s[8:11], s84 offen lds
    s_waitcnt lgkmcnt(14)
    v_mfma_f32_32x32x16_bf16 v[96:111], a[144:147], a[48:51], v[96:111]
    ds_read_b64_tr_b16 a[144:145], v32 offset:8192
    ds_read_b64_tr_b16 a[146:147], v32 offset:8704
    v_bfi_b32 v8, s98, v224, v225
    v_mul_f32 v77, v77, v79
    v_mul_f32 v78, v78, v80
    v_cvt_pk_bf16_f32 v81, v77, v78
L_pad23:
    s_cbranch_execz L_wret
    s_waitcnt lgkmcnt(13)
    v_mfma_f32_32x32x16_bf16 v[112:127], a[148:151], a[48:51], v[112:127]
    buffer_load_dwordx4 v9, s[8:11], s84 offen offset:1024 lds
    ds_read_b64_tr_b16 a[148:149], v35 offset:8192
    ds_read_b64_tr_b16 a[150:151], v35 offset:8704
    v_bfi_b32 v9, s98, v226, v227
    s_waitcnt lgkmcnt(7)
    v_mfma_f32_32x32x16_bf16 v[96:111], a[152:155], a[52:55], v[96:111]
    ds_read_b64_tr_b16 a[152:153], v32 offset:10240
    ds_read_b64_tr_b16 a[154:155], v32 offset:10752
    v_lshlrev_b32 v77, 16, v81
    v_and_b32 v78, 0xffff0000, v81
    v_add_f32 v68, v68, v77
    v_add_f32 v69, v69, v78
    v_mfma_f32_32x32x16_bf16 v[112:127], a[156:159], a[52:55], v[112:127]
    s_add_u32 m0, s51, 0x16000
    s_add_u32 s83, s93, s87
    buffer_load_dwordx4 v10, s[8:11], s83 offen lds
    ds_read_b64_tr_b16 a[156:157], v35 offset:10240
    v_mfma_f32_32x32x16_bf16 v[96:111], a[160:163], a[56:59], v[96:111]
    ds_read_b64_tr_b16 a[158:159], v35 offset:10752
    ds_read_b64_tr_b16 a[160:161], v32 offset:12288
    ds_read_b64_tr_b16 a[162:163], v32 offset:12800
    v_bfi_b32 v10, s98, v228, v229
    v_lshlrev_b32 v82, 16, v130
    v_and_b32 v83, 0xffff0000, v130
    v_mfma_f32_32x32x16_bf16 v[112:127], a[164:167], a[56:59], v[112:127]
    buffer_load_dwordx4 v11, s[8:11], s83 offen offset:1024 lds
    ds_read_b64_tr_b16 a[164:165], v35 offset:12288
    ds_read_b64_tr_b16 a[166:167], v35 offset:12800
    v_bfi_b32 v11, s98, v230, v231
    s_waitcnt lgkmcnt(8)
    v_mfma_f32_32x32x16_bf16 v[96:111], a[168:171], a[60:63], v[96:111]
    ds_read_b64_tr_b16 a[168:169], v32 offset:14336
    ds_read_b64_tr_b16 a[170:171], v32 offset:14848
    v_lshlrev_b32 v84, 16, v166
    v_and_b32 v85, 0xffff0000, v166
    v_mul_f32 v82, v82, v84
    v_mul_f32 v83, v83, v85
    v_mfma_f32_32x32x16_bf16 v[112:127], a[172:175], a[60:63], v[112:127]
    s_add_u32 m0, s51, 0x1e000
    s_mul_i32 s84, s91, 0x6c0
    s_add_u32 s84, s84, s71
    buffer_load_dwordx4 v16, s[12:15], s84 offen lds
    v_mfma_f32_32x32x16_bf16 v[96:111], a[144:147], a[64:67], v[96:111]
    ds_read_b64_tr_b16 a[172:173], v35 offset:14336
    ds_read_b64_tr_b16 a[174:175], v35 offset:14848
    ds_read_b64_tr_b16 a[144:145], v32 offset:16384
    ds_read_b64_tr_b16 a[146:147], v32 offset:16896
    v_cvt_pk_bf16_f32 v86, v82, v83
    v_lshlrev_b32 v82, 16, v86
    v_mfma_f32_32x32x16_bf16 v[112:127], a[148:151], a[64:67], v[112:127]
    buffer_load_dwordx4 v17, s[12:15], s84 offen offset:1024 lds
    ds_read_b64_tr_b16 a[148:149], v35 offset:16384
    ds_read_b64_tr_b16 a[150:151], v35 offset:16896
    v_and_b32 v83, 0xffff0000, v86
    s_waitcnt lgkmcnt(8)
    v_mfma_f32_32x32x16_bf16 v[96:111], a[152:155], a[68:71], v[96:111]
    ds_read_b64_tr_b16 a[152:153], v32 offset:18432
    ds_read_b64_tr_b16 a[154:155], v32 offset:18944
    v_add_f32 v68, v68, v82
    v_add_f32 v69, v69, v83
    v_lshlrev_b32 v87, 16, v131
    v_and_b32 v88, 0xffff0000, v131
    v_mfma_f32_32x32x16_bf16 v[112:127], a[156:159], a[68:71], v[112:127]
    s_add_u32 m0, s51, 0x20000
    s_mul_i32 s83, s92, 0x6c0
    s_add_u32 s83, s83, s71
    buffer_load_dwordx4 v16, s[12:15], s83 offen lds
    v_mfma_f32_32x32x16_bf16 v[96:111], a[160:163], a[72:75], v[96:111]
    ds_read_b64_tr_b16 a[156:157], v35 offset:18432
    ds_read_b64_tr_b16 a[158:159], v35 offset:18944
    s_nop 0
L_pad24:
    s_cbranch_execz L_wret
    ds_read_b64_tr_b16 a[160:161], v32 offset:20480
    ds_read_b64_tr_b16 a[162:163], v32 offset:20992
    s_waitcnt vmcnt(11)
    ds_read_b128 a[96:99], v12 offset:0
    v_mfma_f32_32x32x16_bf16 v[112:127], a[164:167], a[72:75], v[112:127]
    buffer_load_dwordx4 v17, s[12:15], s83 offen offset:1024 lds
    ds_read_b64_tr_b16 a[164:165], v35 offset:20480
    ds_read_b64_tr_b16 a[166:167], v35 offset:20992
    ds_read_b128 a[100:103], v13 offset:0
    s_waitcnt lgkmcnt(10)
    v_mfma_f32_32x32x16_bf16 v[96:111], a[168:171], a[76:79], v[96:111]
    ds_read_b64_tr_b16 a[168:169], v32 offset:22528
    ds_read_b64_tr_b16 a[170:171], v32 offset:23040
    ds_read_b128 a[104:107], v14 offset:0
    ds_read_b128 a[108:111], v15 offset:0
    ds_read_b128 v[152:155], v66 offset:0
    s_mov_b32 s92, -1
    v_mfma_f32_32x32x16_bf16 v[112:127], a[172:175], a[76:79], v[112:127]
    s_add_u32 m0, s51, 0x22000
    s_mul_i32 s84, s93, 0x6c0
    s_add_u32 s84, s84, s71
    buffer_load_dwordx4 v16, s[12:15], s84 offen lds
    v_mfma_f32_32x32x16_bf16 v[96:111], a[144:147], a[80:83], v[96:111]
    ds_read_b64_tr_b16 a[172:173], v35 offset:22528
    ds_read_b64_tr_b16 a[174:175], v35 offset:23040
    s_waitcnt vmcnt(9)
    ds_read_b128 a[112:115], v12 offset:8192
    ds_read_b128 a[116:119], v13 offset:8192
    ds_read_b128 a[120:123], v14 offset:8192
    v_mfma_f32_32x32x16_bf16 v[112:127], a[148:151], a[80:83], v[112:127]
    buffer_load_dwordx4 v17, s[12:15], s84 offen offset:1024 lds
    ds_read_b128 a[124:127], v15 offset:8192
    ds_read_b128 v[156:159], v66 offset:8192
    s_mov_b32 s93, 0
    s_waitcnt lgkmcnt(13)
    v_mfma_f32_32x32x16_bf16 v[96:111], a[152:155], a[84:87], v[96:111]
    s_cmp_eq_u32 s50, 1
    s_cselect_b32 s5, s76, s5
    s_cselect_b32 s77, 18, 16
    s_cselect_b64 s[8:9], s[24:25], s[20:21]
    s_cselect_b32 s10, s26, s22
    s_add_u32 s70, s5, s77
    v_mfma_f32_32x32x16_bf16 v[112:127], a[156:159], a[84:87], v[112:127]
    s_add_u32 m0, s51, 0
    s_add_u32 s83, s56, s65
    buffer_load_dwordx4 v18, s[16:19], s83 offen lds
    s_lshr_b32 s76, s50, 1
    v_mfma_f32_32x32x16_bf16 v[96:111], a[160:163], a[88:91], v[96:111]
    s_waitcnt vmcnt(7)
    ds_read_b128 a[128:131], v12 offset:16384
    ds_read_b128 a[132:135], v13 offset:16384
    ds_read_b128 a[136:139], v14 offset:16384
    ds_read_b128 a[140:143], v15 offset:16384
    ds_read_b128 v[160:163], v66 offset:16384
    v_mfma_f32_32x32x16_bf16 v[112:127], a[164:167], a[88:91], v[112:127]
    buffer_load_dwordx4 v19, s[16:19], s83 offen offset:1024 lds
    v_bfi_b32 v12, s98, v232, v233
    v_bfi_b32 v13, s98, v234, v235
    v_bfi_b32 v14, s98, v236, v237
    s_waitcnt lgkmcnt(5)
    v_mfma_f32_32x32x16_bf16 v[96:111], a[168:171], a[92:95], v[96:111]
    v_bfi_b32 v15, s98, v238, v239
    s_add_u32 s76, s76, 1
    s_add_u32 s76, s76, s48
    s_and_b32 s76, s76, 3
    s_lshl_b32 s76, s76, 6
    s_and_b32 s77, s50, 1
    v_mfma_f32_32x32x16_bf16 v[112:127], a[172:175], a[92:95], v[112:127]
    s_add_u32 m0, s51, 0x6000
    s_add_u32 s84, s59, s65
    buffer_load_dwordx4 v18, s[16:19], s84 offen lds
    s_lshl_b32 s77, s77, 5
    s_add_u32 s76, s76, s77
    s_add_u32 s6, s76, s80
    s_mov_b32 s76, 3
    s_add_u32 s76, s76, s48
    s_and_b32 s76, s76, 3
    s_lshl_b32 s76, s76, 6
    s_and_b32 s77, s50, 1
    s_nop 0
L_pad25:
    s_cbranch_execz L_wret
    buffer_load_dwordx4 v19, s[16:19], s84 offen offset:1024 lds
    s_lshl_b32 s77, s77, 5
    s_add_u32 s76, s76, s77
    s_add_u32 s7, s76, s80
    s_cmp_eq_u32 s50, 2
    s_cselect_b32 s7, s81, s7
    s_mul_i32 s76, s82, 36
    s_cmp_eq_u32 s50, 3
    s_cselect_b32 s7, s76, s7
    s_cselect_b32 s77, 18, 16
    s_cselect_b64 s[12:13], s[24:25], s[20:21]
    s_cselect_b32 s14, s26, s22
    s_add_u32 m0, s51, 0x2000
    s_add_u32 s83, s57, s65
    buffer_load_dwordx4 v18, s[16:19], s83 offen lds
    s_add_u32 s71, s7, s77
    s_mul_i32 s5, s5, 0x480
    s_mul_i32 s6, s6, 0x480
    s_mul_i32 s7, s7, 0x480
    s_mul_i32 s70, s70, 0x480
    s_mul_i32 s71, s71, 0x480
    s_and_b32 s76, s49, 1
    s_mul_i32 s76, s76, 0x240
    buffer_load_dwordx4 v19, s[16:19], s83 offen offset:1024 lds
    s_mul_i32 s77, s48, 11
    s_lshr_b32 s77, s77, 5
    s_mul_i32 s77, s77, 3
    s_sub_u32 s77, s48, s77
    s_mul_i32 s97, s77, 0xc0
    s_mov_b32 s78, s97
    s_add_u32 s87, s78, s76
    s_add_u32 s78, s78, 0xc0
    s_add_u32 m0, s51, 0x8000
    s_add_u32 s84, s60, s65
    buffer_load_dwordx4 v18, s[16:19], s84 offen lds
    s_cmp_ge_u32 s78, 0x240
    s_cselect_b32 s78, 0, s78
    s_add_u32 s88, s78, s76
    s_add_u32 s78, s78, 0xc0
    s_cmp_ge_u32 s78, 0x240
    s_cselect_b32 s78, 0, s78
    s_add_u32 s73, s78, s76
    s_lshr_b32 s77, s50, 1
    buffer_load_dwordx4 v19, s[16:19], s84 offen offset:1024 lds
    s_xor_b32 s77, s77, s49
    s_mul_i32 s77, s77, 36
    s_and_b32 s78, s50, 1
    s_mul_i32 s78, s78, 18
    s_add_u32 s77, s77, s78
    s_add_u32 s77, s77, 16
    s_mul_i32 s77, s77, 0x480
    s_add_u32 s55, s77, s76
    s_add_u32 m0, s51, 0x4000
    s_add_u32 s83, s58, s65
    buffer_load_dwordx4 v18, s[16:19], s83 offen lds
    v_lshlrev_b32 v89, 16, v167
    v_and_b32 v90, 0xffff0000, v167
    v_mul_f32 v87, v87, v89
    v_mul_f32 v88, v88, v90
    v_cvt_pk_bf16_f32 v91, v87, v88
    v_lshlrev_b32 v87, 16, v91
    v_and_b32 v88, 0xffff0000, v91
    v_add_f32 v68, v68, v87
    buffer_load_dwordx4 v19, s[16:19], s83 offen offset:1024 lds
    v_add_f32 v69, v69, v88
    v_lshlrev_b32 v72, 16, v132
    v_and_b32 v73, 0xffff0000, v132
    v_lshlrev_b32 v74, 16, v168
    v_and_b32 v75, 0xffff0000, v168
    v_mul_f32 v72, v72, v74
    v_mul_f32 v73, v73, v75
    v_cvt_pk_bf16_f32 v76, v72, v73
    s_add_u32 m0, s51, 0xa000
    s_add_u32 s84, s61, s65
    buffer_load_dwordx4 v18, s[16:19], s84 offen lds
    v_lshlrev_b32 v72, 16, v76
    v_and_b32 v73, 0xffff0000, v76
    v_add_f32 v68, v68, v72
    v_add_f32 v69, v69, v73
    v_lshlrev_b32 v77, 16, v133
    v_and_b32 v78, 0xffff0000, v133
    v_lshlrev_b32 v79, 16, v169
    v_and_b32 v80, 0xffff0000, v169
    buffer_load_dwordx4 v19, s[16:19], s84 offen offset:1024 lds
    v_mul_f32 v77, v77, v79
    v_mul_f32 v78, v78, v80
    v_cvt_pk_bf16_f32 v81, v77, v78
    v_lshlrev_b32 v77, 16, v81
    v_and_b32 v78, 0xffff0000, v81
    v_add_f32 v68, v68, v77
    v_add_f32 v69, v69, v78
L_pad26:
    s_cbranch_execz L_wret
    v_lshlrev_b32 v82, 16, v134
    s_add_u32 m0, s51, 0xc000
    s_add_u32 s83, s62, s65
    buffer_load_dwordx4 v18, s[16:19], s83 offen lds
    v_and_b32 v83, 0xffff0000, v134
    v_lshlrev_b32 v84, 16, v170
    v_and_b32 v85, 0xffff0000, v170
    v_mul_f32 v82, v82, v84
    v_mul_f32 v83, v83, v85
    v_cvt_pk_bf16_f32 v86, v82, v83
    v_lshlrev_b32 v82, 16, v86
    v_and_b32 v83, 0xffff0000, v86
    buffer_load_dwordx4 v19, s[16:19], s83 offen offset:1024 lds
    v_add_f32 v68, v68, v82
    v_add_f32 v69, v69, v83
    v_lshlrev_b32 v87, 16, v135
    v_and_b32 v88, 0xffff0000, v135
    v_lshlrev_b32 v89, 16, v171
    v_and_b32 v90, 0xffff0000, v171
    v_mul_f32 v87, v87, v89
    v_mul_f32 v88, v88, v90
    s_add_u32 m0, s51, 0xe000
    s_add_u32 s84, s63, s65
    buffer_load_dwordx4 v18, s[16:19], s84 offen lds
    v_cvt_pk_bf16_f32 v91, v87, v88
    v_lshlrev_b32 v87, 16, v91
    v_and_b32 v88, 0xffff0000, v91
    v_add_f32 v68, v68, v87
    v_add_f32 v69, v69, v88
    v_lshlrev_b32 v72, 16, v136
    v_and_b32 v73, 0xffff0000, v136
    v_lshlrev_b32 v74, 16, v172
    buffer_load_dwordx4 v19, s[16:19], s84 offen offset:1024 lds
    v_and_b32 v75, 0xffff0000, v172
    v_mul_f32 v72, v72, v74
    v_mul_f32 v73, v73, v75
    v_cvt_pk_bf16_f32 v76, v72, v73
    v_lshlrev_b32 v72, 16, v76
    v_and_b32 v73, 0xffff0000, v76
    v_add_f32 v68, v68, v72
    v_add_f32 v69, v69, v73
    s_waitcnt lgkmcnt(0)
    s_add_u32 m0, s51, 0x10000
    s_add_u32 s83, s64, s65
    buffer_load_dwordx4 v18, s[16:19], s83 offen lds
    v_lshlrev_b32 v77, 16, v137
    v_and_b32 v78, 0xffff0000, v137
    v_lshlrev_b32 v79, 16, v173
    v_and_b32 v80, 0xffff0000, v173
    v_mul_f32 v77, v77, v79
    v_mul_f32 v78, v78, v80
    v_cvt_pk_bf16_f32 v81, v77, v78
    v_lshlrev_b32 v77, 16, v81
    buffer_load_dwordx4 v19, s[16:19], s83 offen offset:1024 lds
    v_and_b32 v78, 0xffff0000, v81
    v_add_f32 v68, v68, v77
    v_add_f32 v69, v69, v78
    v_lshlrev_b32 v82, 16, v138
    v_and_b32 v83, 0xffff0000, v138
    v_lshlrev_b32 v84, 16, v174
    v_and_b32 v85, 0xffff0000, v174
    v_mul_f32 v82, v82, v84
    s_add_u32 m0, s51, 0x12000
    s_add_u32 s84, s56, s66
    buffer_load_dwordx4 v18, s[16:19], s84 offen lds
    v_mul_f32 v83, v83, v85
    v_cvt_pk_bf16_f32 v86, v82, v83
    v_lshlrev_b32 v82, 16, v86
    v_and_b32 v83, 0xffff0000, v86
    v_add_f32 v68, v68, v82
    v_add_f32 v69, v69, v83
    v_lshlrev_b32 v87, 16, v139
    v_and_b32 v88, 0xffff0000, v139
    buffer_load_dwordx4 v19, s[16:19], s84 offen offset:1024 lds
    v_lshlrev_b32 v89, 16, v175
    v_and_b32 v90, 0xffff0000, v175
    v_mul_f32 v87, v87, v89
    v_mul_f32 v88, v88, v90
    v_cvt_pk_bf16_f32 v91, v87, v88
    v_lshlrev_b32 v87, 16, v91
    v_and_b32 v88, 0xffff0000, v91
    v_add_f32 v68, v68, v87
    s_add_u32 m0, s51, 0x14000
    s_add_u32 s83, s57, s66
    buffer_load_dwordx4 v18, s[16:19], s83 offen lds
    v_add_f32 v69, v69, v88
    v_lshlrev_b32 v72, 16, v140
    v_and_b32 v73, 0xffff0000, v140
L_pad27:
    s_cbranch_execz L_wret
    v_lshlrev_b32 v74, 16, v176
    v_and_b32 v75, 0xffff0000, v176
    v_mul_f32 v72, v72, v74
    v_mul_f32 v73, v73, v75
    v_cvt_pk_bf16_f32 v76, v72, v73
    buffer_load_dwordx4 v19, s[16:19], s83 offen offset:1024 lds
    v_lshlrev_b32 v72, 16, v76
    v_and_b32 v73, 0xffff0000, v76
    v_add_f32 v68, v68, v72
    v_add_f32 v69, v69, v73
    v_lshlrev_b32 v77, 16, v141
    v_and_b32 v78, 0xffff0000, v141
    v_lshlrev_b32 v79, 16, v177
    v_and_b32 v80, 0xffff0000, v177
    s_add_u32 m0, s51, 0x16000
    s_add_u32 s84, s58, s66
    buffer_load_dwordx4 v18, s[16:19], s84 offen lds
    v_mul_f32 v77, v77, v79
    v_mul_f32 v78, v78, v80
    v_cvt_pk_bf16_f32 v81, v77, v78
    v_lshlrev_b32 v77, 16, v81
    v_and_b32 v78, 0xffff0000, v81
    v_add_f32 v68, v68, v77
    v_add_f32 v69, v69, v78
    v_lshlrev_b32 v82, 16, v142
    buffer_load_dwordx4 v19, s[16:19], s84 offen offset:1024 lds
    v_and_b32 v83, 0xffff0000, v142
    v_lshlrev_b32 v84, 16, v178
    v_and_b32 v85, 0xffff0000, v178
    v_mul_f32 v82, v82, v84
    v_mul_f32 v83, v83, v85
    v_cvt_pk_bf16_f32 v86, v82, v83
    v_lshlrev_b32 v82, 16, v86
    v_and_b32 v83, 0xffff0000, v86
    v_add_f32 v68, v68, v82
    v_add_f32 v69, v69, v83
    v_lshlrev_b32 v87, 16, v143
    v_and_b32 v88, 0xffff0000, v143
    v_lshlrev_b32 v89, 16, v179
    v_and_b32 v90, 0xffff0000, v179
    v_mul_f32 v87, v87, v89
    v_mul_f32 v88, v88, v90
    v_cvt_pk_bf16_f32 v91, v87, v88
    v_lshlrev_b32 v87, 16, v91
    v_and_b32 v88, 0xffff0000, v91
    v_add_f32 v68, v68, v87
    v_add_f32 v69, v69, v88
    v_lshlrev_b32 v72, 16, v144
    v_and_b32 v73, 0xffff0000, v144
    v_lshlrev_b32 v74, 16, v180
    v_and_b32 v75, 0xffff0000, v180
    v_mul_f32 v72, v72, v74
    v_mul_f32 v73, v73, v75
    v_cvt_pk_bf16_f32 v76, v72, v73
    v_lshlrev_b32 v72, 16, v76
    v_and_b32 v73, 0xffff0000, v76
    v_add_f32 v68, v68, v72
    v_add_f32 v69, v69, v73
    v_lshlrev_b32 v77, 16, v145
    v_and_b32 v78, 0xffff0000, v145
    v_lshlrev_b32 v79, 16, v181
    v_and_b32 v80, 0xffff0000, v181
    v_mul_f32 v77, v77, v79
    v_mul_f32 v78, v78, v80
    v_cvt_pk_bf16_f32 v81, v77, v78
    v_lshlrev_b32 v77, 16, v81
    v_and_b32 v78, 0xffff0000, v81
    v_add_f32 v68, v68, v77
    v_add_f32 v69, v69, v78
    v_lshlrev_b32 v82, 16, v146
    v_and_b32 v83, 0xffff0000, v146
    v_lshlrev_b32 v84, 16, v182
    v_and_b32 v85, 0xffff0000, v182
    v_mul_f32 v82, v82, v84
    v_mul_f32 v83, v83, v85
    v_cvt_pk_bf16_f32 v86, v82, v83
    v_lshlrev_b32 v82, 16, v86
    v_and_b32 v83, 0xffff0000, v86
    v_add_f32 v68, v68, v82
    v_add_f32 v69, v69, v83
    v_lshlrev_b32 v87, 16, v147
    v_and_b32 v88, 0xffff0000, v147
    v_lshlrev_b32 v89, 16, v183
    v_and_b32 v90, 0xffff0000, v183
    v_mul_f32 v87, v87, v89
    v_mul_f32 v88, v88, v90
    v_cvt_pk_bf16_f32 v91, v87, v88
    v_lshlrev_b32 v87, 16, v91
    v_and_b32 v88, 0xffff0000, v91
    v_add_f32 v68, v68, v87
    v_add_f32 v69, v69, v88
    v_lshlrev_b32 v72, 16, v148
L_pad28:
    s_cbranch_execz L_wret
    v_and_b32 v73, 0xffff0000, v148
    v_lshlrev_b32 v74, 16, v184
    v_and_b32 v75, 0xffff0000, v184
    v_mul_f32 v72, v72, v74
    v_mul_f32 v73, v73, v75
    v_cvt_pk_bf16_f32 v76, v72, v73
    v_lshlrev_b32 v72, 16, v76
    v_and_b32 v73, 0xffff0000, v76
    v_add_f32 v68, v68, v72
    v_add_f32 v69, v69, v73
    v_lshlrev_b32 v77, 16, v149
    v_and_b32 v78, 0xffff0000, v149
    v_lshlrev_b32 v79, 16, v185
    v_and_b32 v80, 0xffff0000, v185
    v_mul_f32 v77, v77, v79
    v_mul_f32 v78, v78, v80
    v_cvt_pk_bf16_f32 v81, v77, v78
    v_lshlrev_b32 v77, 16, v81
    v_and_b32 v78, 0xffff0000, v81
    v_add_f32 v68, v68, v77
    v_add_f32 v69, v69, v78
    v_lshlrev_b32 v82, 16, v150
    v_and_b32 v83, 0xffff0000, v150
    v_lshlrev_b32 v84, 16, v186
    v_and_b32 v85, 0xffff0000, v186
    v_mul_f32 v82, v82, v84
    v_mul_f32 v83, v83, v85
    v_cvt_pk_bf16_f32 v86, v82, v83
    v_lshlrev_b32 v82, 16, v86
    v_and_b32 v83, 0xffff0000, v86
    v_add_f32 v68, v68, v82
    v_add_f32 v69, v69, v83
    v_lshlrev_b32 v87, 16, v151
    v_and_b32 v88, 0xffff0000, v151
    v_lshlrev_b32 v89, 16, v187
    v_and_b32 v90, 0xffff0000, v187
    v_mul_f32 v87, v87, v89
    v_mul_f32 v88, v88, v90
    v_cvt_pk_bf16_f32 v91, v87, v88
    v_lshlrev_b32 v87, 16, v91
    v_and_b32 v88, 0xffff0000, v91
    v_add_f32 v68, v68, v87
    v_add_f32 v69, v69, v88
    v_lshlrev_b32 v72, 16, v152
    v_and_b32 v73, 0xffff0000, v152
    v_lshlrev_b32 v74, 16, v188
    v_and_b32 v75, 0xffff0000, v188
    v_mul_f32 v72, v72, v74
    v_mul_f32 v73, v73, v75
    v_cvt_pk_bf16_f32 v76, v72, v73
    v_lshlrev_b32 v72, 16, v76
    v_and_b32 v73, 0xffff0000, v76
    v_add_f32 v68, v68, v72
    v_add_f32 v69, v69, v73
    v_lshlrev_b32 v77, 16, v153
    v_and_b32 v78, 0xffff0000, v153
    v_lshlrev_b32 v79, 16, v189
    v_and_b32 v80, 0xffff0000, v189
    v_mul_f32 v77, v77, v79
    v_mul_f32 v78, v78, v80
    v_cvt_pk_bf16_f32 v81, v77, v78
    v_lshlrev_b32 v77, 16, v81
    v_and_b32 v78, 0xffff0000, v81
    v_add_f32 v68, v68, v77
    v_add_f32 v69, v69, v78
    v_lshlrev_b32 v82, 16, v154
    v_and_b32 v83, 0xffff0000, v154
    v_lshlrev_b32 v84, 16, v190
    v_and_b32 v85, 0xffff0000, v190
    v_mul_f32 v82, v82, v84
    v_mul_f32 v83, v83, v85
    v_cvt_pk_bf16_f32 v86, v82, v83
    v_lshlrev_b32 v82, 16, v86
    v_and_b32 v83, 0xffff0000, v86
    v_add_f32 v68, v68, v82
    v_add_f32 v69, v69, v83
    v_lshlrev_b32 v87, 16, v155
    v_and_b32 v88, 0xffff0000, v155
    v_lshlrev_b32 v89, 16, v191
    v_and_b32 v90, 0xffff0000, v191
    v_mul_f32 v87, v87, v89
    v_mul_f32 v88, v88, v90
    v_cvt_pk_bf16_f32 v91, v87, v88
    v_lshlrev_b32 v87, 16, v91
    v_and_b32 v88, 0xffff0000, v91
    v_add_f32 v68, v68, v87
    v_add_f32 v69, v69, v88
    v_lshlrev_b32 v72, 16, v156
    v_and_b32 v73, 0xffff0000, v156
    v_lshlrev_b32 v74, 16, v192
    v_and_b32 v75, 0xffff0000, v192
    v_mul_f32 v72, v72, v74
    v_mul_f32 v73, v73, v75
L_pad29:
    s_cbranch_execz L_wret
    v_cvt_pk_bf16_f32 v76, v72, v73
    v_lshlrev_b32 v72, 16, v76
    v_and_b32 v73, 0xffff0000, v76
    v_add_f32 v68, v68, v72
    v_add_f32 v69, v69, v73
    v_lshlrev_b32 v77, 16, v157
    v_and_b32 v78, 0xffff0000, v157
    v_lshlrev_b32 v79, 16, v193
    v_and_b32 v80, 0xffff0000, v193
    v_mul_f32 v77, v77, v79
    v_mul_f32 v78, v78, v80
    v_cvt_pk_bf16_f32 v81, v77, v78
    v_lshlrev_b32 v77, 16, v81
    v_and_b32 v78, 0xffff0000, v81
    v_add_f32 v68, v68, v77
    v_add_f32 v69, v69, v78
    v_lshlrev_b32 v82, 16, v158
    v_and_b32 v83, 0xffff0000, v158
    v_lshlrev_b32 v84, 16, v194
    v_and_b32 v85, 0xffff0000, v194
    v_mul_f32 v82, v82, v84
    v_mul_f32 v83, v83, v85
    v_cvt_pk_bf16_f32 v86, v82, v83
    v_lshlrev_b32 v82, 16, v86
    v_and_b32 v83, 0xffff0000, v86
    v_add_f32 v68, v68, v82
    v_add_f32 v69, v69, v83
    v_lshlrev_b32 v87, 16, v159
    v_and_b32 v88, 0xffff0000, v159
    v_lshlrev_b32 v89, 16, v195
    v_and_b32 v90, 0xffff0000, v195
    v_mul_f32 v87, v87, v89
    v_mul_f32 v88, v88, v90
    v_cvt_pk_bf16_f32 v91, v87, v88
    v_lshlrev_b32 v87, 16, v91
    v_and_b32 v88, 0xffff0000, v91
    v_add_f32 v68, v68, v87
    v_add_f32 v69, v69, v88
    v_lshlrev_b32 v72, 16, v160
    v_and_b32 v73, 0xffff0000, v160
    v_lshlrev_b32 v74, 16, v196
    v_and_b32 v75, 0xffff0000, v196
    v_mul_f32 v72, v72, v74
    v_mul_f32 v73, v73, v75
    v_cvt_pk_bf16_f32 v76, v72, v73
    v_lshlrev_b32 v72, 16, v76
    v_and_b32 v73, 0xffff0000, v76
    v_add_f32 v68, v68, v72
    v_add_f32 v69, v69, v73
    v_lshlrev_b32 v77, 16, v161
    v_and_b32 v78, 0xffff0000, v161
    v_lshlrev_b32 v79, 16, v197
    v_and_b32 v80, 0xffff0000, v197
    v_mul_f32 v77, v77, v79
    v_mul_f32 v78, v78, v80
    v_cvt_pk_bf16_f32 v81, v77, v78
    v_lshlrev_b32 v77, 16, v81
    v_and_b32 v78, 0xffff0000, v81
    v_add_f32 v68, v68, v77
    v_add_f32 v69, v69, v78
    v_lshlrev_b32 v82, 16, v162
    v_and_b32 v83, 0xffff0000, v162
    v_lshlrev_b32 v84, 16, v198
    v_and_b32 v85, 0xffff0000, v198
    v_mul_f32 v82, v82, v84
    v_mul_f32 v83, v83, v85
    v_cvt_pk_bf16_f32 v86, v82, v83
    v_lshlrev_b32 v82, 16, v86
    v_and_b32 v83, 0xffff0000, v86
    v_add_f32 v68, v68, v82
    v_add_f32 v69, v69, v83
    v_lshlrev_b32 v87, 16, v163
    v_and_b32 v88, 0xffff0000, v163
    v_lshlrev_b32 v89, 16, v199
    v_and_b32 v90, 0xffff0000, v199
    v_mul_f32 v87, v87, v89
    v_mul_f32 v88, v88, v90
    v_cvt_pk_bf16_f32 v91, v87, v88
    v_lshlrev_b32 v87, 16, v91
    v_and_b32 v88, 0xffff0000, v91
    v_add_f32 v68, v68, v87
    v_add_f32 v69, v69, v88
    v_add_f32 v68, v68, v69
    v_lshlrev_b32 v64, 3, v64
    s_lshl_b32 s79, s48, 10
    v_add_f32 v69, v68, v68 quad_perm:[1,0,3,2] row_mask:0xf bank_mask:0xf
    s_add_u32 s79, s79, 0x840000
    s_cmp_eq_u32 s49, 15
    s_cselect_b32 s79, 0x40000000, s79
    v_add_f32 v68, v69, v69 quad_perm:[2,3,0,1] row_mask:0xf bank_mask:0xf
    s_nop 1
    v_add_f32 v69, v68, v68 row_half_mirror row_mask:0xf bank_mask:0xf
    s_nop 0
L_pad30:
    s_cbranch_execz L_wret
    v_cvt_pk_bf16_f32 v69, v69, v69
    v_lshlrev_b32 v69, 16, v69
    v_mul_f32 v70, s86, v69
    v_exp_f32 v70, v70
    s_nop 0
    v_add_f32 v70, 1.0, v70
    v_rcp_f32 v70, v70
    s_nop 0
    v_cvt_pk_bf16_f32 v70, v70, v70
    v_lshlrev_b32 v71, 16, v70
    v_sub_f32 v70, 1.0, v71
    v_cvt_pk_bf16_f32 v70, v70, v70
    v_lshlrev_b32 v70, 16, v70
    v_max_f32 v73, 0xd800000, v70
    v_rcp_f32 v70, v73
    s_nop 0
    v_mul_f32 v72, v71, v70
    s_waitcnt vmcnt(24)
    s_barrier
    ds_read_b64_tr_b16 a[144:145], v32 offset:24576
    ds_read_b64_tr_b16 a[146:147], v32 offset:25088
    ds_read_b64_tr_b16 a[148:149], v35 offset:24576
    ds_read_b64_tr_b16 a[150:151], v35 offset:25088
    ds_read_b64_tr_b16 a[152:153], v32 offset:26624
    ds_read_b64_tr_b16 a[154:155], v32 offset:27136
    ds_read_b64_tr_b16 a[156:157], v35 offset:26624
    ds_read_b64_tr_b16 a[158:159], v35 offset:27136
    ds_read_b64_tr_b16 a[160:161], v32 offset:28672
    ds_read_b64_tr_b16 a[162:163], v32 offset:29184
    ds_read_b64_tr_b16 a[164:165], v35 offset:28672
    ds_read_b64_tr_b16 a[166:167], v35 offset:29184
    ds_read_b64_tr_b16 a[168:169], v32 offset:30720
    ds_read_b64_tr_b16 a[170:171], v32 offset:31232
    ds_read_b64_tr_b16 a[172:173], v35 offset:30720
    ds_read_b64_tr_b16 a[174:175], v35 offset:31232
    v_and_b32 v70, 7, v60
    v_cmp_eq_u32 vcc, 0, v70
    v_mov_b32 v70, 0x7ffffff0
    s_nop 0
    v_cndmask_b32 v64, v70, v64, vcc
    buffer_store_dwordx2 v[72:73], v64, s[28:31], s79 offen sc1
    s_waitcnt lgkmcnt(14)
    v_mfma_f32_32x32x16_bf16 v[96:111], a[144:147], a[96:99], v[96:111]
    ds_read_b64_tr_b16 a[144:145], v32 offset:32768
    ds_read_b64_tr_b16 a[146:147], v32 offset:33280
    s_waitcnt lgkmcnt(7)
    v_mfma_f32_32x32x16_bf16 v[112:127], a[148:151], a[96:99], v[112:127]
    ds_read_b64_tr_b16 a[148:149], v35 offset:32768
    ds_read_b64_tr_b16 a[150:151], v35 offset:33280
    v_mfma_f32_32x32x16_bf16 v[96:111], a[152:155], a[100:103], v[96:111]
    ds_read_b64_tr_b16 a[152:153], v32 offset:34816
    ds_read_b64_tr_b16 a[154:155], v32 offset:35328
    v_mfma_f32_32x32x16_bf16 v[112:127], a[156:159], a[100:103], v[112:127]
    ds_read_b64_tr_b16 a[156:157], v35 offset:34816
    ds_read_b64_tr_b16 a[158:159], v35 offset:35328
    v_mfma_f32_32x32x16_bf16 v[96:111], a[160:163], a[104:107], v[96:111]
    ds_read_b64_tr_b16 a[160:161], v32 offset:36864
    ds_read_b64_tr_b16 a[162:163], v32 offset:37376
    s_waitcnt lgkmcnt(8)
    v_mfma_f32_32x32x16_bf16 v[112:127], a[164:167], a[104:107], v[112:127]
    ds_read_b64_tr_b16 a[164:165], v35 offset:36864
    ds_read_b64_tr_b16 a[166:167], v35 offset:37376
    v_mfma_f32_32x32x16_bf16 v[96:111], a[168:171], a[108:111], v[96:111]
    ds_read_b64_tr_b16 a[168:169], v32 offset:38912
    ds_read_b64_tr_b16 a[170:171], v32 offset:39424
    v_mfma_f32_32x32x16_bf16 v[112:127], a[172:175], a[108:111], v[112:127]
    ds_read_b64_tr_b16 a[172:173], v35 offset:38912
    ds_read_b64_tr_b16 a[174:175], v35 offset:39424
    v_mfma_f32_32x32x16_bf16 v[96:111], a[144:147], a[112:115], v[96:111]
    ds_read_b64_tr_b16 a[144:145], v32 offset:40960
    ds_read_b64_tr_b16 a[146:147], v32 offset:41472
    s_waitcnt lgkmcnt(8)
    v_mfma_f32_32x32x16_bf16 v[112:127], a[148:151], a[112:115], v[112:127]
    ds_read_b64_tr_b16 a[148:149], v35 offset:40960
    ds_read_b64_tr_b16 a[150:151], v35 offset:41472
L_pad31:
    s_cbranch_execz L_wret
    v_mfma_f32_32x32x16_bf16 v[96:111], a[152:155], a[116:119], v[96:111]
    ds_read_b64_tr_b16 a[152:153], v32 offset:43008
    ds_read_b64_tr_b16 a[154:155], v32 offset:43520
    v_mfma_f32_32x32x16_bf16 v[112:127], a[156:159], a[116:119], v[112:127]
    ds_read_b64_tr_b16 a[156:157], v35 offset:43008
    ds_read_b64_tr_b16 a[158:159], v35 offset:43520
    v_mfma_f32_32x32x16_bf16 v[96:111], a[160:163], a[120:123], v[96:111]
    ds_read_b64_tr_b16 a[160:161], v32 offset:45056
    ds_read_b64_tr_b16 a[162:163], v32 offset:45568
    s_waitcnt lgkmcnt(8)
    v_mfma_f32_32x32x16_bf16 v[112:127], a[164:167], a[120:123], v[112:127]
    ds_read_b64_tr_b16 a[164:165], v35 offset:45056
    ds_read_b64_tr_b16 a[166:167], v35 offset:45568
    v_mfma_f32_32x32x16_bf16 v[96:111], a[168:171], a[124:127], v[96:111]
    ds_read_b64_tr_b16 a[168:169], v32 offset:47104
    ds_read_b64_tr_b16 a[170:171], v32 offset:47616
    v_mfma_f32_32x32x16_bf16 v[112:127], a[172:175], a[124:127], v[112:127]
    ds_read_b64_tr_b16 a[172:173], v35 offset:47104
    ds_read_b64_tr_b16 a[174:175], v35 offset:47616
    v_mfma_f32_32x32x16_bf16 v[96:111], a[144:147], a[128:131], v[96:111]
    s_waitcnt vmcnt(15)
    s_barrier
    ds_read_b64_tr_b16 a[144:145], v30 offset:0
    ds_read_b64_tr_b16 a[146:147], v30 offset:512
    s_waitcnt lgkmcnt(8)
    v_mfma_f32_32x32x16_bf16 v[112:127], a[148:151], a[128:131], v[112:127]
    ds_read_b64_tr_b16 a[148:149], v33 offset:0
    ds_read_b64_tr_b16 a[150:151], v33 offset:512
    v_mfma_f32_32x32x16_bf16 v[96:111], a[152:155], a[132:135], v[96:111]
    ds_read_b64_tr_b16 a[152:153], v30 offset:2048
    ds_read_b64_tr_b16 a[154:155], v30 offset:2560
    v_mfma_f32_32x32x16_bf16 v[112:127], a[156:159], a[132:135], v[112:127]
    ds_read_b64_tr_b16 a[156:157], v33 offset:2048
    ds_read_b64_tr_b16 a[158:159], v33 offset:2560
    v_mfma_f32_32x32x16_bf16 v[96:111], a[160:163], a[136:139], v[96:111]
    ds_read_b64_tr_b16 a[160:161], v30 offset:4096
    ds_read_b64_tr_b16 a[162:163], v30 offset:4608
    s_waitcnt lgkmcnt(8)
    v_mfma_f32_32x32x16_bf16 v[112:127], a[164:167], a[136:139], v[112:127]
    ds_read_b64_tr_b16 a[164:165], v33 offset:4096
    ds_read_b64_tr_b16 a[166:167], v33 offset:4608
    v_mfma_f32_32x32x16_bf16 v[96:111], a[168:171], a[140:143], v[96:111]
    v_mfma_f32_32x32x16_bf16 v[112:127], a[172:175], a[140:143], v[112:127]
    s_waitcnt lgkmcnt(0)
    s_nop 0
    s_nop 15
    s_branch L_join
L_var_v:
    s_lshl_b32 s71, s49, 7
    s_add_u32 s70, s71, 0x800
    s_add_u32 m0, s51, 0x18000
    s_mul_i32 s83, s3, 0x6c0
    s_add_u32 s83, s83, s70
    buffer_load_dwordx4 v16, s[12:15], s83 offen lds
    buffer_load_dwordx4 v17, s[12:15], s83 offen offset:1024 lds
    s_add_u32 m0, s51, 0xc000
    s_add_u32 s84, s3, s87
    buffer_load_dwordx4 v8, s[8:11], s84 offen lds
    buffer_load_dwordx4 v9, s[8:11], s84 offen offset:1024 lds
    s_add_u32 m0, s51, 0x12000
    s_add_u32 s83, s3, s87
    buffer_load_dwordx4 v10, s[8:11], s83 offen lds
    buffer_load_dwordx4 v11, s[8:11], s83 offen offset:1024 lds
    s_add_u32 m0, s51, 0x1a000
    s_mul_i32 s84, s4, 0x6c0
    s_add_u32 s84, s84, s70
    buffer_load_dwordx4 v16, s[12:15], s84 offen lds
    buffer_load_dwordx4 v17, s[12:15], s84 offen offset:1024 lds
    s_add_u32 m0, s51, 0xe000
    s_add_u32 s83, s4, s87
    buffer_load_dwordx4 v8, s[8:11], s83 offen lds
    buffer_load_dwordx4 v9, s[8:11], s83 offen offset:1024 lds
L_pad32:
    s_cbranch_execz L_wret
    s_add_u32 m0, s51, 0x14000
    s_add_u32 s84, s4, s87
    buffer_load_dwordx4 v10, s[8:11], s84 offen lds
    buffer_load_dwordx4 v11, s[8:11], s84 offen offset:1024 lds
    s_add_u32 m0, s51, 0x1c000
    s_mul_i32 s83, s5, 0x6c0
    s_add_u32 s83, s83, s70
    buffer_load_dwordx4 v16, s[12:15], s83 offen lds
    v_bfe_u32 v1, v60, 4, 1
    v_mul_u32_u24 v1, 0x6000, v1
    v_and_b32 v2, 15, v60
    v_lshl_add_u32 v1, v2, 7, v1
    v_add_u32 v1, s51, v1
    v_add_u32 v1, 0xc000, v1
    v_bfe_u32 v2, v60, 1, 3
    v_lshrrev_b32 v3, 5, v60
    v_xor_b32 v2, v2, v3
    v_lshl_add_u32 v12, v2, 4, v1
    v_xor_b32 v4, 2, v2
    v_lshl_add_u32 v13, v4, 4, v1
    v_xor_b32 v4, 4, v2
    v_lshl_add_u32 v14, v4, 4, v1
    v_xor_b32 v4, 6, v2
    v_lshl_add_u32 v15, v4, 4, v1
    v_bfe_u32 v1, v60, 2, 2
    v_and_b32 v2, 3, v60
    v_bfe_u32 v3, v60, 4, 1
    v_lshrrev_b32 v4, 5, v60
    v_lshlrev_b32 v5, 3, v2
    v_lshl_add_u32 v5, v3, 5, v5
    v_bfe_u32 v6, v60, 3, 1
    v_lshlrev_b32 v6, 6, v6
    v_lshl_add_u32 v7, v4, 3, v1
    buffer_load_dwordx4 v17, s[12:15], s83 offen offset:1024 lds
    v_lshl_add_u32 v7, v7, 7, v5
    v_add_u32 v30, v6, v7
    v_add_u32 v31, 0xc000, v30
    v_add_u32 v32, 0x18000, v30
    v_lshl_add_u32 v7, v4, 3, v1
    v_lshl_add_u32 v7, v7, 7, v5
    v_xor_b32 v33, 64, v6
    v_add_u32 v33, v33, v7
    v_add_u32 v34, 0xc000, v33
    v_add_u32 v35, 0x18000, v33
    v_lshl_add_u32 v7, v4, 3, v1
    v_lshl_add_u32 v36, v7, 6, v5
    v_add_u32 v37, 0xc000, v36
    v_add_u32 v38, 0x18000, v36
    s_mul_i32 s76, s50, 0x24000
    s_mul_i32 s56, s3, 0x1200
    s_add_u32 s56, s56, s76
    s_mul_i32 s57, s4, 0x1200
    s_add_u32 s57, s57, s76
    s_mul_i32 s58, s5, 0x1200
    s_add_u32 s58, s58, s76
    s_mul_i32 s59, s6, 0x1200
    s_add_u32 s59, s59, s76
    s_mul_i32 s60, s7, 0x1200
    s_add_u32 s60, s60, s76
    s_add_u32 m0, s51, 0x10000
    s_add_u32 s84, s5, s87
    buffer_load_dwordx4 v8, s[8:11], s84 offen lds
    s_mul_i32 s61, s90, 0x1200
    s_add_u32 s61, s61, s76
    s_mul_i32 s62, s91, 0x1200
    s_add_u32 s62, s62, s76
    s_mul_i32 s63, s92, 0x1200
    s_add_u32 s63, s63, s76
    s_mul_i32 s64, s93, 0x1200
    s_add_u32 s64, s64, s76
    s_mul_i32 s76, s49, 0x240
    s_and_b32 s77, s49, 1
    s_cselect_b32 s78, 64, 0
    s_cselect_b32 s79, 0, 0x200
    s_add_u32 s78, s78, s76
    s_add_u32 s69, s79, s76
    s_add_u32 s81, s48, 0
    s_and_b32 s81, s81, 3
    s_lshl_b32 s81, s81, 7
    s_add_u32 s65, s81, s78
    s_add_u32 s81, s48, 1
L_pad33:
    s_cbranch_execz L_wret
    s_and_b32 s81, s81, 3
    s_lshl_b32 s81, s81, 7
    s_add_u32 s66, s81, s78
    s_add_u32 s81, s48, 2
    s_and_b32 s81, s81, 3
    s_lshl_b32 s81, s81, 7
    buffer_load_dwordx4 v9, s[8:11], s84 offen offset:1024 lds
    s_add_u32 s67, s81, s78
    s_add_u32 s81, s48, 3
    s_and_b32 s81, s81, 3
    s_lshl_b32 s81, s81, 7
    s_add_u32 s68, s81, s78
    v_lshrrev_b32 v3, 2, v60
    v_mul_u32_u24 v3, 0x2400, v3
    v_and_b32 v4, 3, v60
    v_lshl_add_u32 v20, v4, 4, v3
    s_lshl_b32 s89, s48, 2
    s_add_u32 s89, s89, s50
    s_mul_i32 s76, s89, 0x1b200
    s_lshl_b32 s77, s49, 12
    s_add_u32 s74, s76, s77
    s_mov_b32 s78, 0x3eae1a93
    s_cmp_lt_u32 s49, 9
    s_cselect_b32 s75, s78, 1.0
    v_lshlrev_b32 v45, 4, v60
    v_add_u32 v1, 0, v60
    v_mul_u32_u24 v2, 0xab, v1
    v_lshrrev_b32 v2, 11, v2
    v_mul_u32_u24 v2, 0x3c0, v2
    v_lshl_add_u32 v21, v60, 4, v2
    v_add_u32 v1, 64, v60
    v_mul_u32_u24 v2, 0xab, v1
    s_add_u32 m0, s51, 0x16000
    s_add_u32 s83, s5, s87
    buffer_load_dwordx4 v10, s[8:11], s83 offen lds
    v_lshrrev_b32 v2, 11, v2
    v_mul_u32_u24 v2, 0x3c0, v2
    v_lshl_add_u32 v22, v60, 4, v2
    v_add_u32 v1, 0x80, v60
    v_mul_u32_u24 v2, 0xab, v1
    v_lshrrev_b32 v2, 11, v2
    v_mul_u32_u24 v2, 0x3c0, v2
    v_lshl_add_u32 v23, v60, 4, v2
    v_lshlrev_b32 v28, 4, v60
    s_mul_i32 s77, s49, 0x27000
    s_add_u32 s78, s77, s51
    v_bfe_u32 v1, v60, 2, 3
    v_lshl_add_u32 v1, v1, 8, s78
    v_lshrrev_b32 v2, 5, v60
    v_lshl_add_u32 v1, v2, 6, v1
    v_and_b32 v2, 3, v60
    v_lshl_add_u32 v57, v2, 4, v1
    s_mul_i32 s79, s50, 0x5400
    s_add_u32 s79, s79, 0x12000
    s_add_u32 s78, s77, s79
    v_add_u32 v24, s78, v28
    s_xor_b32 s80, s49, 1
    s_mul_i32 s77, s80, 0x27000
    s_add_u32 s78, s77, s79
    v_add_u32 v25, s78, v28
    buffer_load_dwordx4 v11, s[8:11], s83 offen offset:1024 lds
    s_mul_i32 s76, s49, 9
    s_lshr_b32 s76, s76, 1
    s_lshl_b32 s76, s76, 9
    v_lshrrev_b32 v1, 5, v60
    v_and_b32 v5, 19, v60
    v_bfe_u32 v6, v60, 2, 1
    v_lshl_add_u32 v5, v6, 3, v5
    v_bfe_u32 v6, v60, 3, 1
    v_lshl_add_u32 v5, v6, 2, v5
    v_lshl_add_u32 v5, v5, 4, s76
    v_lshl_add_u32 v6, v1, 9, v5
    v_add_u32 v48, 0x9000, v6
    v_add_u32 v49, 0x9200, v6
    v_add_u32 v5, 0x8c00, v5
    s_mul_i32 s77, s49, 36
    v_add_u32 v2, 0xffffffe0, v60
    v_max_i32 v2, 0, v2
    v_mul_u32_u24 v3, 0xcd, v2
    v_lshrrev_b32 v3, 13, v3
    v_mul_u32_u24 v4, 40, v3
    v_sub_u32 v4, v2, v4
    v_cmp_gt_u32 vcc, 36, v4
    v_mov_b32 v6, 0x21c
    v_mov_b32 v7, s77
    v_cndmask_b32 v6, v6, v7, vcc
    s_add_u32 m0, s51, 0x1e000
    s_nop 0
L_pad34:
    s_cbranch_execz L_wret
    s_mul_i32 s84, s3, 0x6c0
    s_add_u32 s84, s84, s71
    buffer_load_dwordx4 v16, s[12:15], s84 offen lds
    v_add_u32 v4, v4, v6
    v_mul_u32_u24 v3, 0x2480, v3
    v_lshl_add_u32 v4, v4, 4, v3
    v_add_u32 v50, 0x11800, v4
    v_cmp_gt_u32 vcc, 32, v60
    v_add_u32 v2, 32, v60
    v_mul_u32_u24 v3, 0xcd, v2
    v_cndmask_b32 v50, v50, v5, vcc
    v_lshrrev_b32 v3, 13, v3
    v_mul_u32_u24 v4, 40, v3
    v_sub_u32 v4, v2, v4
    v_cmp_gt_u32 vcc, 36, v4
    v_mov_b32 v6, 0x21c
    v_mov_b32 v7, s77
    v_cndmask_b32 v6, v6, v7, vcc
    v_add_u32 v4, v4, v6
    v_mul_u32_u24 v3, 0x2480, v3
    v_lshl_add_u32 v4, v4, 4, v3
    v_add_u32 v51, 0x11400, v4
    v_add_u32 v2, 0x60, v60
    v_mul_u32_u24 v3, 0xcd, v2
    v_lshrrev_b32 v3, 13, v3
    v_mul_u32_u24 v4, 40, v3
    v_sub_u32 v4, v2, v4
    v_cmp_gt_u32 vcc, 36, v4
    buffer_load_dwordx4 v17, s[12:15], s84 offen offset:1024 lds
    v_mov_b32 v6, 0x21c
    v_mov_b32 v7, s77
    v_cndmask_b32 v6, v6, v7, vcc
    v_add_u32 v4, v4, v6
    v_mul_u32_u24 v3, 0x2480, v3
    v_lshl_add_u32 v4, v4, 4, v3
    v_add_u32 v52, 0x12000, v4
    s_add_u32 s78, s53, 0xc000
    v_lshl_add_u32 v53, v60, 4, s78
    v_and_b32 v2, 31, v60
    v_lshl_add_u32 v54, v2, 4, s78
    v_cmp_gt_u32 vcc, 18, v2
    v_mul_u32_u24 v3, 0x280, v1
    v_add_u32 v3, s78, v3
    v_add_u32 v4, 0, v2
    v_mov_b32 v6, 36
    v_cndmask_b32 v4, v6, v4, vcc
    v_lshl_add_u32 v55, v4, 4, v3
    v_add_u32 v4, 18, v2
    v_mov_b32 v6, 36
    v_cndmask_b32 v4, v6, v4, vcc
    v_lshl_add_u32 v56, v4, 4, v3
    v_lshlrev_b32 v3, 3, v1
    v_sub_u32 v61, v2, v3
    s_mov_b32 s94, 0
    s_add_u32 m0, s51, 0x20000
    s_mul_i32 s83, s4, 0x6c0
    s_add_u32 s83, s83, s71
    buffer_load_dwordx4 v16, s[12:15], s83 offen lds
    s_mov_b32 s95, -1
    s_mov_b32 s98, 0xffff
    v_sub_u32 v224, -1, v61
    v_ashrrev_i32 v224, 31, v224
    v_sub_u32 v225, 0, v61
    v_ashrrev_i32 v225, 31, v225
    v_sub_u32 v226, 1, v61
    v_ashrrev_i32 v226, 31, v226
    v_sub_u32 v227, 2, v61
    v_ashrrev_i32 v227, 31, v227
    v_sub_u32 v228, 3, v61
    v_ashrrev_i32 v228, 31, v228
    v_sub_u32 v229, 4, v61
    v_ashrrev_i32 v229, 31, v229
    v_sub_u32 v230, 5, v61
    v_ashrrev_i32 v230, 31, v230
    v_sub_u32 v231, 6, v61
    v_ashrrev_i32 v231, 31, v231
    v_sub_u32 v232, 15, v61
    v_ashrrev_i32 v232, 31, v232
    v_sub_u32 v233, 16, v61
    v_ashrrev_i32 v233, 31, v233
    v_sub_u32 v234, 17, v61
    v_ashrrev_i32 v234, 31, v234
    v_sub_u32 v235, 18, v61
    buffer_load_dwordx4 v17, s[12:15], s83 offen offset:1024 lds
    v_ashrrev_i32 v235, 31, v235
    v_sub_u32 v236, 19, v61
    v_ashrrev_i32 v236, 31, v236
    v_sub_u32 v237, 20, v61
    v_ashrrev_i32 v237, 31, v237
    v_sub_u32 v238, 21, v61
    v_ashrrev_i32 v238, 31, v238
    v_sub_u32 v239, 22, v61
    v_ashrrev_i32 v239, 31, v239
    s_lshl_b32 s79, s89, 4
    s_add_u32 s80, s79, s49
    s_lshl_b32 s80, s80, 7
    s_add_u32 s80, s80, 0x800000
    s_nop 0
L_pad35:
    s_cbranch_execz L_wret
    v_bfe_u32 v5, v60, 3, 1
    v_mul_u32_u24 v5, 0x1ffe0, v5
    v_lshl_add_u32 v5, v60, 2, v5
    v_cmp_gt_u32 vcc, 16, v60
    v_mov_b32 v6, 0x7ffffff0
    v_mov_b32 v7, 0
    v_cndmask_b32 v5, v6, v5, vcc
    s_add_u32 s81, s80, 0x20000
    v_mov_b32 v26, s81
    s_xor_b32 s81, s81, 0x80
    v_cmp_eq_u32 vcc, 0, v60
    s_mul_i32 s76, s89, 0x1b200
    s_add_u32 m0, s51, 0x22000
    s_mul_i32 s84, s5, 0x6c0
    s_add_u32 s84, s84, s71
    buffer_load_dwordx4 v16, s[12:15], s84 offen lds
    s_lshl_b32 s77, s49, 10
    s_add_u32 s76, s76, s77
    s_add_u32 s72, s76, 0x11800
    s_add_u32 s73, s76, 0x16100
    v_lshrrev_b32 v3, 5, v60
    v_mul_u32_u24 v3, 0x2480, v3
    v_and_b32 v1, 31, v60
    v_lshl_add_u32 v44, v1, 4, v3
    buffer_load_dwordx4 v17, s[12:15], s84 offen offset:1024 lds
    buffer_store_dword v7, v5, s[28:31], s80 offen sc1
    v_mov_b32 v5, s81
    v_cndmask_b32 v29, v6, v5, vcc
    s_and_b32 s81, s49, 1
    s_add_u32 s79, s79, s81
    s_lshl_b32 s79, s79, 7
    s_lshr_b32 s81, s49, 1
    s_lshl_b32 s81, s81, 2
    s_add_u32 s79, s79, s81
    s_add_u32 s79, s79, 0x800000
    v_lshl_add_u32 v5, v60, 8, s79
    v_cmp_gt_u32 vcc, 8, v60
    s_nop 1
    v_cndmask_b32 v61, v6, v5, vcc
    v_and_b32 v5, 3, v60
    v_min_u32 v5, 2, v5
    v_sub_u32 v5, s48, v5
    v_max_i32 v5, 0, v5
    v_lshlrev_b32 v59, 4, v5
    s_mov_b32 s96, 0
    s_movk_i32 s97, 0
    s_call_b64 s[0:1], L_warm
    s_waitcnt vmcnt(19)
    ds_read_b128 a[0:3], v12 offset:0
    ds_read_b128 a[4:7], v13 offset:0
    ds_read_b128 a[8:11], v14 offset:0
    ds_read_b128 a[12:15], v15 offset:0
    s_barrier
    s_add_u32 m0, s51, 0
    s_add_u32 s83, s6, s87
    buffer_load_dwordx4 v8, s[8:11], s83 offen lds
    ds_read_b64_tr_b16 a[144:145], v32 offset:0
    ds_read_b64_tr_b16 a[146:147], v32 offset:512
    ds_read_b64_tr_b16 a[148:149], v35 offset:0
    ds_read_b64_tr_b16 a[150:151], v35 offset:512
    ds_read_b64_tr_b16 a[152:153], v32 offset:2048
    ds_read_b64_tr_b16 a[154:155], v32 offset:2560
    ds_read_b64_tr_b16 a[156:157], v35 offset:2048
    ds_read_b64_tr_b16 a[158:159], v35 offset:2560
    buffer_load_dwordx4 v9, s[8:11], s83 offen offset:1024 lds
    ds_read_b64_tr_b16 a[160:161], v32 offset:4096
    ds_read_b64_tr_b16 a[162:163], v32 offset:4608
    ds_read_b64_tr_b16 a[164:165], v35 offset:4096
    ds_read_b64_tr_b16 a[166:167], v35 offset:4608
    ds_read_b64_tr_b16 a[168:169], v32 offset:6144
    ds_read_b64_tr_b16 a[170:171], v32 offset:6656
    ds_read_b64_tr_b16 a[172:173], v35 offset:6144
    ds_read_b64_tr_b16 a[174:175], v35 offset:6656
    s_add_u32 m0, s51, 0x6000
    s_add_u32 s84, s6, s87
    buffer_load_dwordx4 v10, s[8:11], s84 offen lds
    s_mul_i32 s76, s49, 0x120
    s_and_b32 s77, s49, 1
    s_cselect_b32 s78, 32, 0
    s_cselect_b32 s79, 0, 0x100
    s_add_u32 s80, s78, s76
    s_add_u32 s81, s79, s76
    s_lshr_b32 s76, s50, 1
L_pad36:
    s_cbranch_execz L_wret
    s_add_u32 s76, s76, 0
    buffer_load_dwordx4 v11, s[8:11], s84 offen offset:1024 lds
    s_add_u32 s76, s76, s48
    s_waitcnt lgkmcnt(14)
    v_mfma_f32_32x32x16_bf16 v[64:79], a[0:3], a[144:147], 0
    s_and_b32 s76, s76, 3
    s_lshl_b32 s76, s76, 6
    s_and_b32 s77, s50, 1
    s_lshl_b32 s77, s77, 5
    s_add_u32 s76, s76, s77
    s_add_u32 s3, s76, s80
    s_waitcnt lgkmcnt(8)
    v_mfma_f32_32x32x16_bf16 v[80:95], a[0:3], a[148:151], 0
    s_add_u32 m0, s51, 0x2000
    s_add_u32 s83, s7, s87
    buffer_load_dwordx4 v8, s[8:11], s83 offen lds
    s_lshr_b32 s76, s50, 1
    v_mfma_f32_32x32x16_bf16 v[64:79], a[4:7], a[152:155], v[64:79]
    s_add_u32 s76, s76, 2
    s_add_u32 s76, s76, s48
    s_and_b32 s76, s76, 3
    s_lshl_b32 s76, s76, 6
    s_and_b32 s77, s50, 1
    s_lshl_b32 s77, s77, 5
    v_mfma_f32_32x32x16_bf16 v[80:95], a[4:7], a[156:159], v[80:95]
    buffer_load_dwordx4 v9, s[8:11], s83 offen offset:1024 lds
    s_add_u32 s76, s76, s77
    s_add_u32 s4, s76, s80
    s_xor_b32 s82, s49, 1
    s_waitcnt lgkmcnt(0)
    v_mfma_f32_32x32x16_bf16 v[64:79], a[8:11], a[160:163], v[64:79]
    s_waitcnt vmcnt(19)
    ds_read_b128 a[16:19], v12 offset:8192
    ds_read_b128 a[20:23], v13 offset:8192
    ds_read_b128 a[24:27], v14 offset:8192
    ds_read_b128 a[28:31], v15 offset:8192
    s_barrier
    v_mfma_f32_32x32x16_bf16 v[80:95], a[8:11], a[164:167], v[80:95]
    s_add_u32 m0, s51, 0x8000
    s_add_u32 s84, s7, s87
    buffer_load_dwordx4 v10, s[8:11], s84 offen lds
    ds_read_b64_tr_b16 a[144:145], v32 offset:8192
    v_mfma_f32_32x32x16_bf16 v[64:79], a[12:15], a[168:171], v[64:79]
    ds_read_b64_tr_b16 a[146:147], v32 offset:8704
    ds_read_b64_tr_b16 a[148:149], v35 offset:8192
    ds_read_b64_tr_b16 a[150:151], v35 offset:8704
    ds_read_b64_tr_b16 a[152:153], v32 offset:10240
    ds_read_b64_tr_b16 a[154:155], v32 offset:10752
    ds_read_b64_tr_b16 a[156:157], v35 offset:10240
    v_mfma_f32_32x32x16_bf16 v[80:95], a[12:15], a[172:175], v[80:95]
    buffer_load_dwordx4 v11, s[8:11], s84 offen offset:1024 lds
    ds_read_b64_tr_b16 a[158:159], v35 offset:10752
    ds_read_b64_tr_b16 a[160:161], v32 offset:12288
    ds_read_b64_tr_b16 a[162:163], v32 offset:12800
    ds_read_b64_tr_b16 a[164:165], v35 offset:12288
    ds_read_b64_tr_b16 a[166:167], v35 offset:12800
    ds_read_b64_tr_b16 a[168:169], v32 offset:14336
    ds_read_b64_tr_b16 a[170:171], v32 offset:14848
    ds_read_b64_tr_b16 a[172:173], v35 offset:14336
    s_add_u32 m0, s51, 0x4000
    s_add_u32 s83, s90, s87
    buffer_load_dwordx4 v8, s[8:11], s83 offen lds
    ds_read_b64_tr_b16 a[174:175], v35 offset:14848
    s_mul_i32 s76, s82, 0x120
    s_and_b32 s77, s82, 1
    s_cselect_b32 s78, 32, 0
    s_cselect_b32 s79, 0, 0x100
    s_add_u32 s80, s78, s76
    s_and_b32 s77, s50, 1
    s_lshl_b32 s77, s77, 5
    buffer_load_dwordx4 v9, s[8:11], s83 offen offset:1024 lds
    s_waitcnt lgkmcnt(14)
    v_mfma_f32_32x32x16_bf16 v[64:79], a[16:19], a[144:147], v[64:79]
    s_mul_i32 s3, s3, 0x480
    s_mul_i32 s4, s4, 0x480
    s_waitcnt lgkmcnt(9)
    v_mfma_f32_32x32x16_bf16 v[80:95], a[16:19], a[148:151], v[80:95]
    s_add_u32 m0, s51, 0xa000
    s_add_u32 s84, s90, s87
    buffer_load_dwordx4 v10, s[8:11], s84 offen lds
    s_nop 0
L_pad37:
    s_cbranch_execz L_wret
    v_mfma_f32_32x32x16_bf16 v[64:79], a[20:23], a[152:155], v[64:79]
    s_waitcnt lgkmcnt(0)
    v_mfma_f32_32x32x16_bf16 v[80:95], a[20:23], a[156:159], v[80:95]
    buffer_load_dwordx4 v11, s[8:11], s84 offen offset:1024 lds
    v_mfma_f32_32x32x16_bf16 v[64:79], a[24:27], a[160:163], v[64:79]
    s_waitcnt vmcnt(19)
    ds_read_b128 a[32:35], v12 offset:16384
    ds_read_b128 a[36:39], v13 offset:16384
    ds_read_b128 a[40:43], v14 offset:16384
    ds_read_b128 a[44:47], v15 offset:16384
    v_add_u32 v12, 0xffff4000, v12
    v_mfma_f32_32x32x16_bf16 v[80:95], a[24:27], a[164:167], v[80:95]
    v_add_u32 v13, 0xffff4000, v13
    v_add_u32 v14, 0xffff4000, v14
    v_add_u32 v15, 0xffff4000, v15
    s_barrier
    ds_read_b64_tr_b16 a[144:145], v32 offset:16384
    ds_read_b64_tr_b16 a[146:147], v32 offset:16896
    v_mfma_f32_32x32x16_bf16 v[64:79], a[28:31], a[168:171], v[64:79]
    ds_read_b64_tr_b16 a[148:149], v35 offset:16384
    ds_read_b64_tr_b16 a[150:151], v35 offset:16896
    ds_read_b64_tr_b16 a[152:153], v32 offset:18432
    ds_read_b64_tr_b16 a[154:155], v32 offset:18944
    ds_read_b64_tr_b16 a[156:157], v35 offset:18432
    ds_read_b64_tr_b16 a[158:159], v35 offset:18944
    v_mfma_f32_32x32x16_bf16 v[80:95], a[28:31], a[172:175], v[80:95]
    ds_read_b64_tr_b16 a[160:161], v32 offset:20480
    ds_read_b64_tr_b16 a[162:163], v32 offset:20992
    ds_read_b64_tr_b16 a[164:165], v35 offset:20480
    ds_read_b64_tr_b16 a[166:167], v35 offset:20992
    ds_read_b64_tr_b16 a[168:169], v32 offset:22528
    ds_read_b64_tr_b16 a[170:171], v32 offset:23040
    ds_read_b64_tr_b16 a[172:173], v35 offset:22528
    ds_read_b64_tr_b16 a[174:175], v35 offset:23040
    s_add_u32 m0, s51, 0xc000
    s_mul_i32 s83, s6, 0x6c0
    s_add_u32 s83, s83, s70
    buffer_load_dwordx4 v16, s[12:15], s83 offen lds
    buffer_load_dwordx4 v17, s[12:15], s83 offen offset:1024 lds
    s_waitcnt lgkmcnt(14)
    v_mfma_f32_32x32x16_bf16 v[64:79], a[32:35], a[144:147], v[64:79]
    s_waitcnt lgkmcnt(8)
    v_mfma_f32_32x32x16_bf16 v[80:95], a[32:35], a[148:151], v[80:95]
    s_add_u32 m0, s51, 0xe000
    s_mul_i32 s84, s7, 0x6c0
    s_add_u32 s84, s84, s70
    buffer_load_dwordx4 v16, s[12:15], s84 offen lds
    v_mfma_f32_32x32x16_bf16 v[64:79], a[36:39], a[152:155], v[64:79]
    s_waitcnt vmcnt(16)
    s_barrier
    ds_read_b64_tr_b16 a[144:145], v32 offset:24576
    ds_read_b64_tr_b16 a[146:147], v32 offset:25088
    ds_read_b64_tr_b16 a[148:149], v35 offset:24576
    ds_read_b64_tr_b16 a[150:151], v35 offset:25088
    v_mfma_f32_32x32x16_bf16 v[80:95], a[36:39], a[156:159], v[80:95]
    buffer_load_dwordx4 v17, s[12:15], s84 offen offset:1024 lds
    ds_read_b64_tr_b16 a[152:153], v32 offset:26624
    ds_read_b64_tr_b16 a[154:155], v32 offset:27136
    ds_read_b64_tr_b16 a[156:157], v35 offset:26624
    s_waitcnt lgkmcnt(7)
    v_mfma_f32_32x32x16_bf16 v[64:79], a[40:43], a[160:163], v[64:79]
    ds_read_b64_tr_b16 a[158:159], v35 offset:27136
    ds_read_b64_tr_b16 a[160:161], v32 offset:28672
    ds_read_b64_tr_b16 a[162:163], v32 offset:29184
    v_mfma_f32_32x32x16_bf16 v[80:95], a[40:43], a[164:167], v[80:95]
    s_add_u32 m0, s51, 0x10000
    s_mul_i32 s83, s90, 0x6c0
    s_add_u32 s83, s83, s70
    buffer_load_dwordx4 v16, s[12:15], s83 offen lds
L_pad38:
    s_cbranch_execz L_wret
    v_mfma_f32_32x32x16_bf16 v[64:79], a[44:47], a[168:171], v[64:79]
    ds_read_b64_tr_b16 a[164:165], v35 offset:28672
    ds_read_b64_tr_b16 a[166:167], v35 offset:29184
    ds_read_b64_tr_b16 a[168:169], v32 offset:30720
    ds_read_b64_tr_b16 a[170:171], v32 offset:31232
    v_mfma_f32_32x32x16_bf16 v[80:95], a[44:47], a[172:175], v[80:95]
    buffer_load_dwordx4 v17, s[12:15], s83 offen offset:1024 lds
    ds_read_b64_tr_b16 a[172:173], v35 offset:30720
    ds_read_b64_tr_b16 a[174:175], v35 offset:31232
    s_waitcnt lgkmcnt(10)
    v_mfma_f32_32x32x16_bf16 v[96:111], a[144:147], a[0:3], 0
    ds_read_b64_tr_b16 a[144:145], v32 offset:32768
    ds_read_b64_tr_b16 a[146:147], v32 offset:33280
    v_mfma_f32_32x32x16_bf16 v[112:127], a[148:151], a[0:3], 0
    s_add_u32 m0, s51, 0x12000
    s_mul_i32 s84, s6, 0x6c0
    s_add_u32 s84, s84, s71
    buffer_load_dwordx4 v16, s[12:15], s84 offen lds
    v_mfma_f32_32x32x16_bf16 v[96:111], a[152:155], a[4:7], v[96:111]
    ds_read_b64_tr_b16 a[148:149], v35 offset:32768
    ds_read_b64_tr_b16 a[150:151], v35 offset:33280
    ds_read_b64_tr_b16 a[152:153], v32 offset:34816
    ds_read_b64_tr_b16 a[154:155], v32 offset:35328
    s_waitcnt lgkmcnt(8)
    v_mfma_f32_32x32x16_bf16 v[112:127], a[156:159], a[4:7], v[112:127]
    buffer_load_dwordx4 v17, s[12:15], s84 offen offset:1024 lds
    ds_read_b64_tr_b16 a[156:157], v35 offset:34816
    ds_read_b64_tr_b16 a[158:159], v35 offset:35328
    v_mfma_f32_32x32x16_bf16 v[96:111], a[160:163], a[8:11], v[96:111]
    ds_read_b64_tr_b16 a[160:161], v32 offset:36864
    ds_read_b64_tr_b16 a[162:163], v32 offset:37376
    v_mfma_f32_32x32x16_bf16 v[112:127], a[164:167], a[8:11], v[112:127]
    s_add_u32 m0, s51, 0x14000
    s_mul_i32 s83, s7, 0x6c0
    s_add_u32 s83, s83, s71
    buffer_load_dwordx4 v16, s[12:15], s83 offen lds
    v_mfma_f32_32x32x16_bf16 v[96:111], a[168:171], a[12:15], v[96:111]
    ds_read_b64_tr_b16 a[164:165], v35 offset:36864
    ds_read_b64_tr_b16 a[166:167], v35 offset:37376
    ds_read_b64_tr_b16 a[168:169], v32 offset:38912
    ds_read_b64_tr_b16 a[170:171], v32 offset:39424
    s_waitcnt vmcnt(17)
    ds_read_b128 a[48:51], v12 offset:0
    s_waitcnt lgkmcnt(9)
    v_mfma_f32_32x32x16_bf16 v[112:127], a[172:175], a[12:15], v[112:127]
    buffer_load_dwordx4 v17, s[12:15], s83 offen offset:1024 lds
    ds_read_b64_tr_b16 a[172:173], v35 offset:38912
    ds_read_b64_tr_b16 a[174:175], v35 offset:39424
    ds_read_b128 a[52:55], v13 offset:0
    v_mfma_f32_32x32x16_bf16 v[96:111], a[144:147], a[16:19], v[96:111]
    ds_read_b64_tr_b16 a[144:145], v32 offset:40960
    ds_read_b64_tr_b16 a[146:147], v32 offset:41472
    ds_read_b128 a[56:59], v14 offset:0
    ds_read_b128 a[60:63], v15 offset:0
    v_mfma_f32_32x32x16_bf16 v[112:127], a[148:151], a[16:19], v[112:127]
    s_add_u32 m0, s51, 0x16000
    s_mul_i32 s84, s90, 0x6c0
    s_add_u32 s84, s84, s71
    buffer_load_dwordx4 v16, s[12:15], s84 offen lds
    v_mfma_f32_32x32x16_bf16 v[96:111], a[152:155], a[20:23], v[96:111]
    ds_read_b64_tr_b16 a[148:149], v35 offset:40960
    ds_read_b64_tr_b16 a[150:151], v35 offset:41472
    ds_read_b64_tr_b16 a[152:153], v32 offset:43008
    ds_read_b64_tr_b16 a[154:155], v32 offset:43520
    s_waitcnt lgkmcnt(11)
    v_mfma_f32_32x32x16_bf16 v[112:127], a[156:159], a[20:23], v[112:127]
    buffer_load_dwordx4 v17, s[12:15], s84 offen offset:1024 lds
    s_nop 0
L_pad39:
    s_cbranch_execz L_wret
    ds_read_b64_tr_b16 a[156:157], v35 offset:43008
    ds_read_b64_tr_b16 a[158:159], v35 offset:43520
    s_waitcnt vmcnt(16)
    ds_read_b128 a[64:67], v12 offset:8192
    v_mfma_f32_32x32x16_bf16 v[96:111], a[160:163], a[24:27], v[96:111]
    ds_read_b64_tr_b16 a[160:161], v32 offset:45056
    ds_read_b64_tr_b16 a[162:163], v32 offset:45568
    ds_read_b128 a[68:71], v13 offset:8192
    ds_read_b128 a[72:75], v14 offset:8192
    ds_read_b128 a[76:79], v15 offset:8192
    v_mfma_f32_32x32x16_bf16 v[112:127], a[164:167], a[24:27], v[112:127]
    ds_read_b64_tr_b16 a[164:165], v35 offset:45056
    ds_read_b64_tr_b16 a[166:167], v35 offset:45568
    v_mfma_f32_32x32x16_bf16 v[96:111], a[168:171], a[28:31], v[96:111]
    ds_read_b64_tr_b16 a[168:169], v32 offset:47104
    ds_read_b64_tr_b16 a[170:171], v32 offset:47616
    s_waitcnt lgkmcnt(12)
    v_mfma_f32_32x32x16_bf16 v[112:127], a[172:175], a[28:31], v[112:127]
    ds_read_b64_tr_b16 a[172:173], v35 offset:47104
    ds_read_b64_tr_b16 a[174:175], v35 offset:47616
    v_mfma_f32_32x32x16_bf16 v[96:111], a[144:147], a[32:35], v[96:111]
    s_waitcnt vmcnt(12)
    ds_read_b128 a[80:83], v12 offset:16384
    ds_read_b128 a[84:87], v13 offset:16384
    ds_read_b128 a[88:91], v14 offset:16384
    ds_read_b128 a[92:95], v15 offset:16384
    v_mfma_f32_32x32x16_bf16 v[112:127], a[148:151], a[32:35], v[112:127]
    s_add_u32 m0, s51, 0
    s_add_u32 s83, s91, s87
    buffer_load_dwordx4 v8, s[8:11], s83 offen lds
    v_mfma_f32_32x32x16_bf16 v[96:111], a[152:155], a[36:39], v[96:111]
    s_waitcnt vmcnt(7)
    s_barrier
    ds_read_b64_tr_b16 a[144:145], v31 offset:0
    ds_read_b64_tr_b16 a[146:147], v31 offset:512
    ds_read_b64_tr_b16 a[148:149], v34 offset:0
    ds_read_b64_tr_b16 a[150:151], v34 offset:512
    s_waitcnt lgkmcnt(10)
    v_mfma_f32_32x32x16_bf16 v[112:127], a[156:159], a[36:39], v[112:127]
    buffer_load_dwordx4 v9, s[8:11], s83 offen offset:1024 lds
    ds_read_b64_tr_b16 a[152:153], v31 offset:2048
    ds_read_b64_tr_b16 a[154:155], v31 offset:2560
    ds_read_b64_tr_b16 a[156:157], v34 offset:2048
    v_mfma_f32_32x32x16_bf16 v[96:111], a[160:163], a[40:43], v[96:111]
    ds_read_b64_tr_b16 a[158:159], v34 offset:2560
    ds_read_b64_tr_b16 a[160:161], v31 offset:4096
    ds_read_b64_tr_b16 a[162:163], v31 offset:4608
    v_mfma_f32_32x32x16_bf16 v[112:127], a[164:167], a[40:43], v[112:127]
    s_add_u32 m0, s51, 0x6000
    s_add_u32 s84, s91, s87
    buffer_load_dwordx4 v10, s[8:11], s84 offen lds
    ds_read_b64_tr_b16 a[164:165], v34 offset:4096
    v_mfma_f32_32x32x16_bf16 v[96:111], a[168:171], a[44:47], v[96:111]
    ds_read_b64_tr_b16 a[166:167], v34 offset:4608
    ds_read_b64_tr_b16 a[168:169], v31 offset:6144
    ds_read_b64_tr_b16 a[170:171], v31 offset:6656
    s_waitcnt lgkmcnt(11)
    v_mfma_f32_32x32x16_bf16 v[112:127], a[172:175], a[44:47], v[112:127]
    buffer_load_dwordx4 v11, s[8:11], s84 offen offset:1024 lds
    ds_read_b64_tr_b16 a[172:173], v34 offset:6144
    ds_read_b64_tr_b16 a[174:175], v34 offset:6656
    v_mfma_f32_32x32x16_bf16 v[64:79], a[48:51], a[144:147], v[64:79]
    ds_read_b64_tr_b16 a[144:145], v31 offset:8192
    ds_read_b64_tr_b16 a[146:147], v31 offset:8704
    s_waitcnt lgkmcnt(8)
    v_mfma_f32_32x32x16_bf16 v[80:95], a[48:51], a[148:151], v[80:95]
    s_add_u32 m0, s51, 0x2000
    s_add_u32 s83, s92, s87
    buffer_load_dwordx4 v8, s[8:11], s83 offen lds
    s_nop 0
L_pad40:
    s_cbranch_execz L_wret
    ds_read_b64_tr_b16 a[148:149], v34 offset:8192
    v_mfma_f32_32x32x16_bf16 v[64:79], a[52:55], a[152:155], v[64:79]
    ds_read_b64_tr_b16 a[150:151], v34 offset:8704
    ds_read_b64_tr_b16 a[152:153], v31 offset:10240
    ds_read_b64_tr_b16 a[154:155], v31 offset:10752
    v_mfma_f32_32x32x16_bf16 v[80:95], a[52:55], a[156:159], v[80:95]
    buffer_load_dwordx4 v9, s[8:11], s83 offen offset:1024 lds
    ds_read_b64_tr_b16 a[156:157], v34 offset:10240
    ds_read_b64_tr_b16 a[158:159], v34 offset:10752
    v_mfma_f32_32x32x16_bf16 v[64:79], a[56:59], a[160:163], v[64:79]
    ds_read_b64_tr_b16 a[160:161], v31 offset:12288
    ds_read_b64_tr_b16 a[162:163], v31 offset:12800
    s_waitcnt lgkmcnt(8)
    v_mfma_f32_32x32x16_bf16 v[80:95], a[56:59], a[164:167], v[80:95]
    s_add_u32 m0, s51, 0x8000
    s_add_u32 s84, s92, s87
    buffer_load_dwordx4 v10, s[8:11], s84 offen lds
    ds_read_b64_tr_b16 a[164:165], v34 offset:12288
    v_mfma_f32_32x32x16_bf16 v[64:79], a[60:63], a[168:171], v[64:79]
    ds_read_b64_tr_b16 a[166:167], v34 offset:12800
    ds_read_b64_tr_b16 a[168:169], v31 offset:14336
    ds_read_b64_tr_b16 a[170:171], v31 offset:14848
    v_mfma_f32_32x32x16_bf16 v[80:95], a[60:63], a[172:175], v[80:95]
    buffer_load_dwordx4 v11, s[8:11], s84 offen offset:1024 lds
    ds_read_b64_tr_b16 a[172:173], v34 offset:14336
    ds_read_b64_tr_b16 a[174:175], v34 offset:14848
    v_mfma_f32_32x32x16_bf16 v[64:79], a[64:67], a[144:147], v[64:79]
    ds_read_b64_tr_b16 a[144:145], v31 offset:16384
    ds_read_b64_tr_b16 a[146:147], v31 offset:16896
    s_waitcnt lgkmcnt(8)
    v_mfma_f32_32x32x16_bf16 v[80:95], a[64:67], a[148:151], v[80:95]
    s_add_u32 m0, s51, 0x4000
    s_add_u32 s83, s93, s87
    buffer_load_dwordx4 v8, s[8:11], s83 offen lds
    ds_read_b64_tr_b16 a[148:149], v34 offset:16384
    v_mfma_f32_32x32x16_bf16 v[64:79], a[68:71], a[152:155], v[64:79]
    ds_read_b64_tr_b16 a[150:151], v34 offset:16896
    ds_read_b64_tr_b16 a[152:153], v31 offset:18432
    ds_read_b64_tr_b16 a[154:155], v31 offset:18944
    v_bfi_b32 v8, s98, v224, v225
    v_mfma_f32_32x32x16_bf16 v[80:95], a[68:71], a[156:159], v[80:95]
    buffer_load_dwordx4 v9, s[8:11], s83 offen offset:1024 lds
    ds_read_b64_tr_b16 a[156:157], v34 offset:18432
    ds_read_b64_tr_b16 a[158:159], v34 offset:18944
    v_bfi_b32 v9, s98, v226, v227
    v_mfma_f32_32x32x16_bf16 v[64:79], a[72:75], a[160:163], v[64:79]
    ds_read_b64_tr_b16 a[160:161], v31 offset:20480
    ds_read_b64_tr_b16 a[162:163], v31 offset:20992
    s_waitcnt lgkmcnt(8)
    v_mfma_f32_32x32x16_bf16 v[80:95], a[72:75], a[164:167], v[80:95]
    s_add_u32 m0, s51, 0xa000
    s_add_u32 s84, s93, s87
    buffer_load_dwordx4 v10, s[8:11], s84 offen lds
    ds_read_b64_tr_b16 a[164:165], v34 offset:20480
    v_mfma_f32_32x32x16_bf16 v[64:79], a[76:79], a[168:171], v[64:79]
    ds_read_b64_tr_b16 a[166:167], v34 offset:20992
    ds_read_b64_tr_b16 a[168:169], v31 offset:22528
    ds_read_b64_tr_b16 a[170:171], v31 offset:23040
    v_bfi_b32 v10, s98, v228, v229
    v_mfma_f32_32x32x16_bf16 v[80:95], a[76:79], a[172:175], v[80:95]
    buffer_load_dwordx4 v11, s[8:11], s84 offen offset:1024 lds
    ds_read_b64_tr_b16 a[172:173], v34 offset:22528
    ds_read_b64_tr_b16 a[174:175], v34 offset:23040
    v_bfi_b32 v11, s98, v230, v231
    v_mfma_f32_32x32x16_bf16 v[64:79], a[80:83], a[144:147], v[64:79]
    s_waitcnt lgkmcnt(6)
    v_mfma_f32_32x32x16_bf16 v[80:95], a[80:83], a[148:151], v[80:95]
L_pad41:
    s_cbranch_execz L_wret
    s_add_u32 m0, s51, 0x18000
    s_mul_i32 s83, s91, 0x6c0
    s_add_u32 s83, s83, s70
    buffer_load_dwordx4 v16, s[12:15], s83 offen lds
    v_mfma_f32_32x32x16_bf16 v[64:79], a[84:87], a[152:155], v[64:79]
    s_waitcnt vmcnt(13)
    s_barrier
    ds_read_b64_tr_b16 a[144:145], v31 offset:24576
    ds_read_b64_tr_b16 a[146:147], v31 offset:25088
    ds_read_b64_tr_b16 a[148:149], v34 offset:24576
    ds_read_b64_tr_b16 a[150:151], v34 offset:25088
    v_mfma_f32_32x32x16_bf16 v[80:95], a[84:87], a[156:159], v[80:95]
    buffer_load_dwordx4 v17, s[12:15], s83 offen offset:1024 lds
    ds_read_b64_tr_b16 a[152:153], v31 offset:26624
    ds_read_b64_tr_b16 a[154:155], v31 offset:27136
    ds_read_b64_tr_b16 a[156:157], v34 offset:26624
    v_mfma_f32_32x32x16_bf16 v[64:79], a[88:91], a[160:163], v[64:79]
    ds_read_b64_tr_b16 a[158:159], v34 offset:27136
    ds_read_b64_tr_b16 a[160:161], v31 offset:28672
    ds_read_b64_tr_b16 a[162:163], v31 offset:29184
    s_waitcnt lgkmcnt(10)
    v_mfma_f32_32x32x16_bf16 v[80:95], a[88:91], a[164:167], v[80:95]
    s_add_u32 m0, s51, 0x1a000
    s_mul_i32 s84, s92, 0x6c0
    s_add_u32 s84, s84, s70
    buffer_load_dwordx4 v16, s[12:15], s84 offen lds
    v_mfma_f32_32x32x16_bf16 v[64:79], a[92:95], a[168:171], v[64:79]
    ds_read_b64_tr_b16 a[164:165], v34 offset:28672
    ds_read_b64_tr_b16 a[166:167], v34 offset:29184
    ds_read_b64_tr_b16 a[168:169], v31 offset:30720
    ds_read_b64_tr_b16 a[170:171], v31 offset:31232
    v_mfma_f32_32x32x16_bf16 v[80:95], a[92:95], a[172:175], v[80:95]
    buffer_load_dwordx4 v17, s[12:15], s84 offen offset:1024 lds
    ds_read_b64_tr_b16 a[172:173], v34 offset:30720
    ds_read_b64_tr_b16 a[174:175], v34 offset:31232
    s_waitcnt lgkmcnt(10)
    v_mfma_f32_32x32x16_bf16 v[96:111], a[144:147], a[48:51], v[96:111]
    ds_read_b64_tr_b16 a[144:145], v31 offset:32768
    ds_read_b64_tr_b16 a[146:147], v31 offset:33280
    v_mfma_f32_32x32x16_bf16 v[112:127], a[148:151], a[48:51], v[112:127]
    s_add_u32 m0, s51, 0x1c000
    s_mul_i32 s83, s93, 0x6c0
    s_add_u32 s83, s83, s70
    buffer_load_dwordx4 v16, s[12:15], s83 offen lds
    v_mfma_f32_32x32x16_bf16 v[96:111], a[152:155], a[52:55], v[96:111]
    ds_read_b64_tr_b16 a[148:149], v34 offset:32768
    ds_read_b64_tr_b16 a[150:151], v34 offset:33280
    ds_read_b64_tr_b16 a[152:153], v31 offset:34816
    ds_read_b64_tr_b16 a[154:155], v31 offset:35328
    s_mov_b32 s70, s81
    s_add_u32 s81, s79, s76
    s_waitcnt lgkmcnt(8)
    v_mfma_f32_32x32x16_bf16 v[112:127], a[156:159], a[52:55], v[112:127]
    buffer_load_dwordx4 v17, s[12:15], s83 offen offset:1024 lds
    ds_read_b64_tr_b16 a[156:157], v34 offset:34816
    ds_read_b64_tr_b16 a[158:159], v34 offset:35328
    s_mov_b32 s76, 0
    v_mfma_f32_32x32x16_bf16 v[96:111], a[160:163], a[56:59], v[96:111]
    ds_read_b64_tr_b16 a[160:161], v31 offset:36864
    ds_read_b64_tr_b16 a[162:163], v31 offset:37376
    s_waitcnt vmcnt(14)
    ds_read_b128 a[96:99], v12 offset:0
    ds_read_b128 a[100:103], v13 offset:0
    ds_read_b128 a[104:107], v14 offset:0
    v_mfma_f32_32x32x16_bf16 v[112:127], a[164:167], a[56:59], v[112:127]
    s_add_u32 m0, s51, 0x1e000
    s_mul_i32 s84, s91, 0x6c0
    s_add_u32 s84, s84, s71
    buffer_load_dwordx4 v16, s[12:15], s84 offen lds
    v_mfma_f32_32x32x16_bf16 v[96:111], a[168:171], a[60:63], v[96:111]
L_pad42:
    s_cbranch_execz L_wret
    ds_read_b64_tr_b16 a[164:165], v34 offset:36864
    ds_read_b64_tr_b16 a[166:167], v34 offset:37376
    ds_read_b64_tr_b16 a[168:169], v31 offset:38912
    ds_read_b64_tr_b16 a[170:171], v31 offset:39424
    ds_read_b128 a[108:111], v15 offset:0
    s_add_u32 s76, s76, s48
    s_waitcnt lgkmcnt(12)
    v_mfma_f32_32x32x16_bf16 v[112:127], a[172:175], a[60:63], v[112:127]
    buffer_load_dwordx4 v17, s[12:15], s84 offen offset:1024 lds
    ds_read_b64_tr_b16 a[172:173], v34 offset:38912
    ds_read_b64_tr_b16 a[174:175], v34 offset:39424
    s_and_b32 s76, s76, 3
    v_mfma_f32_32x32x16_bf16 v[96:111], a[144:147], a[64:67], v[96:111]
    ds_read_b64_tr_b16 a[144:145], v31 offset:40960
    ds_read_b64_tr_b16 a[146:147], v31 offset:41472
    s_lshl_b32 s76, s76, 6
    s_add_u32 s76, s76, s77
    s_add_u32 s5, s76, s80
    s_mul_i32 s76, s49, 36
    v_mfma_f32_32x32x16_bf16 v[112:127], a[148:151], a[64:67], v[112:127]
    s_add_u32 m0, s51, 0x20000
    s_mul_i32 s83, s92, 0x6c0
    s_add_u32 s83, s83, s71
    buffer_load_dwordx4 v16, s[12:15], s83 offen lds
    v_mfma_f32_32x32x16_bf16 v[96:111], a[152:155], a[68:71], v[96:111]
    ds_read_b64_tr_b16 a[148:149], v34 offset:40960
    ds_read_b64_tr_b16 a[150:151], v34 offset:41472
    ds_read_b64_tr_b16 a[152:153], v31 offset:43008
    ds_read_b64_tr_b16 a[154:155], v31 offset:43520
    s_waitcnt vmcnt(13)
    ds_read_b128 a[112:115], v12 offset:8192
    s_waitcnt lgkmcnt(9)
    v_mfma_f32_32x32x16_bf16 v[112:127], a[156:159], a[68:71], v[112:127]
    buffer_load_dwordx4 v17, s[12:15], s83 offen offset:1024 lds
    ds_read_b64_tr_b16 a[156:157], v34 offset:43008
    ds_read_b64_tr_b16 a[158:159], v34 offset:43520
    ds_read_b128 a[116:119], v13 offset:8192
    v_mfma_f32_32x32x16_bf16 v[96:111], a[160:163], a[72:75], v[96:111]
    ds_read_b64_tr_b16 a[160:161], v31 offset:45056
    ds_read_b64_tr_b16 a[162:163], v31 offset:45568
    ds_read_b128 a[120:123], v14 offset:8192
    ds_read_b128 a[124:127], v15 offset:8192
    s_mov_b32 s92, -1
    v_mfma_f32_32x32x16_bf16 v[112:127], a[164:167], a[72:75], v[112:127]
    s_add_u32 m0, s51, 0x22000
    s_mul_i32 s84, s93, 0x6c0
    s_add_u32 s84, s84, s71
    buffer_load_dwordx4 v16, s[12:15], s84 offen lds
    v_mfma_f32_32x32x16_bf16 v[96:111], a[168:171], a[76:79], v[96:111]
    ds_read_b64_tr_b16 a[164:165], v34 offset:45056
    ds_read_b64_tr_b16 a[166:167], v34 offset:45568
    ds_read_b64_tr_b16 a[168:169], v31 offset:47104
    ds_read_b64_tr_b16 a[170:171], v31 offset:47616
    s_waitcnt vmcnt(11)
    ds_read_b128 a[128:131], v12 offset:16384
    s_waitcnt lgkmcnt(12)
    v_mfma_f32_32x32x16_bf16 v[112:127], a[172:175], a[76:79], v[112:127]
    buffer_load_dwordx4 v17, s[12:15], s84 offen offset:1024 lds
    ds_read_b64_tr_b16 a[172:173], v34 offset:47104
    ds_read_b64_tr_b16 a[174:175], v34 offset:47616
    ds_read_b128 a[132:135], v13 offset:16384
    v_mfma_f32_32x32x16_bf16 v[96:111], a[144:147], a[80:83], v[96:111]
    ds_read_b128 a[136:139], v14 offset:16384
    ds_read_b128 a[140:143], v15 offset:16384
    s_mov_b32 s93, 0
    v_bfi_b32 v12, s98, v232, v233
    v_bfi_b32 v13, s98, v234, v235
    v_bfi_b32 v14, s98, v236, v237
    v_mfma_f32_32x32x16_bf16 v[112:127], a[148:151], a[80:83], v[112:127]
    s_add_u32 m0, s51, 0
    s_add_u32 s83, s56, s65
    buffer_load_dwordx4 v18, s[16:19], s83 offen lds
L_pad43:
    s_cbranch_execz L_wret
    v_bfi_b32 v15, s98, v238, v239
    v_mfma_f32_32x32x16_bf16 v[96:111], a[152:155], a[84:87], v[96:111]
    s_waitcnt vmcnt(7)
    s_barrier
    ds_read_b64_tr_b16 a[144:145], v32 offset:0
    ds_read_b64_tr_b16 a[146:147], v32 offset:512
    ds_read_b64_tr_b16 a[148:149], v35 offset:0
    ds_read_b64_tr_b16 a[150:151], v35 offset:512
    s_waitcnt lgkmcnt(9)
    v_mfma_f32_32x32x16_bf16 v[112:127], a[156:159], a[84:87], v[112:127]
    buffer_load_dwordx4 v19, s[16:19], s83 offen offset:1024 lds
    ds_read_b64_tr_b16 a[152:153], v32 offset:2048
    ds_read_b64_tr_b16 a[154:155], v32 offset:2560
    ds_read_b64_tr_b16 a[156:157], v35 offset:2048
    v_mfma_f32_32x32x16_bf16 v[96:111], a[160:163], a[88:91], v[96:111]
    ds_read_b64_tr_b16 a[158:159], v35 offset:2560
    ds_read_b64_tr_b16 a[160:161], v32 offset:4096
    ds_read_b64_tr_b16 a[162:163], v32 offset:4608
    s_cmp_eq_u32 s50, 0
    s_cselect_b32 s5, s70, s5
    v_mfma_f32_32x32x16_bf16 v[112:127], a[164:167], a[88:91], v[112:127]
    s_add_u32 m0, s51, 0x2000
    s_add_u32 s84, s57, s65
    buffer_load_dwordx4 v18, s[16:19], s84 offen lds
    ds_read_b64_tr_b16 a[164:165], v35 offset:4096
    v_mfma_f32_32x32x16_bf16 v[96:111], a[168:171], a[92:95], v[96:111]
    ds_read_b64_tr_b16 a[166:167], v35 offset:4608
    ds_read_b64_tr_b16 a[168:169], v32 offset:6144
    ds_read_b64_tr_b16 a[170:171], v32 offset:6656
    s_waitcnt lgkmcnt(11)
    v_mfma_f32_32x32x16_bf16 v[112:127], a[172:175], a[92:95], v[112:127]
    buffer_load_dwordx4 v19, s[16:19], s84 offen offset:1024 lds
    ds_read_b64_tr_b16 a[172:173], v35 offset:6144
    ds_read_b64_tr_b16 a[174:175], v35 offset:6656
    v_mfma_f32_32x32x16_bf16 v[64:79], a[96:99], a[144:147], v[64:79]
    ds_read_b64_tr_b16 a[144:145], v32 offset:8192
    ds_read_b64_tr_b16 a[146:147], v32 offset:8704
    s_waitcnt lgkmcnt(8)
    v_mfma_f32_32x32x16_bf16 v[80:95], a[96:99], a[148:151], v[80:95]
    s_add_u32 m0, s51, 0x4000
    s_add_u32 s83, s58, s65
    buffer_load_dwordx4 v18, s[16:19], s83 offen lds
    ds_read_b64_tr_b16 a[148:149], v35 offset:8192
    v_mfma_f32_32x32x16_bf16 v[64:79], a[100:103], a[152:155], v[64:79]
    ds_read_b64_tr_b16 a[150:151], v35 offset:8704
    ds_read_b64_tr_b16 a[152:153], v32 offset:10240
    ds_read_b64_tr_b16 a[154:155], v32 offset:10752
    v_mfma_f32_32x32x16_bf16 v[80:95], a[100:103], a[156:159], v[80:95]
    buffer_load_dwordx4 v19, s[16:19], s83 offen offset:1024 lds
    ds_read_b64_tr_b16 a[156:157], v35 offset:10240
    ds_read_b64_tr_b16 a[158:159], v35 offset:10752
    v_mfma_f32_32x32x16_bf16 v[64:79], a[104:107], a[160:163], v[64:79]
    ds_read_b64_tr_b16 a[160:161], v32 offset:12288
    ds_read_b64_tr_b16 a[162:163], v32 offset:12800
    s_waitcnt lgkmcnt(8)
    v_mfma_f32_32x32x16_bf16 v[80:95], a[104:107], a[164:167], v[80:95]
    s_add_u32 m0, s51, 0x6000
    s_add_u32 s84, s59, s65
    buffer_load_dwordx4 v18, s[16:19], s84 offen lds
    ds_read_b64_tr_b16 a[164:165], v35 offset:12288
    v_mfma_f32_32x32x16_bf16 v[64:79], a[108:111], a[168:171], v[64:79]
    ds_read_b64_tr_b16 a[166:167], v35 offset:12800
    ds_read_b64_tr_b16 a[168:169], v32 offset:14336
    ds_read_b64_tr_b16 a[170:171], v32 offset:14848
    v_mfma_f32_32x32x16_bf16 v[80:95], a[108:111], a[172:175], v[80:95]
    buffer_load_dwordx4 v19, s[16:19], s84 offen offset:1024 lds
    ds_read_b64_tr_b16 a[172:173], v35 offset:14336
    ds_read_b64_tr_b16 a[174:175], v35 offset:14848
    v_mfma_f32_32x32x16_bf16 v[64:79], a[112:115], a[144:147], v[64:79]
L_pad44:
    s_cbranch_execz L_wret
    ds_read_b64_tr_b16 a[144:145], v32 offset:16384
    ds_read_b64_tr_b16 a[146:147], v32 offset:16896
    s_waitcnt lgkmcnt(8)
    v_mfma_f32_32x32x16_bf16 v[80:95], a[112:115], a[148:151], v[80:95]
    s_add_u32 m0, s51, 0x8000
    s_add_u32 s83, s60, s65
    buffer_load_dwordx4 v18, s[16:19], s83 offen lds
    ds_read_b64_tr_b16 a[148:149], v35 offset:16384
    v_mfma_f32_32x32x16_bf16 v[64:79], a[116:119], a[152:155], v[64:79]
    ds_read_b64_tr_b16 a[150:151], v35 offset:16896
    ds_read_b64_tr_b16 a[152:153], v32 offset:18432
    ds_read_b64_tr_b16 a[154:155], v32 offset:18944
    v_mfma_f32_32x32x16_bf16 v[80:95], a[116:119], a[156:159], v[80:95]
    buffer_load_dwordx4 v19, s[16:19], s83 offen offset:1024 lds
    ds_read_b64_tr_b16 a[156:157], v35 offset:18432
    ds_read_b64_tr_b16 a[158:159], v35 offset:18944
    v_mfma_f32_32x32x16_bf16 v[64:79], a[120:123], a[160:163], v[64:79]
    ds_read_b64_tr_b16 a[160:161], v32 offset:20480
    ds_read_b64_tr_b16 a[162:163], v32 offset:20992
    s_waitcnt lgkmcnt(8)
    v_mfma_f32_32x32x16_bf16 v[80:95], a[120:123], a[164:167], v[80:95]
    s_add_u32 m0, s51, 0xa000
    s_add_u32 s84, s61, s65
    buffer_load_dwordx4 v18, s[16:19], s84 offen lds
    ds_read_b64_tr_b16 a[164:165], v35 offset:20480
    v_mfma_f32_32x32x16_bf16 v[64:79], a[124:127], a[168:171], v[64:79]
    ds_read_b64_tr_b16 a[166:167], v35 offset:20992
    ds_read_b64_tr_b16 a[168:169], v32 offset:22528
    ds_read_b64_tr_b16 a[170:171], v32 offset:23040
    v_mfma_f32_32x32x16_bf16 v[80:95], a[124:127], a[172:175], v[80:95]
    buffer_load_dwordx4 v19, s[16:19], s84 offen offset:1024 lds
    ds_read_b64_tr_b16 a[172:173], v35 offset:22528
    ds_read_b64_tr_b16 a[174:175], v35 offset:23040
    v_mfma_f32_32x32x16_bf16 v[64:79], a[128:131], a[144:147], v[64:79]
    s_cmp_eq_u32 s50, 1
    s_cselect_b32 s5, s76, s5
    s_cselect_b32 s77, 18, 16
    s_cselect_b64 s[8:9], s[24:25], s[20:21]
    s_cselect_b32 s10, s26, s22
    s_add_u32 s70, s5, s77
    s_waitcnt lgkmcnt(6)
    v_mfma_f32_32x32x16_bf16 v[80:95], a[128:131], a[148:151], v[80:95]
    s_add_u32 m0, s51, 0xc000
    s_add_u32 s83, s62, s65
    buffer_load_dwordx4 v18, s[16:19], s83 offen lds
    s_lshr_b32 s76, s50, 1
    v_mfma_f32_32x32x16_bf16 v[64:79], a[132:135], a[152:155], v[64:79]
    s_waitcnt vmcnt(13)
    s_barrier
    ds_read_b64_tr_b16 a[144:145], v32 offset:24576
    ds_read_b64_tr_b16 a[146:147], v32 offset:25088
    ds_read_b64_tr_b16 a[148:149], v35 offset:24576
    ds_read_b64_tr_b16 a[150:151], v35 offset:25088
    v_mfma_f32_32x32x16_bf16 v[80:95], a[132:135], a[156:159], v[80:95]
    buffer_load_dwordx4 v19, s[16:19], s83 offen offset:1024 lds
    ds_read_b64_tr_b16 a[152:153], v32 offset:26624
    ds_read_b64_tr_b16 a[154:155], v32 offset:27136
    ds_read_b64_tr_b16 a[156:157], v35 offset:26624
    v_mfma_f32_32x32x16_bf16 v[64:79], a[136:139], a[160:163], v[64:79]
    ds_read_b64_tr_b16 a[158:159], v35 offset:27136
    ds_read_b64_tr_b16 a[160:161], v32 offset:28672
    ds_read_b64_tr_b16 a[162:163], v32 offset:29184
    s_add_u32 s76, s76, 1
    s_add_u32 s76, s76, s48
    s_and_b32 s76, s76, 3
    s_waitcnt lgkmcnt(10)
    v_mfma_f32_32x32x16_bf16 v[80:95], a[136:139], a[164:167], v[80:95]
    s_add_u32 m0, s51, 0xe000
    s_add_u32 s84, s63, s65
    buffer_load_dwordx4 v18, s[16:19], s84 offen lds
    ds_read_b64_tr_b16 a[164:165], v35 offset:28672
    v_mfma_f32_32x32x16_bf16 v[64:79], a[140:143], a[168:171], v[64:79]
    ds_read_b64_tr_b16 a[166:167], v35 offset:29184
    s_nop 0
L_pad45:
    s_cbranch_execz L_wret
    ds_read_b64_tr_b16 a[168:169], v32 offset:30720
    ds_read_b64_tr_b16 a[170:171], v32 offset:31232
    s_lshl_b32 s76, s76, 6
    s_and_b32 s77, s50, 1
    s_lshl_b32 s77, s77, 5
    v_mfma_f32_32x32x16_bf16 v[80:95], a[140:143], a[172:175], v[80:95]
    buffer_load_dwordx4 v19, s[16:19], s84 offen offset:1024 lds
    ds_read_b64_tr_b16 a[172:173], v35 offset:30720
    ds_read_b64_tr_b16 a[174:175], v35 offset:31232
    s_add_u32 s76, s76, s77
    s_waitcnt lgkmcnt(10)
    v_mfma_f32_32x32x16_bf16 v[96:111], a[144:147], a[96:99], v[96:111]
    ds_read_b64_tr_b16 a[144:145], v32 offset:32768
    ds_read_b64_tr_b16 a[146:147], v32 offset:33280
    v_cvt_pk_bf16_f32 v240, v64, v65
    v_cvt_pk_bf16_f32 v241, v66, v67
    v_cvt_pk_bf16_f32 v242, v68, v69
    v_cvt_pk_bf16_f32 v243, v70, v71
    v_mfma_f32_32x32x16_bf16 v[112:127], a[148:151], a[96:99], v[112:127]
    s_add_u32 m0, s51, 0x10000
    s_add_u32 s83, s64, s65
    buffer_load_dwordx4 v18, s[16:19], s83 offen lds
    ds_read_b64_tr_b16 a[148:149], v35 offset:32768
    v_mfma_f32_32x32x16_bf16 v[96:111], a[152:155], a[100:103], v[96:111]
    ds_read_b64_tr_b16 a[150:151], v35 offset:33280
    ds_read_b64_tr_b16 a[152:153], v32 offset:34816
    ds_read_b64_tr_b16 a[154:155], v32 offset:35328
    v_cvt_pk_bf16_f32 v244, v72, v73
    v_cvt_pk_bf16_f32 v245, v74, v75
    v_cvt_pk_bf16_f32 v246, v76, v77
    s_waitcnt lgkmcnt(8)
    v_mfma_f32_32x32x16_bf16 v[112:127], a[156:159], a[100:103], v[112:127]
    buffer_load_dwordx4 v19, s[16:19], s83 offen offset:1024 lds
    ds_read_b64_tr_b16 a[156:157], v35 offset:34816
    ds_read_b64_tr_b16 a[158:159], v35 offset:35328
    v_cvt_pk_bf16_f32 v247, v78, v79
    v_mfma_f32_32x32x16_bf16 v[96:111], a[160:163], a[104:107], v[96:111]
    ds_read_b64_tr_b16 a[160:161], v32 offset:36864
    ds_read_b64_tr_b16 a[162:163], v32 offset:37376
    v_permlane32_swap_b32 v240, v242
    v_permlane32_swap_b32 v241, v243
    v_permlane32_swap_b32 v244, v246
    v_permlane32_swap_b32 v245, v247
    v_mfma_f32_32x32x16_bf16 v[112:127], a[164:167], a[104:107], v[112:127]
    s_add_u32 m0, s51, 0x12000
    s_add_u32 s84, s56, s66
    buffer_load_dwordx4 v18, s[16:19], s84 offen lds
    ds_read_b64_tr_b16 a[164:165], v35 offset:36864
    v_mfma_f32_32x32x16_bf16 v[96:111], a[168:171], a[108:111], v[96:111]
    ds_read_b64_tr_b16 a[166:167], v35 offset:37376
    ds_read_b64_tr_b16 a[168:169], v32 offset:38912
    ds_read_b64_tr_b16 a[170:171], v32 offset:39424
    v_cvt_pk_bf16_f32 v248, v80, v81
    v_cvt_pk_bf16_f32 v249, v82, v83
    v_cvt_pk_bf16_f32 v250, v84, v85
    s_waitcnt lgkmcnt(8)
    v_mfma_f32_32x32x16_bf16 v[112:127], a[172:175], a[108:111], v[112:127]
    buffer_load_dwordx4 v19, s[16:19], s84 offen offset:1024 lds
    ds_read_b64_tr_b16 a[172:173], v35 offset:38912
    ds_read_b64_tr_b16 a[174:175], v35 offset:39424
    v_cvt_pk_bf16_f32 v251, v86, v87
    v_mfma_f32_32x32x16_bf16 v[96:111], a[144:147], a[112:115], v[96:111]
    ds_read_b64_tr_b16 a[144:145], v32 offset:40960
    ds_read_b64_tr_b16 a[146:147], v32 offset:41472
    v_cvt_pk_bf16_f32 v252, v88, v89
    buffer_store_dwordx4 v[240:243], v44, s[28:31], s72 offen sc1
    v_mfma_f32_32x32x16_bf16 v[112:127], a[148:151], a[112:115], v[112:127]
    ds_read_b64_tr_b16 a[148:149], v35 offset:40960
    ds_read_b64_tr_b16 a[150:151], v35 offset:41472
    v_cvt_pk_bf16_f32 v253, v90, v91
L_pad46:
    s_cbranch_execz L_wret
    v_cvt_pk_bf16_f32 v254, v92, v93
    v_cvt_pk_bf16_f32 v255, v94, v95
    v_permlane32_swap_b32 v248, v250
    v_mfma_f32_32x32x16_bf16 v[96:111], a[152:155], a[116:119], v[96:111]
    s_add_u32 m0, s51, 0x14000
    s_add_u32 s83, s57, s66
    buffer_load_dwordx4 v18, s[16:19], s83 offen lds
    ds_read_b64_tr_b16 a[152:153], v32 offset:43008
    s_waitcnt lgkmcnt(7)
    v_mfma_f32_32x32x16_bf16 v[112:127], a[156:159], a[116:119], v[112:127]
    ds_read_b64_tr_b16 a[154:155], v32 offset:43520
    ds_read_b64_tr_b16 a[156:157], v35 offset:43008
    ds_read_b64_tr_b16 a[158:159], v35 offset:43520
    v_permlane32_swap_b32 v249, v251
    v_permlane32_swap_b32 v252, v254
    v_permlane32_swap_b32 v253, v255
    v_mfma_f32_32x32x16_bf16 v[96:111], a[160:163], a[120:123], v[96:111]
    buffer_load_dwordx4 v19, s[16:19], s83 offen offset:1024 lds
    ds_read_b64_tr_b16 a[160:161], v32 offset:45056
    ds_read_b64_tr_b16 a[162:163], v32 offset:45568
    s_add_u32 s6, s76, s80
    v_mfma_f32_32x32x16_bf16 v[112:127], a[164:167], a[120:123], v[112:127]
    ds_read_b64_tr_b16 a[164:165], v35 offset:45056
    ds_read_b64_tr_b16 a[166:167], v35 offset:45568
    s_mov_b32 s76, 3
    buffer_store_dwordx4 v[244:247], v44, s[28:31], s73 offen sc1
    v_mfma_f32_32x32x16_bf16 v[96:111], a[168:171], a[124:127], v[96:111]
    ds_read_b64_tr_b16 a[168:169], v32 offset:47104
    ds_read_b64_tr_b16 a[170:171], v32 offset:47616
    s_add_u32 s76, s76, s48
    s_and_b32 s76, s76, 3
    s_lshl_b32 s76, s76, 6
    s_and_b32 s77, s50, 1
    s_waitcnt lgkmcnt(10)
    v_mfma_f32_32x32x16_bf16 v[112:127], a[172:175], a[124:127], v[112:127]
    s_add_u32 m0, s51, 0x16000
    s_add_u32 s84, s58, s66
    buffer_load_dwordx4 v18, s[16:19], s84 offen lds
    ds_read_b64_tr_b16 a[172:173], v35 offset:47104
    v_mfma_f32_32x32x16_bf16 v[96:111], a[144:147], a[128:131], v[96:111]
    ds_read_b64_tr_b16 a[174:175], v35 offset:47616
    s_waitcnt vmcnt(19)
    s_barrier
    ds_read_b64_tr_b16 a[144:145], v30 offset:0
    ds_read_b64_tr_b16 a[146:147], v30 offset:512
    s_lshl_b32 s77, s77, 5
    v_mfma_f32_32x32x16_bf16 v[112:127], a[148:151], a[128:131], v[112:127]
    buffer_load_dwordx4 v19, s[16:19], s84 offen offset:1024 lds
    ds_read_b64_tr_b16 a[148:149], v33 offset:0
    ds_read_b64_tr_b16 a[150:151], v33 offset:512
    s_add_u32 s76, s76, s77
    s_waitcnt lgkmcnt(8)
    v_mfma_f32_32x32x16_bf16 v[96:111], a[152:155], a[132:135], v[96:111]
    ds_read_b64_tr_b16 a[152:153], v30 offset:2048
    ds_read_b64_tr_b16 a[154:155], v30 offset:2560
    buffer_store_dwordx4 v[248:251], v44, s[28:31], s72 offen offset:512 sc1
    s_add_u32 s7, s76, s80
    v_mfma_f32_32x32x16_bf16 v[112:127], a[156:159], a[132:135], v[112:127]
    ds_read_b64_tr_b16 a[156:157], v33 offset:2048
    ds_read_b64_tr_b16 a[158:159], v33 offset:2560
    s_cmp_eq_u32 s50, 2
    s_cselect_b32 s7, s81, s7
    s_mul_i32 s76, s82, 36
    s_mul_i32 s5, s5, 0x480
    v_mfma_f32_32x32x16_bf16 v[96:111], a[160:163], a[136:139], v[96:111]
    ds_read_b64_tr_b16 a[160:161], v30 offset:4096
    ds_read_b64_tr_b16 a[162:163], v30 offset:4608
    buffer_store_dwordx4 v[252:255], v44, s[28:31], s73 offen offset:512 sc1
    s_mul_i32 s6, s6, 0x480
    v_mfma_f32_32x32x16_bf16 v[112:127], a[164:167], a[136:139], v[112:127]
    ds_read_b64_tr_b16 a[164:165], v33 offset:4096
    ds_read_b64_tr_b16 a[166:167], v33 offset:4608
    s_mul_i32 s70, s70, 0x480
    s_waitcnt lgkmcnt(8)
    v_mfma_f32_32x32x16_bf16 v[96:111], a[168:171], a[140:143], v[96:111]
    s_cmp_eq_u32 s50, 3
L_pad47:
    s_cbranch_execz L_wret
    s_cselect_b32 s7, s76, s7
    s_cselect_b32 s77, 18, 16
    s_cselect_b64 s[12:13], s[24:25], s[20:21]
    s_cselect_b32 s14, s26, s22
    s_add_u32 s71, s7, s77
    v_mfma_f32_32x32x16_bf16 v[112:127], a[172:175], a[140:143], v[112:127]
    s_mul_i32 s7, s7, 0x480
    s_mul_i32 s71, s71, 0x480
    s_and_b32 s76, s49, 1
    s_mul_i32 s76, s76, 0x240
    s_mul_i32 s77, s48, 11
    s_lshr_b32 s77, s77, 5
    s_mul_i32 s77, s77, 3
    s_sub_u32 s77, s48, s77
    s_mul_i32 s97, s77, 0xc0
    s_mov_b32 s78, s97
    s_add_u32 s87, s78, s76
    s_add_u32 s78, s78, 0xc0
    s_cmp_ge_u32 s78, 0x240
    s_cselect_b32 s78, 0, s78
    s_add_u32 s88, s78, s76
    s_add_u32 s78, s78, 0xc0
    s_cmp_ge_u32 s78, 0x240
    s_cselect_b32 s78, 0, s78
    s_add_u32 s73, s78, s76
    s_lshr_b32 s77, s50, 1
    s_xor_b32 s77, s77, s49
    s_mul_i32 s77, s77, 36
    s_and_b32 s78, s50, 1
    s_mul_i32 s78, s78, 18
    s_add_u32 s77, s77, s78
    s_add_u32 s77, s77, 16
    s_mul_i32 s77, s77, 0x480
    s_add_u32 s55, s77, s76
    s_waitcnt lgkmcnt(0)
    s_nop 0
    s_nop 15
L_join:
    v_mfma_f32_32x32x16_bf16 v[64:79], a[144:147], a[0:3], 0
    s_add_u32 m0, s51, 0x18000
    s_add_u32 s83, s59, s66
    buffer_load_dwordx4 v18, s[16:19], s83 offen lds
    ds_read_b64_tr_b16 a[168:169], v30 offset:6144
    v_mfma_f32_32x32x16_bf16 v[80:95], a[148:151], a[0:3], 0
    ds_read_b64_tr_b16 a[170:171], v30 offset:6656
    ds_read_b64_tr_b16 a[172:173], v33 offset:6144
    ds_read_b64_tr_b16 a[174:175], v33 offset:6656
    ds_read_b64_tr_b16 a[144:145], v30 offset:8192
    ds_read_b64_tr_b16 a[146:147], v30 offset:8704
    ds_read_b64_tr_b16 a[148:149], v33 offset:8192
    v_mfma_f32_32x32x16_bf16 v[64:79], a[152:155], a[4:7], v[64:79]
    ds_read_b64_tr_b16 a[150:151], v33 offset:8704
    ds_read_b64_tr_b16 a[152:153], v30 offset:10240
    ds_read_b64_tr_b16 a[154:155], v30 offset:10752
    v_mov_b32 v58, 1
    v_mul_f32 v96, s75, v96
    v_mul_f32 v97, s75, v97
    v_mfma_f32_32x32x16_bf16 v[80:95], a[156:159], a[4:7], v[80:95]
    buffer_load_dwordx4 v19, s[16:19], s83 offen offset:1024 lds
    ds_read_b64_tr_b16 a[156:157], v33 offset:10240
    ds_read_b64_tr_b16 a[158:159], v33 offset:10752
    v_mul_f32 v98, s75, v98
    v_mfma_f32_32x32x16_bf16 v[64:79], a[160:163], a[8:11], v[64:79]
    ds_read_b64_tr_b16 a[160:161], v30 offset:12288
    ds_read_b64_tr_b16 a[162:163], v30 offset:12800
    v_mul_f32 v99, s75, v99
    v_mul_f32 v100, s75, v100
    v_mul_f32 v101, s75, v101
    v_mul_f32 v102, s75, v102
    v_mfma_f32_32x32x16_bf16 v[80:95], a[164:167], a[8:11], v[80:95]
    ds_read_b64_tr_b16 a[164:165], v33 offset:12288
    ds_read_b64_tr_b16 a[166:167], v33 offset:12800
    v_mul_f32 v103, s75, v103
    v_mul_f32 v104, s75, v104
    v_mul_f32 v105, s75, v105
    v_mul_f32 v106, s75, v106
    s_waitcnt lgkmcnt(11)
    v_mfma_f32_32x32x16_bf16 v[64:79], a[168:171], a[12:15], v[64:79]
    s_add_u32 m0, s51, 0x1a000
    s_add_u32 s84, s60, s66
    buffer_load_dwordx4 v18, s[16:19], s84 offen lds
    ds_read_b64_tr_b16 a[168:169], v30 offset:14336
    v_mfma_f32_32x32x16_bf16 v[80:95], a[172:175], a[12:15], v[80:95]
    ds_read_b64_tr_b16 a[170:171], v30 offset:14848
    ds_read_b64_tr_b16 a[172:173], v33 offset:14336
    s_nop 0
L_pad48:
    s_cbranch_execz L_wret
    ds_read_b64_tr_b16 a[174:175], v33 offset:14848
    v_mul_f32 v107, s75, v107
    v_mul_f32 v108, s75, v108
    v_mul_f32 v109, s75, v109
    s_waitcnt lgkmcnt(8)
    v_mfma_f32_32x32x16_bf16 v[64:79], a[144:147], a[16:19], v[64:79]
    ds_read_b64_tr_b16 a[144:145], v30 offset:16384
    ds_read_b64_tr_b16 a[146:147], v30 offset:16896
    v_mul_f32 v110, s75, v110
    v_mul_f32 v111, s75, v111
    v_cvt_pk_bf16_f32 v240, v96, v97
    v_cvt_pk_bf16_f32 v241, v98, v99
    v_mfma_f32_32x32x16_bf16 v[80:95], a[148:151], a[16:19], v[80:95]
    buffer_load_dwordx4 v19, s[16:19], s84 offen offset:1024 lds
    ds_read_b64_tr_b16 a[148:149], v33 offset:16384
    ds_read_b64_tr_b16 a[150:151], v33 offset:16896
    v_cvt_pk_bf16_f32 v242, v100, v101
    v_mfma_f32_32x32x16_bf16 v[64:79], a[152:155], a[20:23], v[64:79]
    ds_read_b64_tr_b16 a[152:153], v30 offset:18432
    ds_read_b64_tr_b16 a[154:155], v30 offset:18944
    v_cvt_pk_bf16_f32 v243, v102, v103
    v_cvt_pk_bf16_f32 v244, v104, v105
    v_cvt_pk_bf16_f32 v245, v106, v107
    v_cvt_pk_bf16_f32 v246, v108, v109
    v_mfma_f32_32x32x16_bf16 v[80:95], a[156:159], a[20:23], v[80:95]
    ds_read_b64_tr_b16 a[156:157], v33 offset:18432
    ds_read_b64_tr_b16 a[158:159], v33 offset:18944
    v_cvt_pk_bf16_f32 v247, v110, v111
    v_permlane32_swap_b32 v240, v242
    v_permlane32_swap_b32 v241, v243
    v_permlane32_swap_b32 v244, v246
    s_waitcnt lgkmcnt(8)
    v_mfma_f32_32x32x16_bf16 v[64:79], a[160:163], a[24:27], v[64:79]
    s_add_u32 m0, s51, 0x1c000
    s_add_u32 s83, s61, s66
    buffer_load_dwordx4 v18, s[16:19], s83 offen lds
    ds_read_b64_tr_b16 a[160:161], v30 offset:20480
    v_mfma_f32_32x32x16_bf16 v[80:95], a[164:167], a[24:27], v[80:95]
    ds_read_b64_tr_b16 a[162:163], v30 offset:20992
    ds_read_b64_tr_b16 a[164:165], v33 offset:20480
    ds_read_b64_tr_b16 a[166:167], v33 offset:20992
    v_permlane32_swap_b32 v245, v247
    v_mul_f32 v112, s75, v112
    v_mul_f32 v113, s75, v113
    v_mfma_f32_32x32x16_bf16 v[64:79], a[168:171], a[28:31], v[64:79]
    ds_read_b64_tr_b16 a[168:169], v30 offset:22528
    ds_read_b64_tr_b16 a[170:171], v30 offset:23040
    v_mul_f32 v114, s75, v114
    v_mul_f32 v115, s75, v115
    v_mul_f32 v116, s75, v116
    v_mul_f32 v117, s75, v117
    v_mfma_f32_32x32x16_bf16 v[80:95], a[172:175], a[28:31], v[80:95]
    buffer_load_dwordx4 v19, s[16:19], s83 offen offset:1024 lds
    ds_read_b64_tr_b16 a[172:173], v33 offset:22528
    ds_read_b64_tr_b16 a[174:175], v33 offset:23040
    v_mul_f32 v118, s75, v118
    s_waitcnt lgkmcnt(8)
    v_mfma_f32_32x32x16_bf16 v[64:79], a[144:147], a[32:35], v[64:79]
    v_mul_f32 v119, s75, v119
    v_mul_f32 v120, s75, v120
    v_mul_f32 v121, s75, v121
    v_mul_f32 v122, s75, v122
    v_mul_f32 v123, s75, v123
    v_mul_f32 v124, s75, v124
    v_mfma_f32_32x32x16_bf16 v[80:95], a[148:151], a[32:35], v[80:95]
    v_mul_f32 v125, s75, v125
    v_mul_f32 v126, s75, v126
    buffer_store_dwordx4 v[240:243], v45, s[28:31], s74 offen sc1
    v_mul_f32 v127, s75, v127
    v_mfma_f32_32x32x16_bf16 v[64:79], a[152:155], a[36:39], v[64:79]
    s_waitcnt vmcnt(20)
    s_barrier
    ds_read_b64_tr_b16 a[144:145], v30 offset:24576
    ds_read_b64_tr_b16 a[146:147], v30 offset:25088
    ds_read_b64_tr_b16 a[148:149], v33 offset:24576
    ds_read_b64_tr_b16 a[150:151], v33 offset:25088
    v_mfma_f32_32x32x16_bf16 v[80:95], a[156:159], a[36:39], v[80:95]
    ds_read_b64_tr_b16 a[152:153], v30 offset:26624
    ds_read_b64_tr_b16 a[154:155], v30 offset:27136
L_pad49:
    s_cbranch_execz L_wret
    ds_read_b64_tr_b16 a[156:157], v33 offset:26624
    ds_read_b64_tr_b16 a[158:159], v33 offset:27136
    v_cvt_pk_bf16_f32 v248, v112, v113
    v_cvt_pk_bf16_f32 v249, v114, v115
    s_waitcnt lgkmcnt(8)
    v_mfma_f32_32x32x16_bf16 v[64:79], a[160:163], a[40:43], v[64:79]
    s_add_u32 m0, s51, 0x1e000
    s_add_u32 s84, s62, s66
    buffer_load_dwordx4 v18, s[16:19], s84 offen lds
    ds_read_b64_tr_b16 a[160:161], v30 offset:28672
    v_mfma_f32_32x32x16_bf16 v[80:95], a[164:167], a[40:43], v[80:95]
    ds_read_b64_tr_b16 a[162:163], v30 offset:29184
    ds_read_b64_tr_b16 a[164:165], v33 offset:28672
    ds_read_b64_tr_b16 a[166:167], v33 offset:29184
    v_cvt_pk_bf16_f32 v250, v116, v117
    v_cvt_pk_bf16_f32 v251, v118, v119
    v_cvt_pk_bf16_f32 v252, v120, v121
    v_mfma_f32_32x32x16_bf16 v[64:79], a[168:171], a[44:47], v[64:79]
    ds_read_b64_tr_b16 a[168:169], v30 offset:30720
    ds_read_b64_tr_b16 a[170:171], v30 offset:31232
    v_cvt_pk_bf16_f32 v253, v122, v123
    v_cvt_pk_bf16_f32 v254, v124, v125
    v_cvt_pk_bf16_f32 v255, v126, v127
    v_permlane32_swap_b32 v248, v250
    v_mfma_f32_32x32x16_bf16 v[80:95], a[172:175], a[44:47], v[80:95]
    buffer_load_dwordx4 v19, s[16:19], s84 offen offset:1024 lds
    ds_read_b64_tr_b16 a[172:173], v33 offset:30720
    ds_read_b64_tr_b16 a[174:175], v33 offset:31232
    v_permlane32_swap_b32 v249, v251
    s_waitcnt lgkmcnt(8)
    v_mfma_f32_32x32x16_bf16 v[64:79], a[144:147], a[48:51], v[64:79]
    ds_read_b64_tr_b16 a[144:145], v30 offset:32768
    ds_read_b64_tr_b16 a[146:147], v30 offset:33280
    v_permlane32_swap_b32 v252, v254
    v_permlane32_swap_b32 v253, v255
    s_mul_i32 s76, s49, 9
    s_lshr_b32 s76, s76, 1
    v_mfma_f32_32x32x16_bf16 v[80:95], a[148:151], a[48:51], v[80:95]
    ds_read_b64_tr_b16 a[148:149], v33 offset:32768
    ds_read_b64_tr_b16 a[150:151], v33 offset:33280
    buffer_store_dwordx4 v[244:247], v45, s[28:31], s74 offen offset:1024 sc1
    s_lshl_b32 s76, s76, 9
    v_mfma_f32_32x32x16_bf16 v[64:79], a[152:155], a[52:55], v[64:79]
    ds_read_b64_tr_b16 a[152:153], v30 offset:34816
    ds_read_b64_tr_b16 a[154:155], v30 offset:35328
    s_mul_i32 s77, s89, 0x1b200
    s_add_u32 s81, s76, s77
    v_lshlrev_b32 v7, 4, v60
    s_lshl_b32 s78, s89, 8
    v_mfma_f32_32x32x16_bf16 v[80:95], a[156:159], a[52:55], v[80:95]
    ds_read_b64_tr_b16 a[156:157], v33 offset:34816
    ds_read_b64_tr_b16 a[158:159], v33 offset:35328
    s_add_u32 s78, s78, 0x840000
    v_and_b32 v6, 31, v60
    v_lshlrev_b32 v6, 3, v6
    s_lshr_b32 s79, s49, 1
    s_waitcnt lgkmcnt(8)
    v_mfma_f32_32x32x16_bf16 v[64:79], a[160:163], a[56:59], v[64:79]
    s_add_u32 m0, s51, 0x20000
    s_add_u32 s83, s63, s66
    buffer_load_dwordx4 v18, s[16:19], s83 offen lds
    ds_read_b64_tr_b16 a[160:161], v30 offset:36864
    v_mfma_f32_32x32x16_bf16 v[80:95], a[164:167], a[56:59], v[80:95]
    ds_read_b64_tr_b16 a[162:163], v30 offset:37376
    ds_read_b64_tr_b16 a[164:165], v33 offset:36864
    ds_read_b64_tr_b16 a[166:167], v33 offset:37376
    s_lshl_b32 s79, s79, 5
    s_add_u32 s79, s79, s78
    v_and_b32 v5, 3, v60
    v_mfma_f32_32x32x16_bf16 v[64:79], a[168:171], a[60:63], v[64:79]
    ds_read_b64_tr_b16 a[168:169], v30 offset:38912
    ds_read_b64_tr_b16 a[170:171], v30 offset:39424
    v_lshlrev_b32 v5, 3, v5
    v_accvgpr_write_b32 a183, 0
    s_nop 0
L_pad50:
    s_cbranch_execz L_wret
    v_accvgpr_write_b32 a188, 0
    v_mov_b32 v44, 0xf149f2ca
    v_mfma_f32_32x32x16_bf16 v[80:95], a[172:175], a[60:63], v[80:95]
    buffer_load_dwordx4 v19, s[16:19], s83 offen offset:1024 lds
    ds_read_b64_tr_b16 a[172:173], v33 offset:38912
    ds_read_b64_tr_b16 a[174:175], v33 offset:39424
    v_bfe_u32 v1, v60, 2, 2
    s_waitcnt lgkmcnt(8)
    v_mfma_f32_32x32x16_bf16 v[64:79], a[144:147], a[64:67], v[64:79]
    ds_read_b64_tr_b16 a[144:145], v30 offset:40960
    ds_read_b64_tr_b16 a[146:147], v30 offset:41472
    s_cmp_ge_u32 s89, 7
    s_mov_b32 s99, 0xf149f2ca
    s_cselect_b32 s99, 0x7f800000, s99
    v_and_b32 v2, 3, v60
    v_mfma_f32_32x32x16_bf16 v[80:95], a[148:151], a[64:67], v[80:95]
    ds_read_b64_tr_b16 a[148:149], v33 offset:40960
    ds_read_b64_tr_b16 a[150:151], v33 offset:41472
    buffer_store_dwordx4 v[248:251], v45, s[28:31], s74 offen offset:2048 sc1
    v_bfe_u32 v3, v60, 4, 1
    v_mfma_f32_32x32x16_bf16 v[64:79], a[152:155], a[68:71], v[64:79]
    ds_read_b64_tr_b16 a[152:153], v30 offset:43008
    ds_read_b64_tr_b16 a[154:155], v30 offset:43520
    v_lshrrev_b32 v4, 5, v60
    s_and_b32 s76, s49, 1
    s_mul_i32 s76, s76, 0x240
    s_sub_u32 s76, 0x24000, s76
    v_mfma_f32_32x32x16_bf16 v[80:95], a[156:159], a[68:71], v[80:95]
    ds_read_b64_tr_b16 a[156:157], v33 offset:43008
    ds_read_b64_tr_b16 a[158:159], v33 offset:43520
    s_mov_b32 s65, 0
    s_waitcnt lgkmcnt(8)
    v_mfma_f32_32x32x16_bf16 v[64:79], a[160:163], a[72:75], v[64:79]
    s_add_u32 m0, s51, 0x22000
    s_add_u32 s84, s64, s66
    buffer_load_dwordx4 v18, s[16:19], s84 offen lds
    ds_read_b64_tr_b16 a[160:161], v30 offset:45056
    v_mfma_f32_32x32x16_bf16 v[80:95], a[164:167], a[72:75], v[80:95]
    ds_read_b64_tr_b16 a[162:163], v30 offset:45568
    ds_read_b64_tr_b16 a[164:165], v33 offset:45056
    ds_read_b64_tr_b16 a[166:167], v33 offset:45568
    v_mfma_f32_32x32x16_bf16 v[64:79], a[168:171], a[76:79], v[64:79]
    ds_read_b64_tr_b16 a[168:169], v30 offset:47104
    ds_read_b64_tr_b16 a[170:171], v30 offset:47616
    v_mfma_f32_32x32x16_bf16 v[80:95], a[172:175], a[76:79], v[80:95]
    buffer_load_dwordx4 v19, s[16:19], s84 offen offset:1024 lds
    ds_read_b64_tr_b16 a[172:173], v33 offset:47104
    ds_read_b64_tr_b16 a[174:175], v33 offset:47616
    s_waitcnt lgkmcnt(8)
    v_mfma_f32_32x32x16_bf16 v[64:79], a[144:147], a[80:83], v[64:79]
    v_mfma_f32_32x32x16_bf16 v[80:95], a[148:151], a[80:83], v[80:95]
    buffer_store_dwordx4 v[252:255], v45, s[28:31], s74 offen offset:3072 sc1
    v_mov_b32 v45, 0xf149f2ca
    v_mfma_f32_32x32x16_bf16 v[64:79], a[152:155], a[84:87], v[64:79]
    s_waitcnt vmcnt(23)
    s_barrier
    ds_read_b64_tr_b16 a[144:145], v31 offset:0
    ds_read_b64_tr_b16 a[146:147], v31 offset:512
    ds_read_b64_tr_b16 a[148:149], v34 offset:0
    ds_read_b64_tr_b16 a[150:151], v34 offset:512
    v_mfma_f32_32x32x16_bf16 v[80:95], a[156:159], a[84:87], v[80:95]
    ds_read_b64_tr_b16 a[152:153], v31 offset:2048
    ds_read_b64_tr_b16 a[154:155], v31 offset:2560
    ds_read_b64_tr_b16 a[156:157], v34 offset:2048
    ds_read_b64_tr_b16 a[158:159], v34 offset:2560
    s_waitcnt lgkmcnt(8)
    v_mfma_f32_32x32x16_bf16 v[64:79], a[160:163], a[88:91], v[64:79]
    s_add_u32 m0, s51, 0
    s_add_u32 s83, s56, s67
    buffer_load_dwordx4 v18, s[16:19], s83 offen lds
    s_nop 0
L_pad51:
    s_cbranch_execz L_wret
    ds_read_b64_tr_b16 a[160:161], v31 offset:4096
    v_mfma_f32_32x32x16_bf16 v[80:95], a[164:167], a[88:91], v[80:95]
    ds_read_b64_tr_b16 a[162:163], v31 offset:4608
    ds_read_b64_tr_b16 a[164:165], v34 offset:4096
    ds_read_b64_tr_b16 a[166:167], v34 offset:4608
    v_mfma_f32_32x32x16_bf16 v[64:79], a[168:171], a[92:95], v[64:79]
    ds_read_b64_tr_b16 a[168:169], v31 offset:6144
    ds_read_b64_tr_b16 a[170:171], v31 offset:6656
    v_mfma_f32_32x32x16_bf16 v[80:95], a[172:175], a[92:95], v[80:95]
    buffer_load_dwordx4 v19, s[16:19], s83 offen offset:1024 lds
    ds_read_b64_tr_b16 a[172:173], v34 offset:6144
    ds_read_b64_tr_b16 a[174:175], v34 offset:6656
    s_waitcnt lgkmcnt(8)
    v_mfma_f32_32x32x16_bf16 v[64:79], a[144:147], a[96:99], v[64:79]
    ds_read_b64_tr_b16 a[144:145], v31 offset:8192
    ds_read_b64_tr_b16 a[146:147], v31 offset:8704
    v_mfma_f32_32x32x16_bf16 v[80:95], a[148:151], a[96:99], v[80:95]
    ds_read_b64_tr_b16 a[148:149], v34 offset:8192
    ds_read_b64_tr_b16 a[150:151], v34 offset:8704
    v_mfma_f32_32x32x16_bf16 v[64:79], a[152:155], a[100:103], v[64:79]
    s_add_u32 m0, s51, 0x2000
    s_add_u32 s84, s57, s67
    buffer_load_dwordx4 v18, s[16:19], s84 offen lds
    ds_read_b64_tr_b16 a[152:153], v31 offset:10240
    v_mfma_f32_32x32x16_bf16 v[80:95], a[156:159], a[100:103], v[80:95]
    ds_read_b64_tr_b16 a[154:155], v31 offset:10752
    ds_read_b64_tr_b16 a[156:157], v34 offset:10240
    ds_read_b64_tr_b16 a[158:159], v34 offset:10752
    s_waitcnt lgkmcnt(8)
    v_mfma_f32_32x32x16_bf16 v[64:79], a[160:163], a[104:107], v[64:79]
    ds_read_b64_tr_b16 a[160:161], v31 offset:12288
    ds_read_b64_tr_b16 a[162:163], v31 offset:12800
    v_mfma_f32_32x32x16_bf16 v[80:95], a[164:167], a[104:107], v[80:95]
    buffer_load_dwordx4 v19, s[16:19], s84 offen offset:1024 lds
    ds_read_b64_tr_b16 a[164:165], v34 offset:12288
    ds_read_b64_tr_b16 a[166:167], v34 offset:12800
    v_mfma_f32_32x32x16_bf16 v[64:79], a[168:171], a[108:111], v[64:79]
    ds_read_b64_tr_b16 a[168:169], v31 offset:14336
    ds_read_b64_tr_b16 a[170:171], v31 offset:14848
    v_mfma_f32_32x32x16_bf16 v[80:95], a[172:175], a[108:111], v[80:95]
    ds_read_b64_tr_b16 a[172:173], v34 offset:14336
    ds_read_b64_tr_b16 a[174:175], v34 offset:14848
    s_waitcnt lgkmcnt(8)
    v_mfma_f32_32x32x16_bf16 v[64:79], a[144:147], a[112:115], v[64:79]
    s_add_u32 m0, s51, 0x4000
    s_add_u32 s83, s58, s67
    buffer_load_dwordx4 v18, s[16:19], s83 offen lds
    ds_read_b64_tr_b16 a[144:145], v31 offset:16384
    v_mfma_f32_32x32x16_bf16 v[80:95], a[148:151], a[112:115], v[80:95]
    ds_read_b64_tr_b16 a[146:147], v31 offset:16896
    ds_read_b64_tr_b16 a[148:149], v34 offset:16384
    ds_read_b64_tr_b16 a[150:151], v34 offset:16896
    v_mfma_f32_32x32x16_bf16 v[64:79], a[152:155], a[116:119], v[64:79]
    ds_read_b64_tr_b16 a[152:153], v31 offset:18432
    ds_read_b64_tr_b16 a[154:155], v31 offset:18944
    v_mfma_f32_32x32x16_bf16 v[80:95], a[156:159], a[116:119], v[80:95]
    buffer_load_dwordx4 v19, s[16:19], s83 offen offset:1024 lds
    ds_read_b64_tr_b16 a[156:157], v34 offset:18432
    ds_read_b64_tr_b16 a[158:159], v34 offset:18944
    s_waitcnt lgkmcnt(8)
    v_mfma_f32_32x32x16_bf16 v[64:79], a[160:163], a[120:123], v[64:79]
    ds_read_b64_tr_b16 a[160:161], v31 offset:20480
    ds_read_b64_tr_b16 a[162:163], v31 offset:20992
    v_mfma_f32_32x32x16_bf16 v[80:95], a[164:167], a[120:123], v[80:95]
    ds_read_b64_tr_b16 a[164:165], v34 offset:20480
    ds_read_b64_tr_b16 a[166:167], v34 offset:20992
    s_nop 0
L_pad52:
    s_cbranch_execz L_wret
    v_mfma_f32_32x32x16_bf16 v[64:79], a[168:171], a[124:127], v[64:79]
    ds_read_b64_tr_b16 a[168:169], v31 offset:22528
    ds_read_b64_tr_b16 a[170:171], v31 offset:23040
    v_mfma_f32_32x32x16_bf16 v[80:95], a[172:175], a[124:127], v[80:95]
    ds_read_b64_tr_b16 a[172:173], v34 offset:22528
    ds_read_b64_tr_b16 a[174:175], v34 offset:23040
    s_waitcnt lgkmcnt(8)
    v_mfma_f32_32x32x16_bf16 v[64:79], a[144:147], a[128:131], v[64:79]
    v_mfma_f32_32x32x16_bf16 v[80:95], a[148:151], a[128:131], v[80:95]
    v_mfma_f32_32x32x16_bf16 v[64:79], a[152:155], a[132:135], v[64:79]
    s_waitcnt vmcnt(23)
    s_barrier
    ds_read_b64_tr_b16 a[144:145], v31 offset:24576
    ds_read_b64_tr_b16 a[146:147], v31 offset:25088
    ds_read_b64_tr_b16 a[148:149], v34 offset:24576
    ds_read_b64_tr_b16 a[150:151], v34 offset:25088
    v_mfma_f32_32x32x16_bf16 v[80:95], a[156:159], a[132:135], v[80:95]
    s_add_u32 m0, s51, 0x6000
    s_add_u32 s84, s59, s67
    buffer_load_dwordx4 v18, s[16:19], s84 offen lds
    ds_read_b64_tr_b16 a[152:153], v31 offset:26624
    s_waitcnt lgkmcnt(5)
    v_mfma_f32_32x32x16_bf16 v[64:79], a[160:163], a[136:139], v[64:79]
    ds_read_b64_tr_b16 a[154:155], v31 offset:27136
    ds_read_b64_tr_b16 a[156:157], v34 offset:26624
    ds_read_b64_tr_b16 a[158:159], v34 offset:27136
    ds_read_b64_tr_b16 a[160:161], v31 offset:28672
    ds_read_b64_tr_b16 a[162:163], v31 offset:29184
    v_mfma_f32_32x32x16_bf16 v[80:95], a[164:167], a[136:139], v[80:95]
    ds_read_b64_tr_b16 a[164:165], v34 offset:28672
    ds_read_b64_tr_b16 a[166:167], v34 offset:29184
    v_mfma_f32_32x32x16_bf16 v[64:79], a[168:171], a[140:143], v[64:79]
    buffer_load_dwordx4 v19, s[16:19], s84 offen offset:1024 lds
    ds_read_b64_tr_b16 a[168:169], v31 offset:30720
    ds_read_b64_tr_b16 a[170:171], v31 offset:31232
    v_mfma_f32_32x32x16_bf16 v[80:95], a[172:175], a[140:143], v[80:95]
    ds_read_b64_tr_b16 a[172:173], v34 offset:30720
    ds_read_b64_tr_b16 a[174:175], v34 offset:31232
    s_waitcnt lgkmcnt(12)
    v_mfma_f32_32x32x16_bf16 v[96:111], a[144:147], a[0:3], 0
    ds_read_b64_tr_b16 a[144:145], v31 offset:32768
    ds_read_b64_tr_b16 a[146:147], v31 offset:33280
    v_mfma_f32_32x32x16_bf16 v[112:127], a[148:151], a[0:3], 0
    s_add_u32 m0, s51, 0x8000
    s_add_u32 s83, s60, s67
    buffer_load_dwordx4 v18, s[16:19], s83 offen lds
    ds_read_b64_tr_b16 a[148:149], v34 offset:32768
    s_waitcnt lgkmcnt(7)
    v_mfma_f32_32x32x16_bf16 v[96:111], a[152:155], a[4:7], v[96:111]
    ds_read_b64_tr_b16 a[150:151], v34 offset:33280
    ds_read_b64_tr_b16 a[152:153], v31 offset:34816
    ds_read_b64_tr_b16 a[154:155], v31 offset:35328
    v_mul_f32 v212, s86, v64
    v_exp_f32 v212, v212
    v_mfma_f32_32x32x16_bf16 v[112:127], a[156:159], a[4:7], v[112:127]
    ds_read_b64_tr_b16 a[156:157], v34 offset:34816
    ds_read_b64_tr_b16 a[158:159], v34 offset:35328
    v_add_f32 v212, 1.0, v212
    v_rcp_f32 v212, v212
    v_mul_f32 v213, s86, v65
    v_mfma_f32_32x32x16_bf16 v[96:111], a[160:163], a[8:11], v[96:111]
    buffer_load_dwordx4 v19, s[16:19], s83 offen offset:1024 lds
    ds_read_b64_tr_b16 a[160:161], v31 offset:36864
    ds_read_b64_tr_b16 a[162:163], v31 offset:37376
    v_mul_f32 v64, v64, v212
    v_mfma_f32_32x32x16_bf16 v[112:127], a[164:167], a[8:11], v[112:127]
    ds_read_b64_tr_b16 a[164:165], v34 offset:36864
    ds_read_b64_tr_b16 a[166:167], v34 offset:37376
    v_exp_f32 v213, v213
    v_mul_f32 v214, s86, v66
    v_add_f32 v213, 1.0, v213
    s_waitcnt lgkmcnt(10)
    s_nop 0
L_pad53:
    s_cbranch_execz L_wret
    v_mfma_f32_32x32x16_bf16 v[96:111], a[168:171], a[12:15], v[96:111]
    ds_read_b64_tr_b16 a[168:169], v31 offset:38912
    ds_read_b64_tr_b16 a[170:171], v31 offset:39424
    v_rcp_f32 v213, v213
    v_exp_f32 v214, v214
    v_mfma_f32_32x32x16_bf16 v[112:127], a[172:175], a[12:15], v[112:127]
    s_add_u32 m0, s51, 0xa000
    s_add_u32 s84, s61, s67
    buffer_load_dwordx4 v18, s[16:19], s84 offen lds
    ds_read_b64_tr_b16 a[172:173], v34 offset:38912
    v_mfma_f32_32x32x16_bf16 v[96:111], a[144:147], a[16:19], v[96:111]
    ds_read_b64_tr_b16 a[174:175], v34 offset:39424
    ds_read_b64_tr_b16 a[144:145], v31 offset:40960
    ds_read_b64_tr_b16 a[146:147], v31 offset:41472
    v_mul_f32 v65, v65, v213
    v_cvt_pk_bf16_f32 v136, v64, v65
    v_add_f32 v214, 1.0, v214
    s_waitcnt lgkmcnt(8)
    v_mfma_f32_32x32x16_bf16 v[112:127], a[148:151], a[16:19], v[112:127]
    ds_read_b64_tr_b16 a[148:149], v34 offset:40960
    ds_read_b64_tr_b16 a[150:151], v34 offset:41472
    v_rcp_f32 v214, v214
    v_mul_f32 v215, s86, v67
    v_mul_f32 v66, v66, v214
    v_mfma_f32_32x32x16_bf16 v[96:111], a[152:155], a[20:23], v[96:111]
    buffer_load_dwordx4 v19, s[16:19], s84 offen offset:1024 lds
    ds_read_b64_tr_b16 a[152:153], v31 offset:43008
    ds_read_b64_tr_b16 a[154:155], v31 offset:43520
    v_mul_f32 v216, s86, v68
    v_mfma_f32_32x32x16_bf16 v[112:127], a[156:159], a[20:23], v[112:127]
    ds_read_b64_tr_b16 a[156:157], v34 offset:43008
    ds_read_b64_tr_b16 a[158:159], v34 offset:43520
    v_exp_f32 v215, v215
    v_exp_f32 v216, v216
    v_mfma_f32_32x32x16_bf16 v[96:111], a[160:163], a[24:27], v[96:111]
    ds_read_b64_tr_b16 a[160:161], v31 offset:45056
    ds_read_b64_tr_b16 a[162:163], v31 offset:45568
    v_add_f32 v215, 1.0, v215
    v_rcp_f32 v215, v215
    v_add_f32 v216, 1.0, v216
    s_waitcnt lgkmcnt(8)
    v_mfma_f32_32x32x16_bf16 v[112:127], a[164:167], a[24:27], v[112:127]
    ds_read_b64_tr_b16 a[164:165], v34 offset:45056
    ds_read_b64_tr_b16 a[166:167], v34 offset:45568
    v_mul_f32 v67, v67, v215
    v_cvt_pk_bf16_f32 v137, v66, v67
    v_rcp_f32 v216, v216
    v_mfma_f32_32x32x16_bf16 v[96:111], a[168:171], a[28:31], v[96:111]
    ds_read_b64_tr_b16 a[168:169], v31 offset:47104
    ds_read_b64_tr_b16 a[170:171], v31 offset:47616
    v_mul_f32 v68, v68, v216
    v_mul_f32 v217, s86, v69
    v_exp_f32 v217, v217
    v_mfma_f32_32x32x16_bf16 v[112:127], a[172:175], a[28:31], v[112:127]
    ds_read_b64_tr_b16 a[172:173], v34 offset:47104
    ds_read_b64_tr_b16 a[174:175], v34 offset:47616
    v_add_f32 v217, 1.0, v217
    v_rcp_f32 v217, v217
    v_mul_f32 v218, s86, v70
    v_mfma_f32_32x32x16_bf16 v[96:111], a[144:147], a[32:35], v[96:111]
    v_mul_f32 v69, v69, v217
    v_cvt_pk_bf16_f32 v138, v68, v69
    v_exp_f32 v218, v218
    v_mul_f32 v219, s86, v71
    v_add_f32 v218, 1.0, v218
    s_waitcnt lgkmcnt(6)
    v_mfma_f32_32x32x16_bf16 v[112:127], a[148:151], a[32:35], v[112:127]
    v_rcp_f32 v218, v218
    v_exp_f32 v219, v219
    v_mul_f32 v70, v70, v218
    v_add_f32 v219, 1.0, v219
    v_mfma_f32_32x32x16_bf16 v[96:111], a[152:155], a[36:39], v[96:111]
    s_waitcnt vmcnt(12)
    s_barrier
    buffer_atomic_add v58, v63, s[40:43], 0 offen sc1
    ds_read_b64_tr_b16 a[144:145], v32 offset:0
    v_mfma_f32_32x32x16_bf16 v[112:127], a[156:159], a[36:39], v[112:127]
    ds_read_b64_tr_b16 a[146:147], v32 offset:512
    ds_read_b64_tr_b16 a[148:149], v35 offset:0
    ds_read_b64_tr_b16 a[150:151], v35 offset:512
    ds_read_b64_tr_b16 a[152:153], v32 offset:2048
L_pad54:
    s_cbranch_execz L_wret
    ds_read_b64_tr_b16 a[154:155], v32 offset:2560
    ds_read_b64_tr_b16 a[156:157], v35 offset:2048
    v_mfma_f32_32x32x16_bf16 v[96:111], a[160:163], a[40:43], v[96:111]
    ds_read_b64_tr_b16 a[158:159], v35 offset:2560
    ds_read_b64_tr_b16 a[160:161], v32 offset:4096
    ds_read_b64_tr_b16 a[162:163], v32 offset:4608
    v_rcp_f32 v219, v219
    v_mul_f32 v220, s86, v72
    s_waitcnt lgkmcnt(10)
    v_mfma_f32_32x32x16_bf16 v[112:127], a[164:167], a[40:43], v[112:127]
    s_add_u32 m0, s51, 0xc000
    s_add_u32 s83, s62, s67
    buffer_load_dwordx4 v18, s[16:19], s83 offen lds
    ds_read_b64_tr_b16 a[164:165], v35 offset:4096
    v_mfma_f32_32x32x16_bf16 v[96:111], a[168:171], a[44:47], v[96:111]
    ds_read_b64_tr_b16 a[166:167], v35 offset:4608
    ds_read_b64_tr_b16 a[168:169], v32 offset:6144
    ds_read_b64_tr_b16 a[170:171], v32 offset:6656
    v_mul_f32 v71, v71, v219
    v_cvt_pk_bf16_f32 v139, v70, v71
    v_mul_f32 v221, s86, v73
    v_mfma_f32_32x32x16_bf16 v[112:127], a[172:175], a[44:47], v[112:127]
    ds_read_b64_tr_b16 a[172:173], v35 offset:6144
    ds_read_b64_tr_b16 a[174:175], v35 offset:6656
    v_exp_f32 v220, v220
    v_exp_f32 v221, v221
    s_waitcnt lgkmcnt(10)
    v_mfma_f32_32x32x16_bf16 v[96:111], a[144:147], a[48:51], v[96:111]
    buffer_store_dwordx4 v[136:139], v24, s[32:35], 0 offen offset:2048 sc1
    ds_read_b64_tr_b16 a[144:145], v32 offset:8192
    ds_read_b64_tr_b16 a[146:147], v32 offset:8704
    v_add_f32 v220, 1.0, v220
    v_mfma_f32_32x32x16_bf16 v[112:127], a[148:151], a[48:51], v[112:127]
    ds_read_b64_tr_b16 a[148:149], v35 offset:8192
    ds_read_b64_tr_b16 a[150:151], v35 offset:8704
    v_rcp_f32 v220, v220
    v_add_f32 v221, 1.0, v221
    v_mul_f32 v72, v72, v220
    v_mfma_f32_32x32x16_bf16 v[96:111], a[152:155], a[52:55], v[96:111]
    ds_read_b64_tr_b16 a[152:153], v32 offset:10240
    ds_read_b64_tr_b16 a[154:155], v32 offset:10752
    v_rcp_f32 v221, v221
    v_mul_f32 v222, s86, v74
    v_mul_f32 v73, v73, v221
    s_waitcnt lgkmcnt(8)
    v_mfma_f32_32x32x16_bf16 v[112:127], a[156:159], a[52:55], v[112:127]
    buffer_load_dwordx4 v19, s[16:19], s83 offen offset:1024 lds
    ds_read_b64_tr_b16 a[156:157], v35 offset:10240
    ds_read_b64_tr_b16 a[158:159], v35 offset:10752
    v_cvt_pk_bf16_f32 v140, v72, v73
    v_mfma_f32_32x32x16_bf16 v[96:111], a[160:163], a[56:59], v[96:111]
    ds_read_b64_tr_b16 a[160:161], v32 offset:12288
    ds_read_b64_tr_b16 a[162:163], v32 offset:12800
    v_exp_f32 v222, v222
    v_mul_f32 v223, s86, v75
    v_add_f32 v222, 1.0, v222
    v_mfma_f32_32x32x16_bf16 v[112:127], a[164:167], a[56:59], v[112:127]
    ds_read_b64_tr_b16 a[164:165], v35 offset:12288
    ds_read_b64_tr_b16 a[166:167], v35 offset:12800
    v_rcp_f32 v222, v222
    v_exp_f32 v223, v223
    v_mfma_f32_32x32x16_bf16 v[96:111], a[168:171], a[60:63], v[96:111]
    s_add_u32 m0, s51, 0xe000
    s_add_u32 s84, s63, s67
    buffer_load_dwordx4 v18, s[16:19], s84 offen lds
    ds_read_b64_tr_b16 a[168:169], v32 offset:14336
    s_waitcnt lgkmcnt(7)
    v_mfma_f32_32x32x16_bf16 v[112:127], a[172:175], a[60:63], v[112:127]
    ds_read_b64_tr_b16 a[170:171], v32 offset:14848
    ds_read_b64_tr_b16 a[172:173], v35 offset:14336
    ds_read_b64_tr_b16 a[174:175], v35 offset:14848
    v_mul_f32 v74, v74, v222
    v_add_f32 v223, 1.0, v223
    v_mul_f32 v212, s86, v76
    v_mfma_f32_32x32x16_bf16 v[96:111], a[144:147], a[64:67], v[96:111]
    ds_read_b64_tr_b16 a[144:145], v32 offset:16384
    ds_read_b64_tr_b16 a[146:147], v32 offset:16896
L_pad55:
    s_cbranch_execz L_wret
    v_rcp_f32 v223, v223
    v_exp_f32 v212, v212
    v_mfma_f32_32x32x16_bf16 v[112:127], a[148:151], a[64:67], v[112:127]
    buffer_load_dwordx4 v19, s[16:19], s84 offen offset:1024 lds
    ds_read_b64_tr_b16 a[148:149], v35 offset:16384
    ds_read_b64_tr_b16 a[150:151], v35 offset:16896
    v_mul_f32 v75, v75, v223
    v_mfma_f32_32x32x16_bf16 v[96:111], a[152:155], a[68:71], v[96:111]
    ds_read_b64_tr_b16 a[152:153], v32 offset:18432
    ds_read_b64_tr_b16 a[154:155], v32 offset:18944
    v_cvt_pk_bf16_f32 v141, v74, v75
    v_add_f32 v212, 1.0, v212
    v_rcp_f32 v212, v212
    s_waitcnt lgkmcnt(10)
    v_mfma_f32_32x32x16_bf16 v[112:127], a[156:159], a[68:71], v[112:127]
    ds_read_b64_tr_b16 a[156:157], v35 offset:18432
    ds_read_b64_tr_b16 a[158:159], v35 offset:18944
    v_mul_f32 v76, v76, v212
    v_mul_f32 v213, s86, v77
    v_exp_f32 v213, v213
    v_mfma_f32_32x32x16_bf16 v[96:111], a[160:163], a[72:75], v[96:111]
    s_add_u32 m0, s51, 0x10000
    s_add_u32 s83, s64, s67
    buffer_load_dwordx4 v18, s[16:19], s83 offen lds
    ds_read_b64_tr_b16 a[160:161], v32 offset:20480
    v_mfma_f32_32x32x16_bf16 v[112:127], a[164:167], a[72:75], v[112:127]
    ds_read_b64_tr_b16 a[162:163], v32 offset:20992
    ds_read_b64_tr_b16 a[164:165], v35 offset:20480
    ds_read_b64_tr_b16 a[166:167], v35 offset:20992
    v_add_f32 v213, 1.0, v213
    v_rcp_f32 v213, v213
    s_waitcnt lgkmcnt(8)
    v_mfma_f32_32x32x16_bf16 v[96:111], a[168:171], a[76:79], v[96:111]
    ds_read_b64_tr_b16 a[168:169], v32 offset:22528
    ds_read_b64_tr_b16 a[170:171], v32 offset:23040
    v_mul_f32 v77, v77, v213
    v_cvt_pk_bf16_f32 v142, v76, v77
    v_mul_f32 v214, s86, v78
    v_mul_f32 v215, s86, v79
    v_mfma_f32_32x32x16_bf16 v[112:127], a[172:175], a[76:79], v[112:127]
    buffer_load_dwordx4 v19, s[16:19], s83 offen offset:1024 lds
    ds_read_b64_tr_b16 a[172:173], v35 offset:22528
    ds_read_b64_tr_b16 a[174:175], v35 offset:23040
    v_mul_f32 v212, s86, v80
    v_mfma_f32_32x32x16_bf16 v[96:111], a[144:147], a[80:83], v[96:111]
    v_exp_f32 v214, v214
    v_exp_f32 v215, v215
    v_add_f32 v214, 1.0, v214
    v_add_f32 v215, 1.0, v215
    v_mfma_f32_32x32x16_bf16 v[112:127], a[148:151], a[80:83], v[112:127]
    v_rcp_f32 v214, v214
    v_rcp_f32 v215, v215
    v_mul_f32 v78, v78, v214
    v_mul_f32 v79, v79, v215
    s_waitcnt lgkmcnt(4)
    v_mfma_f32_32x32x16_bf16 v[96:111], a[152:155], a[84:87], v[96:111]
    s_barrier
    s_add_u32 m0, s51, 0x12000
    s_add_u32 s84, s56, s68
    buffer_load_dwordx4 v18, s[16:19], s84 offen lds
    v_mfma_f32_32x32x16_bf16 v[112:127], a[156:159], a[84:87], v[112:127]
    ds_read_b64_tr_b16 a[144:145], v32 offset:24576
    ds_read_b64_tr_b16 a[146:147], v32 offset:25088
    ds_read_b64_tr_b16 a[148:149], v35 offset:24576
    ds_read_b64_tr_b16 a[150:151], v35 offset:25088
    ds_read_b64_tr_b16 a[152:153], v32 offset:26624
    ds_read_b64_tr_b16 a[154:155], v32 offset:27136
    v_mfma_f32_32x32x16_bf16 v[96:111], a[160:163], a[88:91], v[96:111]
    ds_read_b64_tr_b16 a[156:157], v35 offset:26624
    ds_read_b64_tr_b16 a[158:159], v35 offset:27136
    ds_read_b64_tr_b16 a[160:161], v32 offset:28672
    ds_read_b64_tr_b16 a[162:163], v32 offset:29184
    v_cvt_pk_bf16_f32 v143, v78, v79
    v_mul_f32 v213, s86, v81
    v_mfma_f32_32x32x16_bf16 v[112:127], a[164:167], a[88:91], v[112:127]
    buffer_store_dwordx4 v[140:143], v24, s[32:35], 0 offen offset:3072 sc1
    ds_read_b64_tr_b16 a[164:165], v35 offset:28672
    ds_read_b64_tr_b16 a[166:167], v35 offset:29184
L_pad56:
    s_cbranch_execz L_wret
    v_mul_f32 v214, s86, v82
    s_waitcnt lgkmcnt(12)
    v_mfma_f32_32x32x16_bf16 v[96:111], a[168:171], a[92:95], v[96:111]
    ds_read_b64_tr_b16 a[168:169], v32 offset:30720
    ds_read_b64_tr_b16 a[170:171], v32 offset:31232
    v_exp_f32 v212, v212
    v_exp_f32 v213, v213
    v_mfma_f32_32x32x16_bf16 v[112:127], a[172:175], a[92:95], v[112:127]
    ds_read_b64_tr_b16 a[172:173], v35 offset:30720
    ds_read_b64_tr_b16 a[174:175], v35 offset:31232
    buffer_load_dwordx4 v19, s[16:19], s84 offen offset:1024 lds
    v_add_f32 v212, 1.0, v212
    s_waitcnt lgkmcnt(11)
    v_mfma_f32_32x32x16_bf16 v[96:111], a[144:147], a[96:99], v[96:111]
    ds_read_b64_tr_b16 a[144:145], v32 offset:32768
    ds_read_b64_tr_b16 a[146:147], v32 offset:33280
    v_rcp_f32 v212, v212
    v_add_f32 v213, 1.0, v213
    v_mul_f32 v80, v80, v212
    v_mfma_f32_32x32x16_bf16 v[112:127], a[148:151], a[96:99], v[112:127]
    ds_read_b64_tr_b16 a[148:149], v35 offset:32768
    ds_read_b64_tr_b16 a[150:151], v35 offset:33280
    v_rcp_f32 v213, v213
    v_exp_f32 v214, v214
    s_waitcnt lgkmcnt(8)
    v_mfma_f32_32x32x16_bf16 v[96:111], a[152:155], a[100:103], v[96:111]
    s_add_u32 m0, s51, 0x14000
    s_add_u32 s83, s57, s68
    buffer_load_dwordx4 v18, s[16:19], s83 offen lds
    ds_read_b64_tr_b16 a[152:153], v32 offset:34816
    v_mfma_f32_32x32x16_bf16 v[112:127], a[156:159], a[100:103], v[112:127]
    ds_read_b64_tr_b16 a[154:155], v32 offset:35328
    ds_read_b64_tr_b16 a[156:157], v35 offset:34816
    ds_read_b64_tr_b16 a[158:159], v35 offset:35328
    v_mul_f32 v81, v81, v213
    v_cvt_pk_bf16_f32 v144, v80, v81
    v_add_f32 v214, 1.0, v214
    v_mfma_f32_32x32x16_bf16 v[96:111], a[160:163], a[104:107], v[96:111]
    ds_read_b64_tr_b16 a[160:161], v32 offset:36864
    ds_read_b64_tr_b16 a[162:163], v32 offset:37376
    v_rcp_f32 v214, v214
    v_mul_f32 v215, s86, v83
    v_mul_f32 v82, v82, v214
    v_mfma_f32_32x32x16_bf16 v[112:127], a[164:167], a[104:107], v[112:127]
    buffer_load_dwordx4 v19, s[16:19], s83 offen offset:1024 lds
    ds_read_b64_tr_b16 a[164:165], v35 offset:36864
    ds_read_b64_tr_b16 a[166:167], v35 offset:37376
    v_mul_f32 v216, s86, v84
    s_waitcnt lgkmcnt(8)
    v_mfma_f32_32x32x16_bf16 v[96:111], a[168:171], a[108:111], v[96:111]
    ds_read_b64_tr_b16 a[168:169], v32 offset:38912
    ds_read_b64_tr_b16 a[170:171], v32 offset:39424
    v_exp_f32 v215, v215
    v_exp_f32 v216, v216
    v_mfma_f32_32x32x16_bf16 v[112:127], a[172:175], a[108:111], v[112:127]
    ds_read_b64_tr_b16 a[172:173], v35 offset:38912
    ds_read_b64_tr_b16 a[174:175], v35 offset:39424
    v_add_f32 v215, 1.0, v215
    v_rcp_f32 v215, v215
    v_add_f32 v216, 1.0, v216
    v_mfma_f32_32x32x16_bf16 v[96:111], a[144:147], a[112:115], v[96:111]
    s_add_u32 m0, s51, 0x16000
    s_add_u32 s84, s58, s68
    buffer_load_dwordx4 v18, s[16:19], s84 offen lds
    ds_read_b64_tr_b16 a[144:145], v32 offset:40960
    v_mfma_f32_32x32x16_bf16 v[112:127], a[148:151], a[112:115], v[112:127]
    ds_read_b64_tr_b16 a[146:147], v32 offset:41472
    ds_read_b64_tr_b16 a[148:149], v35 offset:40960
    ds_read_b64_tr_b16 a[150:151], v35 offset:41472
    v_mul_f32 v83, v83, v215
    v_cvt_pk_bf16_f32 v145, v82, v83
    v_mul_f32 v217, s86, v85
    s_waitcnt lgkmcnt(8)
    v_mfma_f32_32x32x16_bf16 v[96:111], a[152:155], a[116:119], v[96:111]
    ds_read_b64_tr_b16 a[152:153], v32 offset:43008
    ds_read_b64_tr_b16 a[154:155], v32 offset:43520
    v_rcp_f32 v216, v216
    v_exp_f32 v217, v217
    v_mfma_f32_32x32x16_bf16 v[112:127], a[156:159], a[116:119], v[112:127]
L_pad57:
    s_cbranch_execz L_wret
    buffer_load_dwordx4 v19, s[16:19], s84 offen offset:1024 lds
    ds_read_b64_tr_b16 a[156:157], v35 offset:43008
    ds_read_b64_tr_b16 a[158:159], v35 offset:43520
    v_mul_f32 v84, v84, v216
    v_mfma_f32_32x32x16_bf16 v[96:111], a[160:163], a[120:123], v[96:111]
    ds_read_b64_tr_b16 a[160:161], v32 offset:45056
    ds_read_b64_tr_b16 a[162:163], v32 offset:45568
    v_add_f32 v217, 1.0, v217
    v_rcp_f32 v217, v217
    v_mul_f32 v218, s86, v86
    v_mfma_f32_32x32x16_bf16 v[112:127], a[164:167], a[120:123], v[112:127]
    ds_read_b64_tr_b16 a[164:165], v35 offset:45056
    ds_read_b64_tr_b16 a[166:167], v35 offset:45568
    v_mul_f32 v85, v85, v217
    v_cvt_pk_bf16_f32 v146, v84, v85
    v_exp_f32 v218, v218
    s_waitcnt lgkmcnt(8)
    v_mfma_f32_32x32x16_bf16 v[96:111], a[168:171], a[124:127], v[96:111]
    ds_read_b64_tr_b16 a[168:169], v32 offset:47104
    ds_read_b64_tr_b16 a[170:171], v32 offset:47616
    v_add_f32 v218, 1.0, v218
    v_rcp_f32 v218, v218
    v_mul_f32 v219, s86, v87
    v_mfma_f32_32x32x16_bf16 v[112:127], a[172:175], a[124:127], v[112:127]
    ds_read_b64_tr_b16 a[172:173], v35 offset:47104
    ds_read_b64_tr_b16 a[174:175], v35 offset:47616
    v_mul_f32 v86, v86, v218
    v_exp_f32 v219, v219
    v_mul_f32 v220, s86, v88
    v_mfma_f32_32x32x16_bf16 v[96:111], a[144:147], a[128:131], v[96:111]
    v_add_f32 v219, 1.0, v219
    v_rcp_f32 v219, v219
    v_exp_f32 v220, v220
    v_mul_f32 v87, v87, v219
    v_mfma_f32_32x32x16_bf16 v[112:127], a[148:151], a[128:131], v[112:127]
    v_cvt_pk_bf16_f32 v147, v86, v87
    s_mov_b32 s85, 0x1000
    buffer_store_dwordx4 v[144:147], v24, s[32:35], s85 offen sc1
    v_add_f32 v220, 1.0, v220
    s_waitcnt lgkmcnt(4)
    v_mfma_f32_32x32x16_bf16 v[96:111], a[152:155], a[132:135], v[96:111]
    s_waitcnt vmcnt(22)
    s_barrier
    ds_read_b64_tr_b16 a[144:145], v30 offset:0
    ds_read_b64_tr_b16 a[146:147], v30 offset:512
    ds_read_b64_tr_b16 a[148:149], v33 offset:0
    ds_read_b64_tr_b16 a[150:151], v33 offset:512
    v_mfma_f32_32x32x16_bf16 v[112:127], a[156:159], a[132:135], v[112:127]
    ds_read_b64_tr_b16 a[152:153], v30 offset:2048
    ds_read_b64_tr_b16 a[154:155], v30 offset:2560
    ds_read_b64_tr_b16 a[156:157], v33 offset:2048
    ds_read_b64_tr_b16 a[158:159], v33 offset:2560
    v_rcp_f32 v220, v220
    v_mfma_f32_32x32x16_bf16 v[96:111], a[160:163], a[136:139], v[96:111]
    s_add_u32 m0, s51, 0x18000
    s_add_u32 s83, s59, s68
    buffer_load_dwordx4 v18, s[16:19], s83 offen lds
    ds_read_b64_tr_b16 a[160:161], v30 offset:4096
    v_mfma_f32_32x32x16_bf16 v[112:127], a[164:167], a[136:139], v[112:127]
    ds_read_b64_tr_b16 a[162:163], v30 offset:4608
    ds_read_b64_tr_b16 a[164:165], v33 offset:4096
    ds_read_b64_tr_b16 a[166:167], v33 offset:4608
    v_mul_f32 v88, v88, v220
    v_mul_f32 v221, s86, v89
    v_mul_f32 v222, s86, v90
    s_waitcnt lgkmcnt(12)
    v_mfma_f32_32x32x16_bf16 v[96:111], a[168:171], a[140:143], v[96:111]
    ds_read_b64_tr_b16 a[168:169], v30 offset:6144
    ds_read_b64_tr_b16 a[170:171], v30 offset:6656
    v_exp_f32 v221, v221
    v_exp_f32 v222, v222
    v_mfma_f32_32x32x16_bf16 v[112:127], a[172:175], a[140:143], v[112:127]
    buffer_load_dwordx4 v19, s[16:19], s83 offen offset:1024 lds
    ds_read_b64_tr_b16 a[172:173], v33 offset:6144
    ds_read_b64_tr_b16 a[174:175], v33 offset:6656
    v_add_f32 v221, 1.0, v221
    s_waitcnt lgkmcnt(8)
    v_mfma_f32_32x32x16_bf16 v[64:79], a[144:147], a[0:3], 0
    ds_read_b64_tr_b16 a[144:145], v30 offset:8192
L_pad58:
    s_cbranch_execz L_wret
    ds_read_b64_tr_b16 a[146:147], v30 offset:8704
    v_rcp_f32 v221, v221
    v_add_f32 v222, 1.0, v222
    v_mul_f32 v89, v89, v221
    v_cvt_pk_bf16_f32 v148, v88, v89
    v_rcp_f32 v222, v222
    v_mul_f32 v223, s86, v91
    s_add_u32 m0, s51, 0x1a000
    s_add_u32 s84, s60, s68
    buffer_load_dwordx4 v18, s[16:19], s84 offen lds
    v_mul_f32 v90, v90, v222
    v_exp_f32 v223, v223
    v_mul_f32 v212, s86, v92
    v_add_f32 v223, 1.0, v223
    v_rcp_f32 v223, v223
    v_exp_f32 v212, v212
    v_mul_f32 v91, v91, v223
    v_cvt_pk_bf16_f32 v149, v90, v91
    v_add_f32 v212, 1.0, v212
    v_rcp_f32 v212, v212
    v_mul_f32 v213, s86, v93
    v_mul_f32 v92, v92, v212
    buffer_load_dwordx4 v19, s[16:19], s84 offen offset:1024 lds
    v_exp_f32 v213, v213
    v_mul_f32 v214, s86, v94
    v_add_f32 v213, 1.0, v213
    v_rcp_f32 v213, v213
    v_exp_f32 v214, v214
    v_mul_f32 v93, v93, v213
    v_cvt_pk_bf16_f32 v150, v92, v93
    v_add_f32 v214, 1.0, v214
    v_rcp_f32 v214, v214
    v_mul_f32 v215, s86, v95
    v_mul_f32 v94, v94, v214
    v_exp_f32 v215, v215
    s_add_u32 m0, s51, 0x1c000
    s_add_u32 s83, s61, s68
    buffer_load_dwordx4 v18, s[16:19], s83 offen lds
    v_add_f32 v215, 1.0, v215
    v_rcp_f32 v215, v215
    v_mul_f32 v212, s86, v96
    v_mul_f32 v95, v95, v215
    v_cvt_pk_bf16_f32 v151, v94, v95
    v_mfma_f32_32x32x16_bf16 v[80:95], a[148:151], a[0:3], 0
    ds_read_b64_tr_b16 a[148:149], v33 offset:8192
    ds_read_b64_tr_b16 a[150:151], v33 offset:8704
    v_exp_f32 v212, v212
    v_mul_f32 v213, s86, v97
    v_add_f32 v212, 1.0, v212
    v_mfma_f32_32x32x16_bf16 v[64:79], a[152:155], a[4:7], v[64:79]
    s_mov_b32 s85, 0x1000
    buffer_store_dwordx4 v[148:151], v24, s[32:35], s85 offen offset:1024 sc1
    ds_read_b64_tr_b16 a[152:153], v30 offset:10240
    ds_read_b64_tr_b16 a[154:155], v30 offset:10752
    v_mfma_f32_32x32x16_bf16 v[80:95], a[156:159], a[4:7], v[80:95]
    ds_read_b64_tr_b16 a[156:157], v33 offset:10240
    ds_read_b64_tr_b16 a[158:159], v33 offset:10752
    v_rcp_f32 v212, v212
    v_exp_f32 v213, v213
    s_waitcnt lgkmcnt(6)
    v_mfma_f32_32x32x16_bf16 v[64:79], a[160:163], a[8:11], v[64:79]
    ds_read_b64_tr_b16 a[160:161], v30 offset:12288
    ds_read_b64_tr_b16 a[162:163], v30 offset:12800
    v_mul_f32 v96, v96, v212
    buffer_load_dwordx4 v19, s[16:19], s83 offen offset:1024 lds
    v_mfma_f32_32x32x16_bf16 v[80:95], a[164:167], a[8:11], v[80:95]
    ds_read_b64_tr_b16 a[164:165], v33 offset:12288
    ds_read_b64_tr_b16 a[166:167], v33 offset:12800
    v_add_f32 v213, 1.0, v213
    v_rcp_f32 v213, v213
    v_mul_f32 v214, s86, v98
    v_mfma_f32_32x32x16_bf16 v[64:79], a[168:171], a[12:15], v[64:79]
    ds_read_b64_tr_b16 a[168:169], v30 offset:14336
    ds_read_b64_tr_b16 a[170:171], v30 offset:14848
    v_mul_f32 v97, v97, v213
    v_cvt_pk_bf16_f32 v152, v96, v97
    v_exp_f32 v214, v214
    v_mfma_f32_32x32x16_bf16 v[80:95], a[172:175], a[12:15], v[80:95]
    ds_read_b64_tr_b16 a[172:173], v33 offset:14336
    ds_read_b64_tr_b16 a[174:175], v33 offset:14848
    v_add_f32 v214, 1.0, v214
    v_rcp_f32 v214, v214
    v_mul_f32 v215, s86, v99
    v_mfma_f32_32x32x16_bf16 v[64:79], a[144:147], a[16:19], v[64:79]
    ds_read_b64_tr_b16 a[144:145], v30 offset:16384
    ds_read_b64_tr_b16 a[146:147], v30 offset:16896
    v_mul_f32 v98, v98, v214
    v_exp_f32 v215, v215
    v_mul_f32 v216, s86, v100
L_pad59:
    s_cbranch_execz L_wret
    s_waitcnt lgkmcnt(8)
    v_mfma_f32_32x32x16_bf16 v[80:95], a[148:151], a[16:19], v[80:95]
    ds_read_b64_tr_b16 a[148:149], v33 offset:16384
    ds_read_b64_tr_b16 a[150:151], v33 offset:16896
    v_add_f32 v215, 1.0, v215
    v_rcp_f32 v215, v215
    v_mul_f32 v217, s86, v101
    v_mfma_f32_32x32x16_bf16 v[64:79], a[152:155], a[20:23], v[64:79]
    ds_read_b64_tr_b16 a[152:153], v30 offset:18432
    ds_read_b64_tr_b16 a[154:155], v30 offset:18944
    v_mul_f32 v99, v99, v215
    v_cvt_pk_bf16_f32 v153, v98, v99
    v_exp_f32 v216, v216
    v_mfma_f32_32x32x16_bf16 v[80:95], a[156:159], a[20:23], v[80:95]
    ds_read_b64_tr_b16 a[156:157], v33 offset:18432
    ds_read_b64_tr_b16 a[158:159], v33 offset:18944
    v_add_f32 v216, 1.0, v216
    v_rcp_f32 v216, v216
    v_mul_f32 v218, s86, v102
    v_mfma_f32_32x32x16_bf16 v[64:79], a[160:163], a[24:27], v[64:79]
    ds_read_b64_tr_b16 a[160:161], v30 offset:20480
    ds_read_b64_tr_b16 a[162:163], v30 offset:20992
    v_mul_f32 v100, v100, v216
    v_exp_f32 v217, v217
    v_mul_f32 v219, s86, v103
    s_waitcnt lgkmcnt(8)
    v_mfma_f32_32x32x16_bf16 v[80:95], a[164:167], a[24:27], v[80:95]
    ds_read_b64_tr_b16 a[164:165], v33 offset:20480
    ds_read_b64_tr_b16 a[166:167], v33 offset:20992
    v_add_f32 v217, 1.0, v217
    v_rcp_f32 v217, v217
    v_mul_f32 v220, s86, v104
    v_mfma_f32_32x32x16_bf16 v[64:79], a[168:171], a[28:31], v[64:79]
    ds_read_b64_tr_b16 a[168:169], v30 offset:22528
    ds_read_b64_tr_b16 a[170:171], v30 offset:23040
    v_mul_f32 v101, v101, v217
    v_cvt_pk_bf16_f32 v154, v100, v101
    v_exp_f32 v218, v218
    v_mfma_f32_32x32x16_bf16 v[80:95], a[172:175], a[28:31], v[80:95]
    ds_read_b64_tr_b16 a[172:173], v33 offset:22528
    ds_read_b64_tr_b16 a[174:175], v33 offset:23040
    v_add_f32 v218, 1.0, v218
    v_rcp_f32 v218, v218
    v_mul_f32 v221, s86, v105
    v_mfma_f32_32x32x16_bf16 v[64:79], a[144:147], a[32:35], v[64:79]
    v_mul_f32 v102, v102, v218
    v_exp_f32 v219, v219
    v_exp_f32 v220, v220
    v_add_f32 v219, 1.0, v219
    s_waitcnt lgkmcnt(6)
    v_mfma_f32_32x32x16_bf16 v[80:95], a[148:151], a[32:35], v[80:95]
    v_rcp_f32 v219, v219
    v_add_f32 v220, 1.0, v220
    v_mul_f32 v103, v103, v219
    v_cvt_pk_bf16_f32 v155, v102, v103
    v_mul_f32 v222, s86, v106
    v_mfma_f32_32x32x16_bf16 v[64:79], a[152:155], a[36:39], v[64:79]
    s_mov_b32 s85, 0x1000
    buffer_store_dwordx4 v[152:155], v24, s[32:35], s85 offen offset:2048 sc1
    s_waitcnt vmcnt(24)
    s_barrier
    v_mfma_f32_32x32x16_bf16 v[80:95], a[156:159], a[36:39], v[80:95]
    ds_read_b64_tr_b16 a[144:145], v30 offset:24576
    ds_read_b64_tr_b16 a[146:147], v30 offset:25088
    ds_read_b64_tr_b16 a[148:149], v33 offset:24576
    ds_read_b64_tr_b16 a[150:151], v33 offset:25088
    ds_read_b64_tr_b16 a[152:153], v30 offset:26624
    ds_read_b64_tr_b16 a[154:155], v30 offset:27136
    v_mfma_f32_32x32x16_bf16 v[64:79], a[160:163], a[40:43], v[64:79]
    ds_read_b64_tr_b16 a[156:157], v33 offset:26624
    ds_read_b64_tr_b16 a[158:159], v33 offset:27136
    ds_read_b64_tr_b16 a[160:161], v30 offset:28672
    ds_read_b64_tr_b16 a[162:163], v30 offset:29184
    v_rcp_f32 v220, v220
    s_waitcnt lgkmcnt(10)
    v_mfma_f32_32x32x16_bf16 v[80:95], a[164:167], a[40:43], v[80:95]
    s_add_u32 m0, s51, 0x1e000
    s_add_u32 s84, s62, s68
    buffer_load_dwordx4 v18, s[16:19], s84 offen lds
    ds_read_b64_tr_b16 a[164:165], v33 offset:28672
    v_mfma_f32_32x32x16_bf16 v[64:79], a[168:171], a[44:47], v[64:79]
L_pad60:
    s_cbranch_execz L_wret
    ds_read_b64_tr_b16 a[166:167], v33 offset:29184
    ds_read_b64_tr_b16 a[168:169], v30 offset:30720
    ds_read_b64_tr_b16 a[170:171], v30 offset:31232
    v_mul_f32 v104, v104, v220
    v_exp_f32 v221, v221
    v_mfma_f32_32x32x16_bf16 v[80:95], a[172:175], a[44:47], v[80:95]
    ds_read_b64_tr_b16 a[172:173], v33 offset:30720
    ds_read_b64_tr_b16 a[174:175], v33 offset:31232
    v_add_f32 v221, 1.0, v221
    v_rcp_f32 v221, v221
    v_mul_f32 v223, s86, v107
    s_waitcnt lgkmcnt(11)
    v_mfma_f32_32x32x16_bf16 v[64:79], a[144:147], a[48:51], v[64:79]
    buffer_load_dwordx4 v19, s[16:19], s84 offen offset:1024 lds
    ds_read_b64_tr_b16 a[144:145], v30 offset:32768
    ds_read_b64_tr_b16 a[146:147], v30 offset:33280
    v_mul_f32 v105, v105, v221
    v_mfma_f32_32x32x16_bf16 v[80:95], a[148:151], a[48:51], v[80:95]
    ds_read_b64_tr_b16 a[148:149], v33 offset:32768
    ds_read_b64_tr_b16 a[150:151], v33 offset:33280
    v_cvt_pk_bf16_f32 v156, v104, v105
    v_exp_f32 v222, v222
    v_mul_f32 v212, s86, v108
    s_waitcnt lgkmcnt(10)
    v_mfma_f32_32x32x16_bf16 v[64:79], a[152:155], a[52:55], v[64:79]
    ds_read_b64_tr_b16 a[152:153], v30 offset:34816
    ds_read_b64_tr_b16 a[154:155], v30 offset:35328
    v_add_f32 v222, 1.0, v222
    v_rcp_f32 v222, v222
    v_mul_f32 v213, s86, v109
    v_mfma_f32_32x32x16_bf16 v[80:95], a[156:159], a[52:55], v[80:95]
    s_add_u32 m0, s51, 0x20000
    s_add_u32 s83, s63, s68
    buffer_load_dwordx4 v18, s[16:19], s83 offen lds
    ds_read_b64_tr_b16 a[156:157], v33 offset:34816
    v_mfma_f32_32x32x16_bf16 v[64:79], a[160:163], a[56:59], v[64:79]
    ds_read_b64_tr_b16 a[158:159], v33 offset:35328
    ds_read_b64_tr_b16 a[160:161], v30 offset:36864
    ds_read_b64_tr_b16 a[162:163], v30 offset:37376
    v_mul_f32 v106, v106, v222
    v_exp_f32 v223, v223
    s_waitcnt lgkmcnt(8)
    v_mfma_f32_32x32x16_bf16 v[80:95], a[164:167], a[56:59], v[80:95]
    ds_read_b64_tr_b16 a[164:165], v33 offset:36864
    ds_read_b64_tr_b16 a[166:167], v33 offset:37376
    v_add_f32 v223, 1.0, v223
    v_rcp_f32 v223, v223
    v_mul_f32 v214, s86, v110
    v_mfma_f32_32x32x16_bf16 v[64:79], a[168:171], a[60:63], v[64:79]
    buffer_load_dwordx4 v19, s[16:19], s83 offen offset:1024 lds
    ds_read_b64_tr_b16 a[168:169], v30 offset:38912
    ds_read_b64_tr_b16 a[170:171], v30 offset:39424
    v_mul_f32 v107, v107, v223
    v_mfma_f32_32x32x16_bf16 v[80:95], a[172:175], a[60:63], v[80:95]
    ds_read_b64_tr_b16 a[172:173], v33 offset:38912
    ds_read_b64_tr_b16 a[174:175], v33 offset:39424
    v_cvt_pk_bf16_f32 v157, v106, v107
    v_exp_f32 v212, v212
    v_mul_f32 v215, s86, v111
    v_mfma_f32_32x32x16_bf16 v[64:79], a[144:147], a[64:67], v[64:79]
    ds_read_b64_tr_b16 a[144:145], v30 offset:40960
    ds_read_b64_tr_b16 a[146:147], v30 offset:41472
    v_add_f32 v212, 1.0, v212
    v_rcp_f32 v212, v212
    v_mul_f32 v216, s86, v116
    s_waitcnt lgkmcnt(8)
    v_mfma_f32_32x32x16_bf16 v[80:95], a[148:151], a[64:67], v[80:95]
    s_add_u32 m0, s51, 0x22000
    s_add_u32 s84, s64, s68
    buffer_load_dwordx4 v18, s[16:19], s84 offen lds
    ds_read_b64_tr_b16 a[148:149], v33 offset:40960
    v_mfma_f32_32x32x16_bf16 v[64:79], a[152:155], a[68:71], v[64:79]
    ds_read_b64_tr_b16 a[150:151], v33 offset:41472
    ds_read_b64_tr_b16 a[152:153], v30 offset:43008
    ds_read_b64_tr_b16 a[154:155], v30 offset:43520
    v_mul_f32 v108, v108, v212
    v_exp_f32 v213, v213
    v_mfma_f32_32x32x16_bf16 v[80:95], a[156:159], a[68:71], v[80:95]
    s_nop 0
L_pad61:
    s_cbranch_execz L_wret
    ds_read_b64_tr_b16 a[156:157], v33 offset:43008
    ds_read_b64_tr_b16 a[158:159], v33 offset:43520
    v_add_f32 v213, 1.0, v213
    v_rcp_f32 v213, v213
    v_mul_f32 v212, s86, v112
    v_mfma_f32_32x32x16_bf16 v[64:79], a[160:163], a[72:75], v[64:79]
    buffer_load_dwordx4 v19, s[16:19], s84 offen offset:1024 lds
    ds_read_b64_tr_b16 a[160:161], v30 offset:45056
    ds_read_b64_tr_b16 a[162:163], v30 offset:45568
    v_mul_f32 v109, v109, v213
    s_waitcnt lgkmcnt(8)
    v_mfma_f32_32x32x16_bf16 v[80:95], a[164:167], a[72:75], v[80:95]
    ds_read_b64_tr_b16 a[164:165], v33 offset:45056
    ds_read_b64_tr_b16 a[166:167], v33 offset:45568
    v_cvt_pk_bf16_f32 v158, v108, v109
    v_exp_f32 v214, v214
    v_mul_f32 v213, s86, v113
    v_mfma_f32_32x32x16_bf16 v[64:79], a[168:171], a[76:79], v[64:79]
    ds_read_b64_tr_b16 a[168:169], v30 offset:47104
    ds_read_b64_tr_b16 a[170:171], v30 offset:47616
    v_add_f32 v214, 1.0, v214
    v_rcp_f32 v214, v214
    v_mul_f32 v217, s86, v117
    v_mfma_f32_32x32x16_bf16 v[80:95], a[172:175], a[76:79], v[80:95]
    ds_read_b64_tr_b16 a[172:173], v33 offset:47104
    ds_read_b64_tr_b16 a[174:175], v33 offset:47616
    v_mul_f32 v110, v110, v214
    v_exp_f32 v215, v215
    v_mul_f32 v214, s86, v114
    v_mfma_f32_32x32x16_bf16 v[64:79], a[144:147], a[80:83], v[64:79]
    v_add_f32 v215, 1.0, v215
    v_rcp_f32 v215, v215
    v_exp_f32 v212, v212
    v_mul_f32 v111, v111, v215
    s_waitcnt lgkmcnt(6)
    v_mfma_f32_32x32x16_bf16 v[80:95], a[148:151], a[80:83], v[80:95]
    v_cvt_pk_bf16_f32 v159, v110, v111
    s_mov_b32 s85, 0x1000
    buffer_store_dwordx4 v[156:159], v24, s[32:35], s85 offen offset:3072 sc1
    v_add_f32 v212, 1.0, v212
    v_mfma_f32_32x32x16_bf16 v[64:79], a[152:155], a[84:87], v[64:79]
    s_waitcnt vmcnt(23)
    s_barrier
    ds_read_b64_tr_b16 a[144:145], v31 offset:0
    ds_read_b64_tr_b16 a[146:147], v31 offset:512
    ds_read_b64_tr_b16 a[148:149], v34 offset:0
    ds_read_b64_tr_b16 a[150:151], v34 offset:512
    v_mfma_f32_32x32x16_bf16 v[80:95], a[156:159], a[84:87], v[80:95]
    ds_read_b64_tr_b16 a[152:153], v31 offset:2048
    ds_read_b64_tr_b16 a[154:155], v31 offset:2560
    ds_read_b64_tr_b16 a[156:157], v34 offset:2048
    ds_read_b64_tr_b16 a[158:159], v34 offset:2560
    v_rcp_f32 v212, v212
    v_mfma_f32_32x32x16_bf16 v[64:79], a[160:163], a[88:91], v[64:79]
    s_add_u32 m0, s51, 0
    s_add_u32 s83, s56, s69
    buffer_load_dwordx4 v20, s[16:19], s83 offen lds
    ds_read_b64_tr_b16 a[160:161], v31 offset:4096
    s_waitcnt lgkmcnt(9)
    v_mfma_f32_32x32x16_bf16 v[80:95], a[164:167], a[88:91], v[80:95]
    ds_read_b64_tr_b16 a[162:163], v31 offset:4608
    ds_read_b64_tr_b16 a[164:165], v34 offset:4096
    ds_read_b64_tr_b16 a[166:167], v34 offset:4608
    v_mul_f32 v112, v112, v212
    v_exp_f32 v213, v213
    v_mfma_f32_32x32x16_bf16 v[64:79], a[168:171], a[92:95], v[64:79]
    ds_read_b64_tr_b16 a[168:169], v31 offset:6144
    ds_read_b64_tr_b16 a[170:171], v31 offset:6656
    v_add_f32 v213, 1.0, v213
    v_rcp_f32 v213, v213
    v_mul_f32 v215, s86, v115
    v_mfma_f32_32x32x16_bf16 v[80:95], a[172:175], a[92:95], v[80:95]
    s_add_u32 m0, s51, 0x400
    s_add_u32 s84, s57, s69
    buffer_load_dwordx4 v20, s[16:19], s84 offen lds
    ds_read_b64_tr_b16 a[172:173], v34 offset:6144
    s_waitcnt lgkmcnt(7)
    v_mfma_f32_32x32x16_bf16 v[64:79], a[144:147], a[96:99], v[64:79]
    ds_read_b64_tr_b16 a[174:175], v34 offset:6656
    s_nop 0
L_pad62:
    s_cbranch_execz L_wret
    ds_read_b64_tr_b16 a[144:145], v31 offset:8192
    ds_read_b64_tr_b16 a[146:147], v31 offset:8704
    v_mul_f32 v113, v113, v213
    v_cvt_pk_bf16_f32 v160, v112, v113
    v_mul_f32 v218, s86, v118
    v_mfma_f32_32x32x16_bf16 v[80:95], a[148:151], a[96:99], v[80:95]
    ds_read_b64_tr_b16 a[148:149], v34 offset:8192
    ds_read_b64_tr_b16 a[150:151], v34 offset:8704
    v_exp_f32 v214, v214
    v_exp_f32 v215, v215
    v_mfma_f32_32x32x16_bf16 v[64:79], a[152:155], a[100:103], v[64:79]
    s_add_u32 m0, s51, 0x2000
    s_add_u32 s83, s58, s69
    buffer_load_dwordx4 v20, s[16:19], s83 offen lds
    ds_read_b64_tr_b16 a[152:153], v31 offset:10240
    v_mfma_f32_32x32x16_bf16 v[80:95], a[156:159], a[100:103], v[80:95]
    ds_read_b64_tr_b16 a[154:155], v31 offset:10752
    ds_read_b64_tr_b16 a[156:157], v34 offset:10240
    ds_read_b64_tr_b16 a[158:159], v34 offset:10752
    v_add_f32 v214, 1.0, v214
    v_rcp_f32 v214, v214
    s_waitcnt lgkmcnt(10)
    v_mfma_f32_32x32x16_bf16 v[64:79], a[160:163], a[104:107], v[64:79]
    ds_read_b64_tr_b16 a[160:161], v31 offset:12288
    ds_read_b64_tr_b16 a[162:163], v31 offset:12800
    v_mul_f32 v114, v114, v214
    v_add_f32 v215, 1.0, v215
    v_rcp_f32 v215, v215
    v_mfma_f32_32x32x16_bf16 v[80:95], a[164:167], a[104:107], v[80:95]
    s_add_u32 m0, s51, 0x2400
    s_add_u32 s84, s59, s69
    buffer_load_dwordx4 v20, s[16:19], s84 offen lds
    ds_read_b64_tr_b16 a[164:165], v34 offset:12288
    v_mfma_f32_32x32x16_bf16 v[64:79], a[168:171], a[108:111], v[64:79]
    ds_read_b64_tr_b16 a[166:167], v34 offset:12800
    ds_read_b64_tr_b16 a[168:169], v31 offset:14336
    ds_read_b64_tr_b16 a[170:171], v31 offset:14848
    v_mul_f32 v115, v115, v215
    v_cvt_pk_bf16_f32 v161, v114, v115
    v_mul_f32 v219, s86, v119
    s_waitcnt lgkmcnt(10)
    v_mfma_f32_32x32x16_bf16 v[80:95], a[172:175], a[108:111], v[80:95]
    ds_read_b64_tr_b16 a[172:173], v34 offset:14336
    ds_read_b64_tr_b16 a[174:175], v34 offset:14848
    v_exp_f32 v216, v216
    v_exp_f32 v217, v217
    v_mfma_f32_32x32x16_bf16 v[64:79], a[144:147], a[112:115], v[64:79]
    s_add_u32 m0, s51, 0x4000
    s_add_u32 s83, s60, s69
    buffer_load_dwordx4 v20, s[16:19], s83 offen lds
    ds_read_b64_tr_b16 a[144:145], v31 offset:16384
    v_mfma_f32_32x32x16_bf16 v[80:95], a[148:151], a[112:115], v[80:95]
    ds_read_b64_tr_b16 a[146:147], v31 offset:16896
    ds_read_b64_tr_b16 a[148:149], v34 offset:16384
    ds_read_b64_tr_b16 a[150:151], v34 offset:16896
    v_add_f32 v216, 1.0, v216
    v_rcp_f32 v216, v216
    s_waitcnt lgkmcnt(10)
    v_mfma_f32_32x32x16_bf16 v[64:79], a[152:155], a[116:119], v[64:79]
    ds_read_b64_tr_b16 a[152:153], v31 offset:18432
    ds_read_b64_tr_b16 a[154:155], v31 offset:18944
    v_mul_f32 v116, v116, v216
    v_add_f32 v217, 1.0, v217
    v_rcp_f32 v217, v217
    v_mfma_f32_32x32x16_bf16 v[80:95], a[156:159], a[116:119], v[80:95]
    s_add_u32 m0, s51, 0x4400
    s_add_u32 s84, s61, s69
    buffer_load_dwordx4 v20, s[16:19], s84 offen lds
    ds_read_b64_tr_b16 a[156:157], v34 offset:18432
    v_mfma_f32_32x32x16_bf16 v[64:79], a[160:163], a[120:123], v[64:79]
    ds_read_b64_tr_b16 a[158:159], v34 offset:18944
    ds_read_b64_tr_b16 a[160:161], v31 offset:20480
    ds_read_b64_tr_b16 a[162:163], v31 offset:20992
    v_mul_f32 v117, v117, v217
    v_cvt_pk_bf16_f32 v162, v116, v117
    v_mul_f32 v220, s86, v120
    s_waitcnt lgkmcnt(10)
    s_nop 0
L_pad63:
    s_cbranch_execz L_wret
    v_mfma_f32_32x32x16_bf16 v[80:95], a[164:167], a[120:123], v[80:95]
    ds_read_b64_tr_b16 a[164:165], v34 offset:20480
    ds_read_b64_tr_b16 a[166:167], v34 offset:20992
    v_exp_f32 v218, v218
    v_exp_f32 v219, v219
    v_mfma_f32_32x32x16_bf16 v[64:79], a[168:171], a[124:127], v[64:79]
    ds_read_b64_tr_b16 a[168:169], v31 offset:22528
    ds_read_b64_tr_b16 a[170:171], v31 offset:23040
    v_add_f32 v218, 1.0, v218
    v_rcp_f32 v218, v218
    v_add_f32 v219, 1.0, v219
    v_mfma_f32_32x32x16_bf16 v[80:95], a[172:175], a[124:127], v[80:95]
    ds_read_b64_tr_b16 a[172:173], v34 offset:22528
    ds_read_b64_tr_b16 a[174:175], v34 offset:23040
    v_mul_f32 v118, v118, v218
    v_rcp_f32 v219, v219
    v_mul_f32 v221, s86, v121
    s_waitcnt lgkmcnt(10)
    v_mfma_f32_32x32x16_bf16 v[64:79], a[144:147], a[128:131], v[64:79]
    v_mul_f32 v119, v119, v219
    v_cvt_pk_bf16_f32 v163, v118, v119
    s_mov_b32 s85, 0x2000
    buffer_store_dwordx4 v[160:163], v24, s[32:35], s85 offen sc1
    v_mfma_f32_32x32x16_bf16 v[80:95], a[148:151], a[128:131], v[80:95]
    v_exp_f32 v220, v220
    v_exp_f32 v221, v221
    v_add_f32 v220, 1.0, v220
    v_add_f32 v221, 1.0, v221
    v_mfma_f32_32x32x16_bf16 v[64:79], a[152:155], a[132:135], v[64:79]
    s_waitcnt vmcnt(23)
    s_barrier
    ds_read_b64_tr_b16 a[144:145], v31 offset:24576
    ds_read_b64_tr_b16 a[146:147], v31 offset:25088
    ds_read_b64_tr_b16 a[148:149], v34 offset:24576
    ds_read_b64_tr_b16 a[150:151], v34 offset:25088
    s_waitcnt lgkmcnt(6)
    v_mfma_f32_32x32x16_bf16 v[80:95], a[156:159], a[132:135], v[80:95]
    buffer_load_dword v58, v59, s[40:43], 0 offen sc1
    ds_read_b64_tr_b16 a[152:153], v31 offset:26624
    ds_read_b64_tr_b16 a[154:155], v31 offset:27136
    ds_read_b64_tr_b16 a[156:157], v34 offset:26624
    ds_read_b64_tr_b16 a[158:159], v34 offset:27136
    v_mfma_f32_32x32x16_bf16 v[64:79], a[160:163], a[136:139], v[64:79]
    s_add_u32 m0, s51, 0x6000
    s_add_u32 s83, s62, s69
    buffer_load_dwordx4 v20, s[16:19], s83 offen lds
    ds_read_b64_tr_b16 a[160:161], v31 offset:28672
    v_mfma_f32_32x32x16_bf16 v[80:95], a[164:167], a[136:139], v[80:95]
    ds_read_b64_tr_b16 a[162:163], v31 offset:29184
    ds_read_b64_tr_b16 a[164:165], v34 offset:28672
    ds_read_b64_tr_b16 a[166:167], v34 offset:29184
    v_rcp_f32 v220, v220
    v_mul_f32 v222, s86, v122
    v_mfma_f32_32x32x16_bf16 v[64:79], a[168:171], a[140:143], v[64:79]
    ds_read_b64_tr_b16 a[168:169], v31 offset:30720
    ds_read_b64_tr_b16 a[170:171], v31 offset:31232
    v_mul_f32 v120, v120, v220
    v_rcp_f32 v221, v221
    v_mul_f32 v223, s86, v123
    s_waitcnt lgkmcnt(11)
    v_mfma_f32_32x32x16_bf16 v[80:95], a[172:175], a[140:143], v[80:95]
    s_add_u32 m0, s51, 0x6400
    s_add_u32 s84, s63, s69
    buffer_load_dwordx4 v20, s[16:19], s84 offen lds
    ds_read_b64_tr_b16 a[172:173], v34 offset:30720
    v_mfma_f32_32x32x16_bf16 v[96:111], a[144:147], a[0:3], 0
    ds_read_b64_tr_b16 a[174:175], v34 offset:31232
    ds_read_b64_tr_b16 a[144:145], v31 offset:32768
    ds_read_b64_tr_b16 a[146:147], v31 offset:33280
    v_mul_f32 v121, v121, v221
    v_cvt_pk_bf16_f32 v164, v120, v121
    v_exp_f32 v222, v222
    v_exp_f32 v223, v223
    v_add_f32 v222, 1.0, v222
    v_rcp_f32 v222, v222
    v_add_f32 v223, 1.0, v223
    s_add_u32 m0, s51, 0x8000
    s_add_u32 s83, s64, s69
    buffer_load_dwordx4 v20, s[16:19], s83 offen lds
    v_mul_f32 v122, v122, v222
L_pad64:
    s_cbranch_execz L_wret
    v_rcp_f32 v223, v223
    v_mul_f32 v212, s86, v124
    v_mul_f32 v123, v123, v223
    v_cvt_pk_bf16_f32 v165, v122, v123
    v_exp_f32 v212, v212
    v_mul_f32 v213, s86, v125
    v_add_f32 v212, 1.0, v212
    v_rcp_f32 v212, v212
    v_exp_f32 v213, v213
    v_mul_f32 v124, v124, v212
    v_add_f32 v213, 1.0, v213
    v_rcp_f32 v213, v213
    v_mul_f32 v214, s86, v126
    v_mul_f32 v125, v125, v213
    v_cvt_pk_bf16_f32 v166, v124, v125
    v_exp_f32 v214, v214
    v_mul_f32 v215, s86, v127
    v_add_f32 v214, 1.0, v214
    v_rcp_f32 v214, v214
    v_exp_f32 v215, v215
    v_mul_f32 v126, v126, v214
    v_add_f32 v215, 1.0, v215
    v_rcp_f32 v215, v215
    v_mul_f32 v212, s86, v64
    v_mul_f32 v127, v127, v215
    v_cvt_pk_bf16_f32 v167, v126, v127
    s_waitcnt lgkmcnt(0)
    v_mfma_f32_32x32x16_bf16 v[112:127], a[148:151], a[0:3], 0
    s_mov_b32 s85, 0x2000
    buffer_store_dwordx4 v[164:167], v24, s[32:35], s85 offen offset:1024 sc1
    ds_read_b64_tr_b16 a[148:149], v34 offset:32768
    ds_read_b64_tr_b16 a[150:151], v34 offset:33280
    v_mfma_f32_32x32x16_bf16 v[96:111], a[152:155], a[4:7], v[96:111]
    ds_read_b64_tr_b16 a[152:153], v31 offset:34816
    ds_read_b64_tr_b16 a[154:155], v31 offset:35328
    v_exp_f32 v212, v212
    v_mul_f32 v213, s86, v65
    v_add_f32 v212, 1.0, v212
    v_mfma_f32_32x32x16_bf16 v[112:127], a[156:159], a[4:7], v[112:127]
    ds_read_b64_tr_b16 a[156:157], v34 offset:34816
    ds_read_b64_tr_b16 a[158:159], v34 offset:35328
    v_rcp_f32 v212, v212
    v_exp_f32 v213, v213
    v_mfma_f32_32x32x16_bf16 v[96:111], a[160:163], a[8:11], v[96:111]
    ds_read_b64_tr_b16 a[160:161], v31 offset:36864
    ds_read_b64_tr_b16 a[162:163], v31 offset:37376
    v_mul_f32 v64, v64, v212
    v_add_f32 v213, 1.0, v213
    v_rcp_f32 v213, v213
    v_mfma_f32_32x32x16_bf16 v[112:127], a[164:167], a[8:11], v[112:127]
    ds_read_b64_tr_b16 a[164:165], v34 offset:36864
    ds_read_b64_tr_b16 a[166:167], v34 offset:37376
    v_mul_f32 v65, v65, v213
    v_cvt_pk_bf16_f32 v168, v64, v65
    v_mul_f32 v214, s86, v66
    v_mul_f32 v215, s86, v67
    v_mfma_f32_32x32x16_bf16 v[96:111], a[168:171], a[12:15], v[96:111]
    ds_read_b64_tr_b16 a[168:169], v31 offset:38912
    ds_read_b64_tr_b16 a[170:171], v31 offset:39424
    v_exp_f32 v214, v214
    v_exp_f32 v215, v215
    v_mfma_f32_32x32x16_bf16 v[112:127], a[172:175], a[12:15], v[112:127]
    ds_read_b64_tr_b16 a[172:173], v34 offset:38912
    ds_read_b64_tr_b16 a[174:175], v34 offset:39424
    v_add_f32 v214, 1.0, v214
    v_rcp_f32 v214, v214
    v_add_f32 v215, 1.0, v215
    v_mfma_f32_32x32x16_bf16 v[96:111], a[144:147], a[16:19], v[96:111]
    ds_read_b64_tr_b16 a[144:145], v31 offset:40960
    ds_read_b64_tr_b16 a[146:147], v31 offset:41472
    v_mul_f32 v66, v66, v214
    v_rcp_f32 v215, v215
    v_mul_f32 v216, s86, v68
    s_waitcnt lgkmcnt(8)
    v_mfma_f32_32x32x16_bf16 v[112:127], a[148:151], a[16:19], v[112:127]
    ds_read_b64_tr_b16 a[148:149], v34 offset:40960
    ds_read_b64_tr_b16 a[150:151], v34 offset:41472
    v_mul_f32 v67, v67, v215
    v_cvt_pk_bf16_f32 v169, v66, v67
    v_exp_f32 v216, v216
    v_mfma_f32_32x32x16_bf16 v[96:111], a[152:155], a[20:23], v[96:111]
    ds_read_b64_tr_b16 a[152:153], v31 offset:43008
    ds_read_b64_tr_b16 a[154:155], v31 offset:43520
    v_add_f32 v216, 1.0, v216
    v_rcp_f32 v216, v216
    v_mul_f32 v217, s86, v69
    v_mfma_f32_32x32x16_bf16 v[112:127], a[156:159], a[20:23], v[112:127]
    ds_read_b64_tr_b16 a[156:157], v34 offset:43008
L_pad65:
    s_cbranch_execz L_wret
    ds_read_b64_tr_b16 a[158:159], v34 offset:43520
    v_mul_f32 v68, v68, v216
    v_exp_f32 v217, v217
    v_mul_f32 v218, s86, v70
    v_mfma_f32_32x32x16_bf16 v[96:111], a[160:163], a[24:27], v[96:111]
    ds_read_b64_tr_b16 a[160:161], v31 offset:45056
    ds_read_b64_tr_b16 a[162:163], v31 offset:45568
    v_add_f32 v217, 1.0, v217
    v_rcp_f32 v217, v217
    v_mul_f32 v219, s86, v71
    s_waitcnt lgkmcnt(8)
    v_mfma_f32_32x32x16_bf16 v[112:127], a[164:167], a[24:27], v[112:127]
    ds_read_b64_tr_b16 a[164:165], v34 offset:45056
    ds_read_b64_tr_b16 a[166:167], v34 offset:45568
    v_mul_f32 v69, v69, v217
    v_cvt_pk_bf16_f32 v170, v68, v69
    v_exp_f32 v218, v218
    v_mfma_f32_32x32x16_bf16 v[96:111], a[168:171], a[28:31], v[96:111]
    ds_read_b64_tr_b16 a[168:169], v31 offset:47104
    ds_read_b64_tr_b16 a[170:171], v31 offset:47616
    v_add_f32 v218, 1.0, v218
    v_rcp_f32 v218, v218
    v_mul_f32 v220, s86, v72
    v_mfma_f32_32x32x16_bf16 v[112:127], a[172:175], a[28:31], v[112:127]
    ds_read_b64_tr_b16 a[172:173], v34 offset:47104
    ds_read_b64_tr_b16 a[174:175], v34 offset:47616
    v_mul_f32 v70, v70, v218
    v_exp_f32 v219, v219
    v_mul_f32 v221, s86, v73
    v_mfma_f32_32x32x16_bf16 v[96:111], a[144:147], a[32:35], v[96:111]
    v_add_f32 v219, 1.0, v219
    v_rcp_f32 v219, v219
    v_exp_f32 v220, v220
    v_mul_f32 v71, v71, v219
    s_waitcnt lgkmcnt(6)
    v_mfma_f32_32x32x16_bf16 v[112:127], a[148:151], a[32:35], v[112:127]
    v_cvt_pk_bf16_f32 v171, v70, v71
    s_mov_b32 s85, 0x2000
    buffer_store_dwordx4 v[168:171], v24, s[32:35], s85 offen offset:2048 sc1
    v_add_f32 v220, 1.0, v220
    v_mfma_f32_32x32x16_bf16 v[96:111], a[152:155], a[36:39], v[96:111]
    s_waitcnt vmcnt(21)
    s_barrier
    ds_read_b64_tr_b16 a[144:145], v32 offset:0
    ds_read_b64_tr_b16 a[146:147], v32 offset:512
    ds_read_b64_tr_b16 a[148:149], v35 offset:0
    ds_read_b64_tr_b16 a[150:151], v35 offset:512
    v_mfma_f32_32x32x16_bf16 v[112:127], a[156:159], a[36:39], v[112:127]
    ds_read_b64_tr_b16 a[152:153], v32 offset:2048
    ds_read_b64_tr_b16 a[154:155], v32 offset:2560
    ds_read_b64_tr_b16 a[156:157], v35 offset:2048
    ds_read_b64_tr_b16 a[158:159], v35 offset:2560
    v_rcp_f32 v220, v220
    v_mfma_f32_32x32x16_bf16 v[96:111], a[160:163], a[40:43], v[96:111]
    ds_read_b64_tr_b16 a[160:161], v32 offset:4096
    ds_read_b64_tr_b16 a[162:163], v32 offset:4608
    v_mul_f32 v72, v72, v220
    v_exp_f32 v221, v221
    v_mul_f32 v222, s86, v74
    s_waitcnt lgkmcnt(10)
    v_mfma_f32_32x32x16_bf16 v[112:127], a[164:167], a[40:43], v[112:127]
    ds_read_b64_tr_b16 a[164:165], v35 offset:4096
    ds_read_b64_tr_b16 a[166:167], v35 offset:4608
    v_add_f32 v221, 1.0, v221
    v_rcp_f32 v221, v221
    v_mul_f32 v223, s86, v75
    v_mfma_f32_32x32x16_bf16 v[96:111], a[168:171], a[44:47], v[96:111]
    ds_read_b64_tr_b16 a[168:169], v32 offset:6144
    ds_read_b64_tr_b16 a[170:171], v32 offset:6656
    v_mul_f32 v73, v73, v221
    v_cvt_pk_bf16_f32 v172, v72, v73
    v_exp_f32 v222, v222
    v_mfma_f32_32x32x16_bf16 v[112:127], a[172:175], a[44:47], v[112:127]
    ds_read_b64_tr_b16 a[172:173], v35 offset:6144
    ds_read_b64_tr_b16 a[174:175], v35 offset:6656
    v_add_f32 v222, 1.0, v222
    v_rcp_f32 v222, v222
    v_mul_f32 v212, s86, v76
    s_waitcnt lgkmcnt(8)
    v_mfma_f32_32x32x16_bf16 v[96:111], a[144:147], a[48:51], v[96:111]
    ds_read_b64_tr_b16 a[144:145], v32 offset:8192
    ds_read_b64_tr_b16 a[146:147], v32 offset:8704
L_pad66:
    s_cbranch_execz L_wret
    v_mul_f32 v74, v74, v222
    v_exp_f32 v223, v223
    v_mul_f32 v213, s86, v77
    v_mfma_f32_32x32x16_bf16 v[112:127], a[148:151], a[48:51], v[112:127]
    ds_read_b64_tr_b16 a[148:149], v35 offset:8192
    ds_read_b64_tr_b16 a[150:151], v35 offset:8704
    v_add_f32 v223, 1.0, v223
    v_rcp_f32 v223, v223
    v_mul_f32 v214, s86, v78
    v_mfma_f32_32x32x16_bf16 v[96:111], a[152:155], a[52:55], v[96:111]
    s_waitcnt vmcnt(5)
    v_cmp_le_u32 vcc, 16, v58
    s_nop 1
    s_cmp_eq_u64 vcc, -1
    s_cbranch_scc0 L_slow0
L_back0:
    v_mfma_f32_32x32x16_bf16 v[112:127], a[156:159], a[52:55], v[112:127]
    s_add_u32 m0, s53, 0xc000
    s_add_i32 s82, s89, -8
    s_mul_i32 s84, s82, 0x1b200
    s_cmp_lt_i32 s82, 0
    s_cselect_b32 s84, 0x40000000, s84
    buffer_load_dwordx4 v48, s[28:31], s84 offen sc1 lds
    s_waitcnt lgkmcnt(4)
    v_mfma_f32_32x32x16_bf16 v[96:111], a[160:163], a[56:59], v[96:111]
    ds_read_b64_tr_b16 a[152:153], v32 offset:10240
    ds_read_b64_tr_b16 a[154:155], v32 offset:10752
    ds_read_b64_tr_b16 a[156:157], v35 offset:10240
    ds_read_b64_tr_b16 a[158:159], v35 offset:10752
    ds_read_b64_tr_b16 a[160:161], v32 offset:12288
    ds_read_b64_tr_b16 a[162:163], v32 offset:12800
    v_mfma_f32_32x32x16_bf16 v[112:127], a[164:167], a[56:59], v[112:127]
    ds_read_b64_tr_b16 a[164:165], v35 offset:12288
    ds_read_b64_tr_b16 a[166:167], v35 offset:12800
    v_mul_f32 v75, v75, v223
    v_cvt_pk_bf16_f32 v173, v74, v75
    v_exp_f32 v212, v212
    v_mfma_f32_32x32x16_bf16 v[96:111], a[168:171], a[60:63], v[96:111]
    buffer_load_dwordx4 v49, s[28:31], s84 offen offset:1024 sc1 lds
    ds_read_b64_tr_b16 a[168:169], v32 offset:14336
    ds_read_b64_tr_b16 a[170:171], v32 offset:14848
    v_add_f32 v212, 1.0, v212
    v_mfma_f32_32x32x16_bf16 v[112:127], a[172:175], a[60:63], v[112:127]
    ds_read_b64_tr_b16 a[172:173], v35 offset:14336
    ds_read_b64_tr_b16 a[174:175], v35 offset:14848
    v_rcp_f32 v212, v212
    v_exp_f32 v213, v213
    s_waitcnt lgkmcnt(12)
    v_mfma_f32_32x32x16_bf16 v[96:111], a[144:147], a[64:67], v[96:111]
    ds_read_b64_tr_b16 a[144:145], v32 offset:16384
    ds_read_b64_tr_b16 a[146:147], v32 offset:16896
    buffer_load_dwordx4 v50, s[28:31], s84 offen offset:2048 sc1 lds
    v_mul_f32 v76, v76, v212
    v_mfma_f32_32x32x16_bf16 v[112:127], a[148:151], a[64:67], v[112:127]
    ds_read_b64_tr_b16 a[148:149], v35 offset:16384
    ds_read_b64_tr_b16 a[150:151], v35 offset:16896
    v_add_f32 v213, 1.0, v213
    v_rcp_f32 v213, v213
    v_mul_f32 v215, s86, v79
    s_waitcnt lgkmcnt(8)
    v_mfma_f32_32x32x16_bf16 v[96:111], a[152:155], a[68:71], v[96:111]
    ds_read_b64_tr_b16 a[152:153], v32 offset:18432
    ds_read_b64_tr_b16 a[154:155], v32 offset:18944
    v_mul_f32 v77, v77, v213
    v_cvt_pk_bf16_f32 v174, v76, v77
    buffer_load_dwordx4 v[240:243], v7, s[28:31], s81 offen sc1
    v_mfma_f32_32x32x16_bf16 v[112:127], a[156:159], a[68:71], v[112:127]
    ds_read_b64_tr_b16 a[156:157], v35 offset:18432
    ds_read_b64_tr_b16 a[158:159], v35 offset:18944
    v_exp_f32 v214, v214
    v_exp_f32 v215, v215
    v_mfma_f32_32x32x16_bf16 v[96:111], a[160:163], a[72:75], v[96:111]
    ds_read_b64_tr_b16 a[160:161], v32 offset:20480
    ds_read_b64_tr_b16 a[162:163], v32 offset:20992
    v_add_f32 v214, 1.0, v214
    v_rcp_f32 v214, v214
    v_add_f32 v215, 1.0, v215
    v_mfma_f32_32x32x16_bf16 v[112:127], a[164:167], a[72:75], v[112:127]
    buffer_load_dwordx4 v51, s[28:31], s84 offen offset:3072 sc1 lds
    ds_read_b64_tr_b16 a[164:165], v35 offset:20480
    s_nop 0
L_pad67:
    s_cbranch_execz L_wret
    ds_read_b64_tr_b16 a[166:167], v35 offset:20992
    v_mul_f32 v78, v78, v214
    s_waitcnt lgkmcnt(8)
    v_mfma_f32_32x32x16_bf16 v[96:111], a[168:171], a[76:79], v[96:111]
    ds_read_b64_tr_b16 a[168:169], v32 offset:22528
    ds_read_b64_tr_b16 a[170:171], v32 offset:23040
    v_rcp_f32 v215, v215
    v_mul_f32 v212, s86, v80
    v_mul_f32 v79, v79, v215
    v_mfma_f32_32x32x16_bf16 v[112:127], a[172:175], a[76:79], v[112:127]
    ds_read_b64_tr_b16 a[172:173], v35 offset:22528
    ds_read_b64_tr_b16 a[174:175], v35 offset:23040
    buffer_load_dwordx4 v[244:247], v7, s[28:31], s81 offen offset:1024 sc1
    v_cvt_pk_bf16_f32 v175, v78, v79
    v_mul_f32 v213, s86, v81
    v_mfma_f32_32x32x16_bf16 v[96:111], a[144:147], a[80:83], v[96:111]
    v_exp_f32 v212, v212
    v_exp_f32 v213, v213
    v_add_f32 v212, 1.0, v212
    v_add_f32 v213, 1.0, v213
    v_mfma_f32_32x32x16_bf16 v[112:127], a[148:151], a[80:83], v[112:127]
    v_rcp_f32 v212, v212
    v_rcp_f32 v213, v213
    buffer_load_dwordx4 v[248:251], v7, s[28:31], s81 offen offset:1536 sc1
    s_waitcnt lgkmcnt(4)
    v_mfma_f32_32x32x16_bf16 v[96:111], a[152:155], a[84:87], v[96:111]
    s_barrier
    ds_read_b64_tr_b16 a[144:145], v32 offset:24576
    ds_read_b64_tr_b16 a[146:147], v32 offset:25088
    ds_read_b64_tr_b16 a[148:149], v35 offset:24576
    ds_read_b64_tr_b16 a[150:151], v35 offset:25088
    ds_read_b64_tr_b16 a[152:153], v32 offset:26624
    v_mfma_f32_32x32x16_bf16 v[112:127], a[156:159], a[84:87], v[112:127]
    ds_read_b64_tr_b16 a[154:155], v32 offset:27136
    ds_read_b64_tr_b16 a[156:157], v35 offset:26624
    ds_read_b64_tr_b16 a[158:159], v35 offset:27136
    v_mul_f32 v80, v80, v212
    v_mul_f32 v81, v81, v213
    v_cvt_pk_bf16_f32 v176, v80, v81
    v_mfma_f32_32x32x16_bf16 v[96:111], a[160:163], a[88:91], v[96:111]
    s_mov_b32 s85, 0x2000
    buffer_store_dwordx4 v[172:175], v24, s[32:35], s85 offen offset:3072 sc1
    ds_read_b64_tr_b16 a[160:161], v32 offset:28672
    ds_read_b64_tr_b16 a[162:163], v32 offset:29184
    v_mfma_f32_32x32x16_bf16 v[112:127], a[164:167], a[88:91], v[112:127]
    ds_read_b64_tr_b16 a[164:165], v35 offset:28672
    ds_read_b64_tr_b16 a[166:167], v35 offset:29184
    v_mul_f32 v214, s86, v82
    v_exp_f32 v214, v214
    v_mul_f32 v215, s86, v83
    s_waitcnt lgkmcnt(12)
    v_mfma_f32_32x32x16_bf16 v[96:111], a[168:171], a[92:95], v[96:111]
    ds_read_b64_tr_b16 a[168:169], v32 offset:30720
    ds_read_b64_tr_b16 a[170:171], v32 offset:31232
    v_add_f32 v214, 1.0, v214
    buffer_load_dword v47, v6, s[28:31], s78 offen sc1
    v_mul_f32 v216, s86, v84
    v_mfma_f32_32x32x16_bf16 v[112:127], a[172:175], a[92:95], v[112:127]
    ds_read_b64_tr_b16 a[172:173], v35 offset:30720
    ds_read_b64_tr_b16 a[174:175], v35 offset:31232
    buffer_load_dword v46, v5, s[28:31], s79 offen offset:4 sc1
    v_rcp_f32 v214, v214
    s_waitcnt lgkmcnt(8)
    v_mfma_f32_32x32x16_bf16 v[96:111], a[144:147], a[96:99], v[96:111]
    s_add_u32 m0, s53, 0xd000
    s_nop 0
    buffer_load_dwordx4 v52, s[28:31], s84 offen sc1 lds
    ds_read_b64_tr_b16 a[144:145], v32 offset:32768
    v_mfma_f32_32x32x16_bf16 v[112:127], a[148:151], a[96:99], v[112:127]
    ds_read_b64_tr_b16 a[146:147], v32 offset:33280
    ds_read_b64_tr_b16 a[148:149], v35 offset:32768
    ds_read_b64_tr_b16 a[150:151], v35 offset:33280
    v_mul_f32 v82, v82, v214
    v_exp_f32 v215, v215
    v_mfma_f32_32x32x16_bf16 v[96:111], a[152:155], a[100:103], v[96:111]
    ds_read_b64_tr_b16 a[152:153], v32 offset:34816
    ds_read_b64_tr_b16 a[154:155], v32 offset:35328
L_pad68:
    s_cbranch_execz L_wret
    v_add_f32 v215, 1.0, v215
    v_rcp_f32 v215, v215
    s_add_u32 m0, s53, 0x11000
    s_add_i32 s82, s89, -4
    s_mul_i32 s83, s82, 0x1b200
    s_cmp_lt_i32 s82, 0
    s_cselect_b32 s83, 0x40000000, s83
    buffer_load_dwordx4 v48, s[28:31], s83 offen sc1 lds
    v_mfma_f32_32x32x16_bf16 v[112:127], a[156:159], a[100:103], v[112:127]
    ds_read_b64_tr_b16 a[156:157], v35 offset:34816
    ds_read_b64_tr_b16 a[158:159], v35 offset:35328
    v_mul_f32 v83, v83, v215
    v_cvt_pk_bf16_f32 v177, v82, v83
    v_exp_f32 v216, v216
    s_waitcnt lgkmcnt(8)
    v_mfma_f32_32x32x16_bf16 v[96:111], a[160:163], a[104:107], v[96:111]
    ds_read_b64_tr_b16 a[160:161], v32 offset:36864
    ds_read_b64_tr_b16 a[162:163], v32 offset:37376
    v_add_f32 v216, 1.0, v216
    v_rcp_f32 v216, v216
    v_mul_f32 v217, s86, v85
    v_mfma_f32_32x32x16_bf16 v[112:127], a[164:167], a[104:107], v[112:127]
    buffer_load_dwordx4 v49, s[28:31], s83 offen offset:1024 sc1 lds
    ds_read_b64_tr_b16 a[164:165], v35 offset:36864
    ds_read_b64_tr_b16 a[166:167], v35 offset:37376
    v_mul_f32 v84, v84, v216
    v_mfma_f32_32x32x16_bf16 v[96:111], a[168:171], a[108:111], v[96:111]
    ds_read_b64_tr_b16 a[168:169], v32 offset:38912
    ds_read_b64_tr_b16 a[170:171], v32 offset:39424
    v_exp_f32 v217, v217
    v_mul_f32 v218, s86, v86
    v_add_f32 v217, 1.0, v217
    v_mfma_f32_32x32x16_bf16 v[112:127], a[172:175], a[108:111], v[112:127]
    ds_read_b64_tr_b16 a[172:173], v35 offset:38912
    ds_read_b64_tr_b16 a[174:175], v35 offset:39424
    v_rcp_f32 v217, v217
    v_exp_f32 v218, v218
    s_waitcnt lgkmcnt(8)
    v_mfma_f32_32x32x16_bf16 v[96:111], a[144:147], a[112:115], v[96:111]
    buffer_load_dwordx4 v50, s[28:31], s83 offen offset:2048 sc1 lds
    ds_read_b64_tr_b16 a[144:145], v32 offset:40960
    ds_read_b64_tr_b16 a[146:147], v32 offset:41472
    v_mul_f32 v85, v85, v217
    v_mfma_f32_32x32x16_bf16 v[112:127], a[148:151], a[112:115], v[112:127]
    ds_read_b64_tr_b16 a[148:149], v35 offset:40960
    ds_read_b64_tr_b16 a[150:151], v35 offset:41472
    v_cvt_pk_bf16_f32 v178, v84, v85
    v_add_f32 v218, 1.0, v218
    v_rcp_f32 v218, v218
    v_mfma_f32_32x32x16_bf16 v[96:111], a[152:155], a[116:119], v[96:111]
    ds_read_b64_tr_b16 a[152:153], v32 offset:43008
    ds_read_b64_tr_b16 a[154:155], v32 offset:43520
    v_mul_f32 v86, v86, v218
    buffer_load_dwordx4 v51, s[28:31], s83 offen offset:3072 sc1 lds
    v_mfma_f32_32x32x16_bf16 v[112:127], a[156:159], a[116:119], v[112:127]
    ds_read_b64_tr_b16 a[156:157], v35 offset:43008
    ds_read_b64_tr_b16 a[158:159], v35 offset:43520
    v_mul_f32 v219, s86, v87
    v_exp_f32 v219, v219
    v_mul_f32 v220, s86, v88
    s_waitcnt lgkmcnt(8)
    v_mfma_f32_32x32x16_bf16 v[96:111], a[160:163], a[120:123], v[96:111]
    ds_read_b64_tr_b16 a[160:161], v32 offset:45056
    ds_read_b64_tr_b16 a[162:163], v32 offset:45568
    v_add_f32 v219, 1.0, v219
    v_rcp_f32 v219, v219
    v_mul_f32 v221, s86, v89
    v_mfma_f32_32x32x16_bf16 v[112:127], a[164:167], a[120:123], v[112:127]
    s_add_u32 m0, s53, 0x12000
    s_nop 0
    buffer_load_dwordx4 v52, s[28:31], s83 offen sc1 lds
    ds_read_b64_tr_b16 a[164:165], v35 offset:45056
    v_mfma_f32_32x32x16_bf16 v[96:111], a[168:171], a[124:127], v[96:111]
    ds_read_b64_tr_b16 a[166:167], v35 offset:45568
    ds_read_b64_tr_b16 a[168:169], v32 offset:47104
    ds_read_b64_tr_b16 a[170:171], v32 offset:47616
    v_mul_f32 v87, v87, v219
    v_cvt_pk_bf16_f32 v179, v86, v87
    v_mul_f32 v222, s86, v90
    s_nop 0
L_pad69:
    s_cbranch_execz L_wret
    v_mfma_f32_32x32x16_bf16 v[112:127], a[172:175], a[124:127], v[112:127]
    ds_read_b64_tr_b16 a[172:173], v35 offset:47104
    ds_read_b64_tr_b16 a[174:175], v35 offset:47616
    v_exp_f32 v220, v220
    v_exp_f32 v221, v221
    s_waitcnt lgkmcnt(8)
    v_mfma_f32_32x32x16_bf16 v[96:111], a[144:147], a[128:131], v[96:111]
    s_mov_b32 s85, 0x3000
    buffer_store_dwordx4 v[176:179], v24, s[32:35], s85 offen sc1
    v_add_f32 v220, 1.0, v220
    v_add_f32 v221, 1.0, v221
    v_mfma_f32_32x32x16_bf16 v[112:127], a[148:151], a[128:131], v[112:127]
    v_rcp_f32 v220, v220
    v_rcp_f32 v221, v221
    v_mul_f32 v88, v88, v220
    v_mul_f32 v89, v89, v221
    v_mfma_f32_32x32x16_bf16 v[96:111], a[152:155], a[132:135], v[96:111]
    s_barrier
    ds_read_b64_tr_b16 a[144:145], v36 offset:0
    ds_read_b64_tr_b16 a[146:147], v36 offset:256
    ds_read_b64_tr_b16 a[148:149], v36 offset:2048
    s_add_u32 m0, s53, 0x16000
    s_add_i32 s82, s89, 0
    s_mul_i32 s84, s82, 0x1b200
    s_cmp_lt_i32 s82, 0
    s_cselect_b32 s84, 0x40000000, s84
    buffer_load_dwordx4 v48, s[28:31], s84 offen sc1 lds
    v_mfma_f32_32x32x16_bf16 v[112:127], a[156:159], a[132:135], v[112:127]
    ds_read_b64_tr_b16 a[150:151], v36 offset:2304
    ds_read_b64_tr_b16 a[152:153], v36 offset:4096
    ds_read_b64_tr_b16 a[154:155], v36 offset:4352
    ds_read_b64_tr_b16 a[156:157], v36 offset:6144
    ds_read_b64_tr_b16 a[158:159], v36 offset:6400
    v_cvt_pk_bf16_f32 v180, v88, v89
    s_waitcnt lgkmcnt(8)
    v_mfma_f32_32x32x16_bf16 v[96:111], a[160:163], a[136:139], v[96:111]
    ds_read_b64_tr_b16 a[160:161], v36 offset:1024
    ds_read_b64_tr_b16 a[162:163], v36 offset:1280
    v_exp_f32 v222, v222
    v_mul_f32 v223, s86, v91
    v_add_f32 v222, 1.0, v222
    v_mfma_f32_32x32x16_bf16 v[112:127], a[164:167], a[136:139], v[112:127]
    buffer_load_dwordx4 v49, s[28:31], s84 offen offset:1024 sc1 lds
    ds_read_b64_tr_b16 a[164:165], v36 offset:3072
    ds_read_b64_tr_b16 a[166:167], v36 offset:3328
    v_mul_f32 v212, s86, v92
    v_mfma_f32_32x32x16_bf16 v[96:111], a[168:171], a[140:143], v[96:111]
    ds_read_b64_tr_b16 a[168:169], v36 offset:5120
    ds_read_b64_tr_b16 a[170:171], v36 offset:5376
    v_rcp_f32 v222, v222
    v_exp_f32 v223, v223
    v_mfma_f32_32x32x16_bf16 v[112:127], a[172:175], a[140:143], v[112:127]
    ds_read_b64_tr_b16 a[172:173], v36 offset:7168
    ds_read_b64_tr_b16 a[174:175], v36 offset:7424
    v_mul_f32 v90, v90, v222
    buffer_load_dwordx4 v50, s[28:31], s84 offen offset:2048 sc1 lds
    s_waitcnt lgkmcnt(8)
    v_mfma_f32_32x32x16_bf16 v[64:79], a[144:147], a[0:3], 0
    ds_read_b64_tr_b16 a[144:145], v36 offset:8192
    ds_read_b64_tr_b16 a[146:147], v36 offset:8448
    v_add_f32 v223, 1.0, v223
    v_rcp_f32 v223, v223
    v_mul_f32 v213, s86, v93
    v_mfma_f32_32x32x16_bf16 v[64:79], a[148:151], a[4:7], v[64:79]
    ds_read_b64_tr_b16 a[148:149], v36 offset:10240
    ds_read_b64_tr_b16 a[150:151], v36 offset:10496
    v_mul_f32 v91, v91, v223
    v_cvt_pk_bf16_f32 v181, v90, v91
    v_exp_f32 v212, v212
    v_mfma_f32_32x32x16_bf16 v[64:79], a[152:155], a[8:11], v[64:79]
    buffer_load_dwordx4 v51, s[28:31], s84 offen offset:3072 sc1 lds
    ds_read_b64_tr_b16 a[152:153], v36 offset:12288
    ds_read_b64_tr_b16 a[154:155], v36 offset:12544
    v_add_f32 v212, 1.0, v212
    v_mfma_f32_32x32x16_bf16 v[64:79], a[156:159], a[12:15], v[64:79]
    ds_read_b64_tr_b16 a[156:157], v36 offset:14336
    ds_read_b64_tr_b16 a[158:159], v36 offset:14592
    v_rcp_f32 v212, v212
L_pad70:
    s_cbranch_execz L_wret
    v_exp_f32 v213, v213
    s_waitcnt lgkmcnt(8)
    v_mfma_f32_32x32x16_bf16 v[64:79], a[160:163], a[16:19], v[64:79]
    ds_read_b64_tr_b16 a[160:161], v36 offset:9216
    ds_read_b64_tr_b16 a[162:163], v36 offset:9472
    v_mul_f32 v92, v92, v212
    v_add_f32 v213, 1.0, v213
    v_rcp_f32 v213, v213
    v_mfma_f32_32x32x16_bf16 v[64:79], a[164:167], a[20:23], v[64:79]
    s_add_u32 m0, s53, 0x17000
    s_nop 0
    buffer_load_dwordx4 v52, s[28:31], s84 offen sc1 lds
    ds_read_b64_tr_b16 a[164:165], v36 offset:11264
    v_mfma_f32_32x32x16_bf16 v[64:79], a[168:171], a[24:27], v[64:79]
    ds_read_b64_tr_b16 a[166:167], v36 offset:11520
    ds_read_b64_tr_b16 a[168:169], v36 offset:13312
    ds_read_b64_tr_b16 a[170:171], v36 offset:13568
    v_mul_f32 v93, v93, v213
    v_cvt_pk_bf16_f32 v182, v92, v93
    v_mul_f32 v214, s86, v94
    v_mfma_f32_32x32x16_bf16 v[64:79], a[172:175], a[28:31], v[64:79]
    ds_read_b64_tr_b16 a[172:173], v36 offset:15360
    ds_read_b64_tr_b16 a[174:175], v36 offset:15616
    v_exp_f32 v214, v214
    v_mul_f32 v215, s86, v95
    v_add_f32 v214, 1.0, v214
    s_waitcnt lgkmcnt(8)
    v_mfma_f32_32x32x16_bf16 v[64:79], a[144:147], a[32:35], v[64:79]
    ds_read_b64_tr_b16 a[144:145], v36 offset:16384
    ds_read_b64_tr_b16 a[146:147], v36 offset:16640
    v_rcp_f32 v214, v214
    v_exp_f32 v215, v215
    v_mfma_f32_32x32x16_bf16 v[64:79], a[148:151], a[36:39], v[64:79]
    ds_read_b64_tr_b16 a[148:149], v36 offset:18432
    ds_read_b64_tr_b16 a[150:151], v36 offset:18688
    v_mul_f32 v94, v94, v214
    v_add_f32 v215, 1.0, v215
    v_rcp_f32 v215, v215
    v_mfma_f32_32x32x16_bf16 v[64:79], a[152:155], a[40:43], v[64:79]
    ds_read_b64_tr_b16 a[152:153], v36 offset:20480
    ds_read_b64_tr_b16 a[154:155], v36 offset:20736
    v_mul_f32 v95, v95, v215
    v_cvt_pk_bf16_f32 v183, v94, v95
    s_waitcnt vmcnt(18)
    v_accvgpr_write_b32 a178, v242
    v_mfma_f32_32x32x16_bf16 v[64:79], a[156:159], a[44:47], v[64:79]
    s_mov_b32 s85, 0x3000
    buffer_store_dwordx4 v[180:183], v24, s[32:35], s85 offen offset:1024 sc1
    ds_read_b64_tr_b16 a[156:157], v36 offset:22528
    ds_read_b64_tr_b16 a[158:159], v36 offset:22784
    s_waitcnt lgkmcnt(8)
    v_mfma_f32_32x32x16_bf16 v[64:79], a[160:163], a[48:51], v[64:79]
    ds_read_b64_tr_b16 a[160:161], v36 offset:17408
    ds_read_b64_tr_b16 a[162:163], v36 offset:17664
    s_and_b32 s80, s49, 1
    s_cselect_b64 s[90:91], s[94:95], -1
    v_cndmask_b32 v252, 0, v240, s[90:91]
    v_accvgpr_write_b32 a176, v252
    v_mfma_f32_32x32x16_bf16 v[64:79], a[164:167], a[52:55], v[64:79]
    ds_read_b64_tr_b16 a[164:165], v36 offset:19456
    ds_read_b64_tr_b16 a[166:167], v36 offset:19712
    s_and_b32 s80, s49, 1
    s_cselect_b64 s[90:91], s[94:95], -1
    v_cndmask_b32 v253, 0, v241, s[90:91]
    v_accvgpr_write_b32 a177, v253
    v_mfma_f32_32x32x16_bf16 v[64:79], a[168:171], a[56:59], v[64:79]
    ds_read_b64_tr_b16 a[168:169], v36 offset:21504
    ds_read_b64_tr_b16 a[170:171], v36 offset:21760
    v_accvgpr_write_b32 a179, v243
    s_waitcnt vmcnt(17)
    v_cndmask_b32 v254, 0, v244, s[92:93]
    v_accvgpr_write_b32 a180, v254
    v_mfma_f32_32x32x16_bf16 v[64:79], a[172:175], a[60:63], v[64:79]
    ds_read_b64_tr_b16 a[172:173], v36 offset:23552
    ds_read_b64_tr_b16 a[174:175], v36 offset:23808
    s_and_b32 s80, s49, 1
    s_cselect_b64 s[90:91], s[92:93], 0
L_pad71:
    s_cbranch_execz L_wret
    v_cndmask_b32 v255, 0, v245, s[90:91]
    v_accvgpr_write_b32 a181, v255
    s_waitcnt lgkmcnt(9)
    v_mfma_f32_32x32x16_bf16 v[64:79], a[144:147], a[64:67], v[64:79]
    s_and_b32 s80, s49, 1
    s_cselect_b64 s[90:91], s[92:93], 0
    v_cndmask_b32 v252, 0, v246, s[90:91]
    v_accvgpr_write_b32 a182, v252
    s_waitcnt vmcnt(16)
    v_accvgpr_write_b32 a184, v248
    v_mfma_f32_32x32x16_bf16 v[64:79], a[148:151], a[68:71], v[64:79]
    v_accvgpr_write_b32 a185, v249
    s_and_b32 s80, s49, 1
    s_cselect_b64 s[90:91], -1, s[92:93]
    v_cndmask_b32 v253, 0, v250, s[90:91]
    v_accvgpr_write_b32 a186, v253
    v_cndmask_b32 v253, 0, v247, s[92:93]
    v_mfma_f32_32x32x16_bf16 v[64:79], a[152:155], a[72:75], v[64:79]
    s_barrier
    s_add_u32 m0, s52, 0x1e000
    s_add_u32 s83, s3, s87
    buffer_load_dwordx4 v21, s[20:23], s83 offen lds
    s_waitcnt lgkmcnt(2)
    v_mfma_f32_32x32x16_bf16 v[64:79], a[156:159], a[76:79], v[64:79]
    ds_read_b64_tr_b16 a[144:145], v36 offset:24576
    ds_read_b64_tr_b16 a[146:147], v36 offset:24832
    ds_read_b64_tr_b16 a[148:149], v36 offset:26624
    ds_read_b64_tr_b16 a[150:151], v36 offset:26880
    ds_read_b64_tr_b16 a[152:153], v36 offset:28672
    ds_read_b64_tr_b16 a[154:155], v36 offset:28928
    v_mfma_f32_32x32x16_bf16 v[64:79], a[160:163], a[80:83], v[64:79]
    ds_read_b64_tr_b16 a[156:157], v36 offset:30720
    ds_read_b64_tr_b16 a[158:159], v36 offset:30976
    ds_read_b64_tr_b16 a[160:161], v36 offset:25600
    ds_read_b64_tr_b16 a[162:163], v36 offset:25856
    v_accvgpr_write_b32 a191, v253
    v_mul_f32 v212, s86, v96
    v_mfma_f32_32x32x16_bf16 v[64:79], a[164:167], a[84:87], v[64:79]
    buffer_load_dwordx4 v22, s[20:23], s83 offen offset:1024 lds
    ds_read_b64_tr_b16 a[164:165], v36 offset:27648
    ds_read_b64_tr_b16 a[166:167], v36 offset:27904
    v_mul_f32 v213, s86, v97
    v_mfma_f32_32x32x16_bf16 v[64:79], a[168:171], a[88:91], v[64:79]
    ds_read_b64_tr_b16 a[168:169], v36 offset:29696
    ds_read_b64_tr_b16 a[170:171], v36 offset:29952
    s_and_b32 s80, s49, 1
    s_cselect_b64 s[90:91], -1, s[92:93]
    v_cndmask_b32 v254, 0, v251, s[90:91]
    v_accvgpr_write_b32 a187, v254
    s_waitcnt lgkmcnt(14)
    v_mfma_f32_32x32x16_bf16 v[64:79], a[172:175], a[92:95], v[64:79]
    ds_read_b64_tr_b16 a[172:173], v36 offset:31744
    ds_read_b64_tr_b16 a[174:175], v36 offset:32000
    buffer_load_dwordx4 v23, s[20:23], s83 offen offset:2048 lds
    v_mul_f32 v214, s86, v98
    s_waitcnt lgkmcnt(11)
    v_mfma_f32_32x32x16_bf16 v[64:79], a[144:147], a[96:99], v[64:79]
    ds_read_b64_tr_b16 a[144:145], v36 offset:32768
    ds_read_b64_tr_b16 a[146:147], v36 offset:33024
    s_and_b32 s80, s49, 1
    s_cselect_b64 s[90:91], 0, s[92:93]
    v_cndmask_b32 v255, 0, v245, s[90:91]
    v_accvgpr_write_b32 a189, v255
    v_mfma_f32_32x32x16_bf16 v[64:79], a[148:151], a[100:103], v[64:79]
    ds_read_b64_tr_b16 a[148:149], v36 offset:34816
    ds_read_b64_tr_b16 a[150:151], v36 offset:35072
    s_and_b32 s80, s49, 1
    s_cselect_b64 s[90:91], 0, s[92:93]
    v_cndmask_b32 v252, 0, v246, s[90:91]
    v_accvgpr_write_b32 a190, v252
    s_waitcnt lgkmcnt(8)
    v_mfma_f32_32x32x16_bf16 v[64:79], a[152:155], a[104:107], v[64:79]
    s_add_u32 m0, s52, 0x1ec00
    s_add_u32 s84, s83, 0x4800
L_pad72:
    s_cbranch_execz L_wret
    buffer_load_dwordx4 v21, s[20:23], s84 offen lds
    ds_read_b64_tr_b16 a[152:153], v36 offset:36864
    v_mfma_f32_32x32x16_bf16 v[64:79], a[156:159], a[108:111], v[64:79]
    ds_read_b64_tr_b16 a[154:155], v36 offset:37120
    ds_read_b64_tr_b16 a[156:157], v36 offset:38912
    ds_read_b64_tr_b16 a[158:159], v36 offset:39168
    v_exp_f32 v212, v212
    v_mul_f32 v215, s86, v99
    v_mfma_f32_32x32x16_bf16 v[64:79], a[160:163], a[112:115], v[64:79]
    v_add_f32 v212, 1.0, v212
    v_rcp_f32 v212, v212
    v_exp_f32 v213, v213
    v_mul_f32 v96, v96, v212
    v_mfma_f32_32x32x16_bf16 v[64:79], a[164:167], a[116:119], v[64:79]
    buffer_load_dwordx4 v22, s[20:23], s84 offen offset:1024 lds
    v_add_f32 v213, 1.0, v213
    v_rcp_f32 v213, v213
    s_waitcnt lgkmcnt(4)
    v_mfma_f32_32x32x16_bf16 v[64:79], a[168:171], a[120:123], v[64:79]
    s_waitcnt vmcnt(12)
    s_barrier
    v_mov_b32 v16, 1
    ds_read_b128 a[0:3], v53 offset:5120
    ds_read_b128 a[4:7], v54 offset:7168
    ds_read_b128 a[8:11], v53 offset:6144
    v_mfma_f32_32x32x16_bf16 v[64:79], a[172:175], a[124:127], v[64:79]
    ds_read_b128 a[12:15], v53 offset:10240
    ds_read_b128 a[16:19], v54 offset:12288
    buffer_load_dwordx4 v23, s[20:23], s84 offen offset:2048 lds
    ds_read_b128 a[20:23], v53 offset:11264
    v_mfma_f32_32x32x16_bf16 v[64:79], a[144:147], a[128:131], v[64:79]
    ds_read_b128 a[24:27], v53 offset:15360
    ds_read_b128 a[28:31], v54 offset:17408
    ds_read_b128 a[32:35], v53 offset:16384
    ds_read_b128 a[36:39], v53 offset:20480
    ds_read_b128 a[40:43], v54 offset:22528
    ds_read_b128 a[44:47], v53 offset:21504
    v_mfma_f32_32x32x16_bf16 v[64:79], a[148:151], a[132:135], v[64:79]
    ds_read_b128 a[84:87], v53 offset:0
    ds_read_b128 a[88:91], v54 offset:2048
    ds_read_b128 a[92:95], v53 offset:1024
    ds_read_b128 a[192:195], v55 offset:7680
    ds_read_b128 a[196:199], v55 offset:8960
    ds_read_b128 a[200:203], v55 offset:12800
    s_waitcnt lgkmcnt(15)
    v_mfma_f32_32x32x16_bf16 v[64:79], a[152:155], a[136:139], v[64:79]
    buffer_store_dword v16, v29, s[28:31], 0 offen sc1
    ds_read_b128 a[204:207], v55 offset:14080
    ds_read_b128 a[208:211], v55 offset:17920
    ds_read_b128 a[212:215], v55 offset:19200
    v_mfma_f32_32x32x16_bf16 v[64:79], a[156:159], a[140:143], v[64:79]
    s_add_u32 m0, s52, 0
    s_add_u32 s83, s4, s87
    buffer_load_dwordx4 v21, s[20:23], s83 offen lds
    ds_read_b128 a[216:219], v55 offset:23040
    v_mfma_f32_32x32x16_bf16 v[80:95], a[0:3], a[176:179], 0
    ds_read_b128 a[220:223], v55 offset:24320
    ds_read_b128 a[128:131], v55 offset:2560
    ds_read_b128 a[132:135], v55 offset:3840
    v_mul_f32 v97, v97, v213
    v_cvt_pk_bf16_f32 v184, v96, v97
    v_mul_f32 v216, s86, v100
    v_mfma_f32_32x32x16_bf16 v[80:95], a[4:7], a[180:183], v[80:95]
    v_exp_f32 v214, v214
    v_exp_f32 v215, v215
    v_add_f32 v214, 1.0, v214
    buffer_load_dwordx4 v22, s[20:23], s83 offen offset:1024 lds
    v_rcp_f32 v214, v214
    v_add_f32 v215, 1.0, v215
    v_mul_f32 v98, v98, v214
    v_rcp_f32 v215, v215
    v_exp_f32 v216, v216
    v_mul_f32 v99, v99, v215
    v_cvt_pk_bf16_f32 v185, v98, v99
    v_add_f32 v216, 1.0, v216
    v_rcp_f32 v216, v216
    v_mul_f32 v217, s86, v101
    v_mul_f32 v100, v100, v216
    v_exp_f32 v217, v217
L_pad73:
    s_cbranch_execz L_wret
    buffer_load_dwordx4 v23, s[20:23], s83 offen offset:2048 lds
    v_add_f32 v217, 1.0, v217
    v_rcp_f32 v217, v217
    v_mul_f32 v218, s86, v102
    v_mul_f32 v101, v101, v217
    v_cvt_pk_bf16_f32 v186, v100, v101
    v_exp_f32 v218, v218
    v_mul_f32 v219, s86, v103
    v_add_f32 v218, 1.0, v218
    v_rcp_f32 v218, v218
    v_exp_f32 v219, v219
    v_mul_f32 v102, v102, v218
    v_add_f32 v219, 1.0, v219
    s_add_u32 m0, s52, 0xc00
    s_add_u32 s84, s83, 0x4800
    buffer_load_dwordx4 v21, s[20:23], s84 offen lds
    v_rcp_f32 v219, v219
    v_mul_f32 v220, s86, v104
    v_mul_f32 v103, v103, v219
    v_cvt_pk_bf16_f32 v187, v102, v103
    v_exp_f32 v220, v220
    v_mul_f32 v221, s86, v105
    v_add_f32 v220, 1.0, v220
    v_rcp_f32 v220, v220
    v_exp_f32 v221, v221
    v_mul_f32 v104, v104, v220
    v_add_f32 v221, 1.0, v221
    v_rcp_f32 v221, v221
    buffer_load_dwordx4 v22, s[20:23], s84 offen offset:1024 lds
    v_mul_f32 v105, v105, v221
    v_cvt_pk_bf16_f32 v188, v104, v105
    v_mul_f32 v222, s86, v106
    v_exp_f32 v222, v222
    v_mul_f32 v223, s86, v107
    v_add_f32 v222, 1.0, v222
    v_rcp_f32 v222, v222
    v_exp_f32 v223, v223
    v_mul_f32 v106, v106, v222
    v_add_f32 v223, 1.0, v223
    v_rcp_f32 v223, v223
    v_mul_f32 v212, s86, v108
    buffer_load_dwordx4 v23, s[20:23], s84 offen offset:2048 lds
    v_mul_f32 v107, v107, v223
    v_cvt_pk_bf16_f32 v189, v106, v107
    v_exp_f32 v212, v212
    v_mul_f32 v213, s86, v109
    v_add_f32 v212, 1.0, v212
    v_rcp_f32 v212, v212
    v_exp_f32 v213, v213
    v_mul_f32 v108, v108, v212
    v_add_f32 v213, 1.0, v213
    v_rcp_f32 v213, v213
    v_mul_f32 v214, s86, v110
    v_mul_f32 v109, v109, v213
    s_add_u32 m0, s54, 0x24000
    s_mov_b32 exec_hi, 15
    buffer_load_dwordx4 v28, s[24:27], s55 offen lds
    s_mov_b32 exec_hi, -1
    s_add_u32 s55, s55, 0x480
    v_cvt_pk_bf16_f32 v190, v108, v109
    v_exp_f32 v214, v214
    v_mul_f32 v215, s86, v111
    v_add_f32 v214, 1.0, v214
    s_add_u32 m0, s54, 0x24240
    s_mov_b32 exec_hi, 15
    buffer_load_dwordx4 v28, s[24:27], s55 offen lds
    s_mov_b32 exec_hi, -1
    v_rcp_f32 v214, v214
    v_exp_f32 v215, v215
    v_mul_f32 v110, v110, v214
    v_add_f32 v215, 1.0, v215
    v_rcp_f32 v215, v215
    v_mul_f32 v212, s86, v112
    v_mul_f32 v111, v111, v215
    v_cvt_pk_bf16_f32 v191, v110, v111
    v_mfma_f32_32x32x16_bf16 v[96:111], a[8:11], a[184:187], 0
    v_exp_f32 v212, v212
    v_mul_f32 v213, s86, v113
    v_add_f32 v212, 1.0, v212
    v_rcp_f32 v212, v212
    v_mfma_f32_32x32x16_bf16 v[96:111], a[4:7], a[188:191], v[96:111]
    v_mul_f32 v112, v112, v212
    v_exp_f32 v213, v213
    v_mul_f32 v214, s86, v114
    v_add_f32 v213, 1.0, v213
    v_rcp_f32 v213, v213
    v_exp_f32 v214, v214
    v_mul_f32 v113, v113, v213
    v_cvt_pk_bf16_f32 v192, v112, v113
    v_add_f32 v214, 1.0, v214
    v_rcp_f32 v214, v214
    v_mul_f32 v215, s86, v115
    v_mul_f32 v114, v114, v214
    v_exp_f32 v215, v215
    v_mul_f32 v216, s86, v116
    v_add_f32 v215, 1.0, v215
    v_rcp_f32 v215, v215
    v_exp_f32 v216, v216
    v_mul_f32 v115, v115, v215
    v_cvt_pk_bf16_f32 v193, v114, v115
    v_add_f32 v216, 1.0, v216
    v_rcp_f32 v216, v216
    v_mul_f32 v217, s86, v117
    v_mul_f32 v116, v116, v216
    v_exp_f32 v217, v217
    v_mul_f32 v218, s86, v118
L_pad74:
    s_cbranch_execz L_wret
    v_add_f32 v217, 1.0, v217
    v_rcp_f32 v217, v217
    v_exp_f32 v218, v218
    v_mul_f32 v117, v117, v217
    v_cvt_pk_bf16_f32 v194, v116, v117
    v_add_f32 v218, 1.0, v218
    v_rcp_f32 v218, v218
    v_mul_f32 v219, s86, v119
    v_mul_f32 v118, v118, v218
    v_exp_f32 v219, v219
    v_mul_f32 v220, s86, v120
    v_add_f32 v219, 1.0, v219
    v_rcp_f32 v219, v219
    v_exp_f32 v220, v220
    v_mul_f32 v119, v119, v219
    v_cvt_pk_bf16_f32 v195, v118, v119
    v_add_f32 v220, 1.0, v220
    v_rcp_f32 v220, v220
    v_mul_f32 v221, s86, v121
    v_mul_f32 v120, v120, v220
    v_exp_f32 v221, v221
    v_mul_f32 v222, s86, v122
    v_add_f32 v221, 1.0, v221
    v_rcp_f32 v221, v221
    v_exp_f32 v222, v222
    v_mul_f32 v121, v121, v221
    v_cvt_pk_bf16_f32 v196, v120, v121
    v_add_f32 v222, 1.0, v222
    v_rcp_f32 v222, v222
    v_mul_f32 v223, s86, v123
    v_mul_f32 v122, v122, v222
    v_exp_f32 v223, v223
    v_mul_f32 v212, s86, v124
    v_add_f32 v223, 1.0, v223
    v_rcp_f32 v223, v223
    v_exp_f32 v212, v212
    v_mul_f32 v123, v123, v223
    v_cvt_pk_bf16_f32 v197, v122, v123
    v_add_f32 v212, 1.0, v212
    v_rcp_f32 v212, v212
    v_mul_f32 v213, s86, v125
    v_mul_f32 v124, v124, v212
    v_exp_f32 v213, v213
    v_mul_f32 v214, s86, v126
    v_add_f32 v213, 1.0, v213
    v_rcp_f32 v213, v213
    v_exp_f32 v214, v214
    v_mul_f32 v125, v125, v213
    v_cvt_pk_bf16_f32 v198, v124, v125
    v_add_f32 v214, 1.0, v214
    v_rcp_f32 v214, v214
    v_mul_f32 v215, s86, v127
    v_mul_f32 v126, v126, v214
    v_exp_f32 v215, v215
    v_mul_f32 v212, s86, v64
    v_add_f32 v215, 1.0, v215
    v_rcp_f32 v215, v215
    v_exp_f32 v212, v212
    v_mul_f32 v127, v127, v215
    v_cvt_pk_bf16_f32 v199, v126, v127
    v_add_f32 v212, 1.0, v212
    v_rcp_f32 v212, v212
    v_mul_f32 v213, s86, v65
    v_mul_f32 v64, v64, v212
    v_exp_f32 v213, v213
    v_mul_f32 v214, s86, v66
    v_add_f32 v213, 1.0, v213
    v_rcp_f32 v213, v213
    v_exp_f32 v214, v214
    v_mul_f32 v65, v65, v213
    v_cvt_pk_bf16_f32 v128, v64, v65
    v_add_f32 v214, 1.0, v214
    v_rcp_f32 v214, v214
    v_mul_f32 v215, s86, v67
    v_mul_f32 v66, v66, v214
    v_exp_f32 v215, v215
    v_mul_f32 v216, s86, v68
    v_add_f32 v215, 1.0, v215
    v_rcp_f32 v215, v215
    v_exp_f32 v216, v216
    v_mul_f32 v67, v67, v215
    v_cvt_pk_bf16_f32 v129, v66, v67
    v_add_f32 v216, 1.0, v216
    v_rcp_f32 v216, v216
    v_mul_f32 v217, s86, v69
    v_mul_f32 v68, v68, v216
    v_exp_f32 v217, v217
    v_mul_f32 v218, s86, v70
    v_add_f32 v217, 1.0, v217
    v_rcp_f32 v217, v217
    v_exp_f32 v218, v218
    v_mul_f32 v69, v69, v217
    v_cvt_pk_bf16_f32 v130, v68, v69
    v_add_f32 v218, 1.0, v218
    v_rcp_f32 v218, v218
    v_mul_f32 v219, s86, v71
    v_mul_f32 v70, v70, v218
    v_exp_f32 v219, v219
    v_mul_f32 v220, s86, v72
    v_add_f32 v219, 1.0, v219
    v_rcp_f32 v219, v219
    v_exp_f32 v220, v220
    v_mul_f32 v71, v71, v219
    v_cvt_pk_bf16_f32 v131, v70, v71
    v_add_f32 v220, 1.0, v220
    v_rcp_f32 v220, v220
    v_mul_f32 v221, s86, v73
    v_mul_f32 v72, v72, v220
    v_exp_f32 v221, v221
    v_mul_f32 v222, s86, v74
    v_add_f32 v221, 1.0, v221
    v_rcp_f32 v221, v221
    v_exp_f32 v222, v222
    v_mul_f32 v73, v73, v221
    v_cvt_pk_bf16_f32 v132, v72, v73
    v_add_f32 v222, 1.0, v222
L_pad75:
    s_cbranch_execz L_wret
    v_rcp_f32 v222, v222
    v_mul_f32 v223, s86, v75
    v_mul_f32 v74, v74, v222
    v_exp_f32 v223, v223
    v_mul_f32 v212, s86, v76
    v_add_f32 v223, 1.0, v223
    v_rcp_f32 v223, v223
    v_exp_f32 v212, v212
    v_mul_f32 v75, v75, v223
    v_cvt_pk_bf16_f32 v133, v74, v75
    v_add_f32 v212, 1.0, v212
    v_rcp_f32 v212, v212
    v_mul_f32 v213, s86, v77
    v_mul_f32 v76, v76, v212
    v_exp_f32 v213, v213
    v_mul_f32 v214, s86, v78
    v_add_f32 v213, 1.0, v213
    v_rcp_f32 v213, v213
    v_exp_f32 v214, v214
    v_mul_f32 v77, v77, v213
    v_cvt_pk_bf16_f32 v134, v76, v77
    v_add_f32 v214, 1.0, v214
    v_rcp_f32 v214, v214
    v_mul_f32 v215, s86, v79
    v_mul_f32 v78, v78, v214
    v_exp_f32 v215, v215
    v_max3_f32 v44, v44, v80, v81
    v_add_f32 v215, 1.0, v215
    v_rcp_f32 v215, v215
    v_max3_f32 v44, v44, v82, v83
    v_mul_f32 v79, v79, v215
    v_cvt_pk_bf16_f32 v135, v78, v79
    v_max3_f32 v44, v44, v84, v85
    v_max3_f32 v44, v44, v86, v87
    v_max3_f32 v44, v44, v88, v89
    v_max3_f32 v44, v44, v90, v91
    v_max3_f32 v44, v44, v92, v93
    v_max3_f32 v44, v44, v94, v95
    s_waitcnt lgkmcnt(0)
    v_mfma_f32_32x32x16_bf16 v[80:95], a[12:15], a[176:179], 0
    s_waitcnt vmcnt(16)
    s_barrier
    buffer_load_dword v27, v26, s[28:31], 0 offen sc1
    ds_read_b128 a[48:51], v53 offset:25600
    ds_read_b128 a[52:55], v54 offset:27648
    v_mfma_f32_32x32x16_bf16 v[80:95], a[16:19], a[180:183], v[80:95]
    ds_read_b128 a[56:59], v53 offset:26624
    s_add_u32 m0, s52, 0x6000
    s_add_u32 s83, s3, s88
    buffer_load_dwordx4 v21, s[20:23], s83 offen lds
    ds_read_b128 a[60:63], v53 offset:30720
    ds_read_b128 a[64:67], v54 offset:32768
    ds_read_b128 a[68:71], v53 offset:31744
    ds_read_b128 a[72:75], v53 offset:35840
    ds_read_b128 a[76:79], v54 offset:37888
    ds_read_b128 a[80:83], v53 offset:36864
    ds_read_b128 a[96:99], v53 offset:40960
    ds_read_b128 a[100:103], v54 offset:43008
    ds_read_b128 a[104:107], v53 offset:41984
    ds_read_b128 a[224:227], v55 offset:28160
    ds_read_b128 a[228:231], v55 offset:29440
    ds_read_b128 a[232:235], v55 offset:33280
    ds_read_b128 a[236:239], v55 offset:34560
    ds_read_b128 a[240:243], v55 offset:38400
    ds_read_b128 a[124:127], v55 offset:39680
    ds_read_b128 a[136:139], v55 offset:43520
    buffer_load_dwordx4 v22, s[20:23], s83 offen offset:1024 lds
    ds_read_b128 a[140:143], v55 offset:44800
    v_min_f32 v44, s99, v44
    v_max3_f32 v45, v45, v96, v97
    v_max3_f32 v45, v45, v98, v99
    v_max3_f32 v45, v45, v100, v101
    v_max3_f32 v45, v45, v102, v103
    v_max3_f32 v45, v45, v104, v105
    v_max3_f32 v45, v45, v106, v107
    v_max3_f32 v45, v45, v108, v109
    v_max3_f32 v45, v45, v110, v111
    v_mfma_f32_32x32x16_bf16 v[96:111], a[20:23], a[184:187], 0
    v_min_f32 v45, s99, v45
    s_cmp_ge_u32 s89, 6
    s_nop 0
L_pad76:
    s_cbranch_execz L_wret
    s_mov_b32 s99, 0xf149f2ca
    s_cselect_b32 s99, 0x7f800000, s99
    v_max3_f32 v44, v44, v80, v81
    v_max3_f32 v44, v44, v82, v83
    v_mfma_f32_32x32x16_bf16 v[96:111], a[16:19], a[188:191], v[96:111]
    buffer_load_dwordx4 v23, s[20:23], s83 offen offset:2048 lds
    v_max3_f32 v44, v44, v84, v85
    v_max3_f32 v44, v44, v86, v87
    v_max3_f32 v44, v44, v88, v89
    v_max3_f32 v44, v44, v90, v91
    v_max3_f32 v44, v44, v92, v93
    v_max3_f32 v44, v44, v94, v95
    v_mfma_f32_32x32x16_bf16 v[80:95], a[24:27], a[176:179], 0
    v_min_f32 v44, s99, v44
    v_lshlrev_b32 v5, 3, v2
    v_lshl_add_u32 v5, v3, 5, v5
    v_lshl_add_u32 v7, v4, 2, v1
    v_mul_u32_u24 v7, 0xc0, v7
    v_add_u32 v30, v7, v5
    v_mfma_f32_32x32x16_bf16 v[80:95], a[28:31], a[180:183], v[80:95]
    s_add_u32 m0, s52, 0x6c00
    s_add_u32 s84, s83, 0x4800
    buffer_load_dwordx4 v21, s[20:23], s84 offen lds
    v_max3_f32 v45, v45, v96, v97
    v_max3_f32 v45, v45, v98, v99
    v_max3_f32 v45, v45, v100, v101
    v_max3_f32 v45, v45, v102, v103
    v_max3_f32 v45, v45, v104, v105
    v_max3_f32 v45, v45, v106, v107
    v_max3_f32 v45, v45, v108, v109
    v_max3_f32 v45, v45, v110, v111
    v_mfma_f32_32x32x16_bf16 v[96:111], a[32:35], a[184:187], 0
    v_min_f32 v45, s99, v45
    s_cmp_ge_u32 s89, 5
    s_mov_b32 s99, 0xf149f2ca
    s_cselect_b32 s99, 0x7f800000, s99
    v_max3_f32 v44, v44, v80, v81
    v_max3_f32 v44, v44, v82, v83
    v_mfma_f32_32x32x16_bf16 v[96:111], a[28:31], a[188:191], v[96:111]
    buffer_load_dwordx4 v22, s[20:23], s84 offen offset:1024 lds
    v_max3_f32 v44, v44, v84, v85
    v_max3_f32 v44, v44, v86, v87
    v_max3_f32 v44, v44, v88, v89
    v_max3_f32 v44, v44, v90, v91
    v_max3_f32 v44, v44, v92, v93
    v_max3_f32 v44, v44, v94, v95
    v_mfma_f32_32x32x16_bf16 v[80:95], a[36:39], a[176:179], 0
    v_min_f32 v44, s99, v44
    v_add_u32 v31, 0xc000, v30
    v_add_u32 v32, 0x18000, v30
    v_mul_u32_u24 v7, 0x240, v1
    v_add_u32 v7, v7, v5
    v_add_u32 v7, s76, v7
    v_mfma_f32_32x32x16_bf16 v[80:95], a[40:43], a[180:183], v[80:95]
    buffer_load_dwordx4 v23, s[20:23], s84 offen offset:2048 lds
    v_max3_f32 v45, v45, v96, v97
    v_max3_f32 v45, v45, v98, v99
    v_max3_f32 v45, v45, v100, v101
    v_max3_f32 v45, v45, v102, v103
    v_max3_f32 v45, v45, v104, v105
    v_max3_f32 v45, v45, v106, v107
    v_max3_f32 v45, v45, v108, v109
    v_max3_f32 v45, v45, v110, v111
    v_mfma_f32_32x32x16_bf16 v[96:111], a[44:47], a[184:187], 0
    v_min_f32 v45, s99, v45
    s_cmp_ge_u32 s89, 4
    s_mov_b32 s99, 0xf149f2ca
    s_cselect_b32 s99, 0x7f800000, s99
    v_add_u32 v33, s87, v7
L_pad77:
    s_cbranch_execz L_wret
    v_add_u32 v34, s88, v7
    v_mfma_f32_32x32x16_bf16 v[96:111], a[40:43], a[188:191], v[96:111]
    v_max3_f32 v44, v44, v80, v81
    v_max3_f32 v44, v44, v82, v83
    v_max3_f32 v44, v44, v84, v85
    v_max3_f32 v44, v44, v86, v87
    v_max3_f32 v44, v44, v88, v89
    v_max3_f32 v44, v44, v90, v91
    v_max3_f32 v44, v44, v92, v93
    v_max3_f32 v44, v44, v94, v95
    s_waitcnt lgkmcnt(0)
    v_mfma_f32_32x32x16_bf16 v[80:95], a[48:51], a[176:179], 0
    s_mov_b32 s85, 0x3000
    buffer_store_dwordx4 v[184:187], v24, s[32:35], s85 offen offset:2048 sc1
    v_min_f32 v44, s99, v44
    v_add_u32 v35, s73, v7
    v_mfma_f32_32x32x16_bf16 v[80:95], a[52:55], a[180:183], v[80:95]
    v_max3_f32 v45, v45, v96, v97
    v_max3_f32 v45, v45, v98, v99
    v_max3_f32 v45, v45, v100, v101
    v_max3_f32 v45, v45, v102, v103
    v_max3_f32 v45, v45, v104, v105
    v_max3_f32 v45, v45, v106, v107
    v_max3_f32 v45, v45, v108, v109
    v_max3_f32 v45, v45, v110, v111
    v_mfma_f32_32x32x16_bf16 v[96:111], a[56:59], a[184:187], 0
    v_min_f32 v45, s99, v45
    s_cmp_ge_u32 s89, 3
    s_mov_b32 s99, 0xf149f2ca
    s_cselect_b32 s99, 0x7f800000, s99
    s_and_b32 s76, s49, 1
    s_mul_i32 s77, s76, 0x27000
    v_mfma_f32_32x32x16_bf16 v[96:111], a[52:55], a[188:191], v[96:111]
    s_mov_b32 s85, 0x3000
    buffer_store_dwordx4 v[188:191], v24, s[32:35], s85 offen offset:3072 sc1
    v_max3_f32 v44, v44, v80, v81
    v_max3_f32 v44, v44, v82, v83
    v_max3_f32 v44, v44, v84, v85
    v_max3_f32 v44, v44, v86, v87
    v_max3_f32 v44, v44, v88, v89
    v_max3_f32 v44, v44, v90, v91
    v_max3_f32 v44, v44, v92, v93
    v_max3_f32 v44, v44, v94, v95
    v_mfma_f32_32x32x16_bf16 v[80:95], a[60:63], a[176:179], 0
    v_min_f32 v44, s99, v44
    s_lshr_b32 s78, s49, 1
    s_lshl_b32 s78, s78, 8
    s_add_u32 s77, s77, s78
    s_add_u32 s77, s77, s51
    v_max3_f32 v45, v45, v96, v97
    v_mfma_f32_32x32x16_bf16 v[80:95], a[64:67], a[180:183], v[80:95]
    s_mov_b32 s85, 0x4000
    buffer_store_dwordx4 v[192:195], v24, s[32:35], s85 offen sc1
    v_max3_f32 v45, v45, v98, v99
    v_max3_f32 v45, v45, v100, v101
    v_max3_f32 v45, v45, v102, v103
    v_max3_f32 v45, v45, v104, v105
    v_max3_f32 v45, v45, v106, v107
    v_max3_f32 v45, v45, v108, v109
    v_max3_f32 v45, v45, v110, v111
    v_mfma_f32_32x32x16_bf16 v[96:111], a[68:71], a[184:187], 0
    v_min_f32 v45, s99, v45
    s_cmp_ge_u32 s89, 2
    s_mov_b32 s99, 0xf149f2ca
    s_cselect_b32 s99, 0x7f800000, s99
    v_lshrrev_b32 v1, 4, v60
    v_mul_u32_u24 v2, 0x4e000, v1
    v_mfma_f32_32x32x16_bf16 v[96:111], a[64:67], a[188:191], v[96:111]
    s_mov_b32 s85, 0x4000
    buffer_store_dwordx4 v[196:199], v24, s[32:35], s85 offen offset:1024 sc1
    v_max3_f32 v44, v44, v80, v81
L_pad78:
    s_cbranch_execz L_wret
    v_max3_f32 v44, v44, v82, v83
    v_max3_f32 v44, v44, v84, v85
    v_max3_f32 v44, v44, v86, v87
    v_max3_f32 v44, v44, v88, v89
    v_max3_f32 v44, v44, v90, v91
    v_max3_f32 v44, v44, v92, v93
    v_max3_f32 v44, v44, v94, v95
    v_mfma_f32_32x32x16_bf16 v[80:95], a[72:75], a[176:179], 0
    v_min_f32 v44, s99, v44
    v_and_b32 v3, 15, v60
    v_lshl_add_u32 v2, v3, 4, v2
    v_add_u32 v62, s77, v2
    s_lshr_b32 s78, s49, 1
    v_max3_f32 v45, v45, v96, v97
    v_mfma_f32_32x32x16_bf16 v[80:95], a[76:79], a[180:183], v[80:95]
    buffer_store_dwordx4 v[128:131], v24, s[32:35], 0 offen sc1
    v_max3_f32 v45, v45, v98, v99
    v_max3_f32 v45, v45, v100, v101
    v_max3_f32 v45, v45, v102, v103
    v_max3_f32 v45, v45, v104, v105
    v_max3_f32 v45, v45, v106, v107
    v_max3_f32 v45, v45, v108, v109
    v_max3_f32 v45, v45, v110, v111
    v_mfma_f32_32x32x16_bf16 v[96:111], a[80:83], a[184:187], 0
    v_min_f32 v45, s99, v45
    s_cmp_ge_u32 s89, 1
    s_mov_b32 s99, 0xf149f2ca
    s_cselect_b32 s99, 0x7f800000, s99
    s_lshl_b32 s78, s78, 2
    s_lshl_b32 s79, s89, 5
    v_mfma_f32_32x32x16_bf16 v[96:111], a[76:79], a[188:191], v[96:111]
    buffer_store_dwordx4 v[132:135], v24, s[32:35], 0 offen offset:1024 sc1
    v_max3_f32 v44, v44, v80, v81
    v_max3_f32 v44, v44, v82, v83
    v_max3_f32 v44, v44, v84, v85
    v_max3_f32 v44, v44, v86, v87
    v_max3_f32 v44, v44, v88, v89
    v_max3_f32 v44, v44, v90, v91
    v_max3_f32 v44, v44, v92, v93
    v_max3_f32 v44, v44, v94, v95
    v_mfma_f32_32x32x16_bf16 v[80:95], a[96:99], a[176:179], 0
    v_min_f32 v44, s99, v44
    s_add_u32 s78, s78, s79
    v_and_b32 v4, 3, v60
    v_add_u32 v4, s78, v4
    v_mul_u32_u24 v4, 0x480, v4
    s_mul_i32 s78, s76, 0x240
    v_mfma_f32_32x32x16_bf16 v[80:95], a[100:103], a[180:183], v[80:95]
    v_max3_f32 v45, v45, v96, v97
    v_max3_f32 v45, v45, v98, v99
    v_max3_f32 v45, v45, v100, v101
    v_max3_f32 v45, v45, v102, v103
    v_max3_f32 v45, v45, v104, v105
    v_max3_f32 v45, v45, v106, v107
    v_max3_f32 v45, v45, v108, v109
    v_max3_f32 v45, v45, v110, v111
    v_min_f32 v45, s99, v45
    s_cmp_ge_u32 s89, 8
    s_mov_b32 s99, 0xf149f2ca
    s_cselect_b32 s99, 0, s99
    v_mov_b32 v64, s99
    v_mov_b32 v65, s99
    v_mov_b32 v66, s99
    v_mov_b32 v67, s99
    v_mov_b32 v68, s99
    v_mov_b32 v69, s99
    v_mov_b32 v70, s99
    v_mov_b32 v71, s99
    v_mov_b32 v72, s99
    v_mov_b32 v73, s99
    v_mov_b32 v74, s99
    v_mov_b32 v75, s99
    s_waitcnt vmcnt(12)
    v_cmp_le_u32 vcc, 1, v27
    s_nop 1
    s_cmp_eq_u64 vcc, -1
    s_cbranch_scc0 L_slow1
L_back1:
    buffer_load_dwordx4 a[144:147], v25, s[32:35], 0 offen offset:2048 sc1
    v_mov_b32 v76, s99
    v_mov_b32 v77, s99
    v_mov_b32 v78, s99
L_pad79:
    s_cbranch_execz L_wret
    v_mov_b32 v79, s99
    v_lshl_add_u32 v4, v1, 4, v4
    v_bfe_u32 v5, v60, 3, 1
    v_mfma_f32_32x32x16_bf16 v[112:127], a[84:87], a[176:179], v[64:79]
    v_lshl_add_u32 v4, v5, 5, v4
    v_bfe_u32 v5, v60, 2, 1
    v_lshl_add_u32 v4, v5, 3, v4
    v_add_u32 v4, s78, v4
    v_mov_b32 v5, 0x7ffffff0
    v_cndmask_b32 v63, v5, v4, s[92:93]
    v_mfma_f32_32x32x16_bf16 v[112:127], a[88:91], a[180:183], v[112:127]
    buffer_load_dwordx4 a[148:151], v25, s[32:35], 0 offen offset:3072 sc1
    v_and_b32 v6, 7, v60
    v_lshl_add_u32 v59, v6, 2, v26
    v_subrev_u32 v59, 0x20000, v59
    s_lshr_b32 s79, s49, 1
    v_mfma_f32_32x32x16_bf16 v[96:111], a[92:95], a[184:187], v[64:79]
    v_cmp_eq_u32 vcc, s79, v6
    v_mov_b32 v5, 12
    v_mfma_f32_32x32x16_bf16 v[96:111], a[88:91], a[188:191], v[96:111]
    v_cndmask_b32 v17, 0, v5, vcc
    v_mov_b32 v5, 0x3f80
    s_mov_b32 s72, 0x1000
    buffer_load_dwordx4 a[152:155], v25, s[32:35], s72 offen sc1
    v_bfi_b32 v80, v224, v80, v112
    v_bfi_b32 v81, v225, v81, v113
    v_max3_f32 v44, v44, v80, v81
    v_bfi_b32 v82, v226, v82, v114
    v_bfi_b32 v83, v227, v83, v115
    v_max3_f32 v44, v44, v82, v83
    v_bfi_b32 v84, v228, v84, v116
    v_bfi_b32 v85, v229, v85, v117
    v_max3_f32 v44, v44, v84, v85
    v_bfi_b32 v86, v230, v86, v118
    v_bfi_b32 v87, v231, v87, v119
    v_max3_f32 v44, v44, v86, v87
    v_bfi_b32 v88, v232, v88, v120
    v_bfi_b32 v89, v233, v89, v121
    v_max3_f32 v44, v44, v88, v89
    v_bfi_b32 v90, v234, v90, v122
    s_mov_b32 s72, 0x1000
    buffer_load_dwordx4 a[156:159], v25, s[32:35], s72 offen offset:1024 sc1
    v_bfi_b32 v91, v235, v91, v123
    v_max3_f32 v44, v44, v90, v91
    v_bfi_b32 v92, v236, v92, v124
    v_bfi_b32 v93, v237, v93, v125
    v_max3_f32 v44, v44, v92, v93
    v_bfi_b32 v94, v238, v94, v126
    v_bfi_b32 v95, v239, v95, v127
    v_mfma_f32_32x32x16_bf16 v[112:127], a[104:107], a[184:187], 0
    v_max3_f32 v44, v44, v94, v95
    v_mov_b32 v214, v44
    v_cmp_eq_u32 vcc, 0, v3
    v_mfma_f32_32x32x16_bf16 v[112:127], a[100:103], a[188:191], v[112:127]
    s_mov_b32 s72, 0x1000
    buffer_load_dwordx4 a[160:163], v25, s[32:35], s72 offen offset:2048 sc1
    v_permlane32_swap_b32 v214, v44
    v_max_f32 v44, v44, v214
    v_sub_f32 v44, 0, v44
    v_mov_b32 v64, v44
    v_mov_b32 v65, v44
    v_mov_b32 v66, v44
    v_mov_b32 v67, v44
    v_mov_b32 v68, v44
    v_mov_b32 v69, v44
    v_mov_b32 v70, v44
    v_mov_b32 v71, v44
    v_mov_b32 v72, v44
    v_mov_b32 v73, v44
    v_mov_b32 v74, v44
    v_mov_b32 v75, v44
    v_mov_b32 v76, v44
    s_mov_b32 s72, 0x1000
    buffer_load_dwordx4 a[164:167], v25, s[32:35], s72 offen offset:3072 sc1
    v_bfi_b32 v112, v224, v112, v96
    v_bfi_b32 v113, v225, v113, v97
L_pad80:
    s_cbranch_execz L_wret
    v_max3_f32 v45, v45, v112, v113
    v_bfi_b32 v114, v226, v114, v98
    v_bfi_b32 v115, v227, v115, v99
    v_max3_f32 v45, v45, v114, v115
    v_bfi_b32 v116, v228, v116, v100
    v_bfi_b32 v117, v229, v117, v101
    v_max3_f32 v45, v45, v116, v117
    v_bfi_b32 v118, v230, v118, v102
    v_bfi_b32 v119, v231, v119, v103
    v_max3_f32 v45, v45, v118, v119
    v_bfi_b32 v120, v232, v120, v104
    v_bfi_b32 v121, v233, v121, v105
    v_max3_f32 v45, v45, v120, v121
    v_bfi_b32 v122, v234, v122, v106
    s_mov_b32 s72, 0x2000
    buffer_load_dwordx4 a[168:171], v25, s[32:35], s72 offen sc1
    v_bfi_b32 v123, v235, v123, v107
    v_max3_f32 v45, v45, v122, v123
    v_bfi_b32 v124, v236, v124, v108
    v_bfi_b32 v125, v237, v125, v109
    v_max3_f32 v45, v45, v124, v125
    v_bfi_b32 v126, v238, v126, v110
    v_bfi_b32 v127, v239, v127, v111
    v_max3_f32 v45, v45, v126, v127
    v_mov_b32 v215, v45
    v_mov_b32 v77, v44
    v_mov_b32 v78, v44
    v_permlane32_swap_b32 v215, v45
    v_max_f32 v45, v45, v215
    v_sub_f32 v45, 0, v45
    v_mov_b32 v79, v44
    v_cndmask_b32 v6, 0, v5, vcc
    s_mov_b32 s72, 0x2000
    buffer_load_dwordx4 a[172:175], v25, s[32:35], s72 offen offset:1024 sc1
    v_mfma_f32_32x32x16_bf16 v[80:95], a[0:3], a[176:179], v[64:79]
    v_mov_b32 v5, 0x3f800000
    v_cmp_eq_u32 vcc, 1, v3
    v_mfma_f32_32x32x16_bf16 v[80:95], a[4:7], a[180:183], v[80:95]
    v_mfma_f32_32x32x16_bf16 v[96:111], a[12:15], a[176:179], v[64:79]
    s_mov_b32 s72, 0x2000
    buffer_load_dwordx4 a[244:247], v25, s[32:35], s72 offen offset:2048 sc1
    v_cndmask_b32 v6, v6, v5, vcc
    v_accvgpr_write_b32 a252, v6
    v_mov_b32 v5, 0x3f80
    v_mfma_f32_32x32x16_bf16 v[96:111], a[16:19], a[180:183], v[96:111]
    v_cmp_eq_u32 vcc, 2, v3
    v_mfma_f32_32x32x16_bf16 v[112:127], a[24:27], a[176:179], v[64:79]
    s_mov_b32 s72, 0x2000
    buffer_load_dwordx4 a[248:251], v25, s[32:35], s72 offen offset:3072 sc1
    v_mfma_f32_32x32x16_bf16 v[112:127], a[28:31], a[180:183], v[112:127]
    v_exp_f32 v80, v80 clamp
    v_exp_f32 v81, v81 clamp
    v_exp_f32 v82, v82 clamp
    v_cvt_pk_bf16_f32 v240, v80, v81
    v_exp_f32 v83, v83 clamp
    v_exp_f32 v84, v84 clamp
    v_cvt_pk_bf16_f32 v241, v82, v83
    v_exp_f32 v85, v85 clamp
    v_exp_f32 v86, v86 clamp
    v_cvt_pk_bf16_f32 v242, v84, v85
    v_exp_f32 v87, v87 clamp
    v_exp_f32 v88, v88 clamp
    v_cvt_pk_bf16_f32 v243, v86, v87
    v_exp_f32 v89, v89 clamp
    s_nop 0
    v_mfma_f32_32x32x16_bf16 a[108:123], a[192:195], v[240:243], 0
    ds_read_b128 a[192:195], v56 offset:7680
    v_cvt_pk_bf16_f32 v244, v88, v89
    v_exp_f32 v90, v90 clamp
    v_exp_f32 v91, v91 clamp
L_pad81:
    s_cbranch_execz L_wret
    v_exp_f32 v92, v92 clamp
    v_cvt_pk_bf16_f32 v245, v90, v91
    v_exp_f32 v93, v93 clamp
    v_exp_f32 v94, v94 clamp
    v_cvt_pk_bf16_f32 v246, v92, v93
    v_exp_f32 v95, v95 clamp
    v_exp_f32 v96, v96 clamp
    v_cvt_pk_bf16_f32 v247, v94, v95
    v_mfma_f32_32x32x16_bf16 v[80:95], a[36:39], a[176:179], v[64:79]
    v_exp_f32 v97, v97 clamp
    v_exp_f32 v98, v98 clamp
    v_cvt_pk_bf16_f32 v248, v96, v97
    v_cndmask_b32 v6, 0, v5, vcc
    v_mfma_f32_32x32x16_bf16 a[108:123], a[196:199], v[244:247], a[108:123]
    ds_read_b128 a[196:199], v56 offset:8960
    v_exp_f32 v99, v99 clamp
    v_exp_f32 v100, v100 clamp
    v_cvt_pk_bf16_f32 v249, v98, v99
    v_mfma_f32_32x32x16_bf16 v[80:95], a[40:43], a[180:183], v[80:95]
    v_exp_f32 v101, v101 clamp
    v_exp_f32 v102, v102 clamp
    v_cvt_pk_bf16_f32 v250, v100, v101
    v_exp_f32 v103, v103 clamp
    v_exp_f32 v104, v104 clamp
    v_cvt_pk_bf16_f32 v251, v102, v103
    v_exp_f32 v105, v105 clamp
    s_nop 0
    v_mfma_f32_32x32x16_bf16 a[108:123], a[200:203], v[248:251], a[108:123]
    ds_read_b128 a[200:203], v56 offset:12800
    v_cvt_pk_bf16_f32 v252, v104, v105
    v_exp_f32 v106, v106 clamp
    v_exp_f32 v107, v107 clamp
    v_exp_f32 v108, v108 clamp
    v_cvt_pk_bf16_f32 v253, v106, v107
    v_exp_f32 v109, v109 clamp
    v_exp_f32 v110, v110 clamp
    v_cvt_pk_bf16_f32 v254, v108, v109
    v_exp_f32 v111, v111 clamp
    v_exp_f32 v112, v112 clamp
    v_cvt_pk_bf16_f32 v255, v110, v111
    v_mfma_f32_32x32x16_bf16 v[96:111], a[48:51], a[176:179], v[64:79]
    v_exp_f32 v113, v113 clamp
    v_exp_f32 v114, v114 clamp
    v_cvt_pk_bf16_f32 v240, v112, v113
    v_mov_b32 v5, 0x3f800000
    v_mfma_f32_32x32x16_bf16 a[108:123], a[204:207], v[252:255], a[108:123]
    ds_read_b128 a[204:207], v56 offset:14080
    v_exp_f32 v115, v115 clamp
    v_exp_f32 v116, v116 clamp
    v_cvt_pk_bf16_f32 v241, v114, v115
    v_mfma_f32_32x32x16_bf16 v[96:111], a[52:55], a[180:183], v[96:111]
    v_exp_f32 v117, v117 clamp
    v_exp_f32 v118, v118 clamp
    v_cvt_pk_bf16_f32 v242, v116, v117
    v_exp_f32 v119, v119 clamp
    v_exp_f32 v120, v120 clamp
    v_cvt_pk_bf16_f32 v243, v118, v119
    v_exp_f32 v121, v121 clamp
    s_nop 0
    v_mfma_f32_32x32x16_bf16 a[108:123], a[208:211], v[240:243], a[108:123]
    ds_read_b128 a[208:211], v56 offset:17920
    v_cvt_pk_bf16_f32 v244, v120, v121
    v_exp_f32 v122, v122 clamp
    v_exp_f32 v123, v123 clamp
    v_exp_f32 v124, v124 clamp
    s_nop 0
L_pad82:
    s_cbranch_execz L_wret
    v_cvt_pk_bf16_f32 v245, v122, v123
    v_exp_f32 v125, v125 clamp
    v_exp_f32 v126, v126 clamp
    v_cvt_pk_bf16_f32 v246, v124, v125
    v_exp_f32 v127, v127 clamp
    v_exp_f32 v80, v80 clamp
    v_cvt_pk_bf16_f32 v247, v126, v127
    v_mfma_f32_32x32x16_bf16 v[112:127], a[60:63], a[176:179], v[64:79]
    v_exp_f32 v81, v81 clamp
    v_exp_f32 v82, v82 clamp
    v_cvt_pk_bf16_f32 v248, v80, v81
    v_cmp_eq_u32 vcc, 3, v3
    v_mfma_f32_32x32x16_bf16 a[108:123], a[212:215], v[244:247], a[108:123]
    ds_read_b128 a[212:215], v56 offset:19200
    v_exp_f32 v83, v83 clamp
    v_exp_f32 v84, v84 clamp
    v_cvt_pk_bf16_f32 v249, v82, v83
    v_mfma_f32_32x32x16_bf16 v[112:127], a[64:67], a[180:183], v[112:127]
    v_exp_f32 v85, v85 clamp
    v_exp_f32 v86, v86 clamp
    v_cvt_pk_bf16_f32 v250, v84, v85
    v_exp_f32 v87, v87 clamp
    v_exp_f32 v88, v88 clamp
    v_cvt_pk_bf16_f32 v251, v86, v87
    v_exp_f32 v89, v89 clamp
    s_nop 0
    v_mfma_f32_32x32x16_bf16 a[108:123], a[216:219], v[248:251], a[108:123]
    ds_read_b128 a[216:219], v56 offset:23040
    v_cvt_pk_bf16_f32 v252, v88, v89
    v_exp_f32 v90, v90 clamp
    v_exp_f32 v91, v91 clamp
    v_exp_f32 v92, v92 clamp
    v_cvt_pk_bf16_f32 v253, v90, v91
    v_exp_f32 v93, v93 clamp
    v_exp_f32 v94, v94 clamp
    v_cvt_pk_bf16_f32 v254, v92, v93
    v_exp_f32 v95, v95 clamp
    v_exp_f32 v96, v96 clamp
    v_cvt_pk_bf16_f32 v255, v94, v95
    v_mfma_f32_32x32x16_bf16 v[80:95], a[72:75], a[176:179], v[64:79]
    v_exp_f32 v97, v97 clamp
    v_exp_f32 v98, v98 clamp
    v_cvt_pk_bf16_f32 v240, v96, v97
    v_cndmask_b32 v6, v6, v5, vcc
    v_mfma_f32_32x32x16_bf16 a[108:123], a[220:223], v[252:255], a[108:123]
    v_mov_b32 v16, 2
    s_waitcnt vmcnt(10)
    buffer_store_dword v16, v29, s[28:31], 0 offen sc1
    ds_read_b128 a[220:223], v56 offset:24320
    v_mfma_f32_32x32x16_bf16 v[80:95], a[76:79], a[180:183], v[80:95]
    v_exp_f32 v99, v99 clamp
    v_exp_f32 v100, v100 clamp
    v_cvt_pk_bf16_f32 v241, v98, v99
    v_exp_f32 v101, v101 clamp
    v_exp_f32 v102, v102 clamp
    v_cvt_pk_bf16_f32 v242, v100, v101
    v_exp_f32 v103, v103 clamp
    v_exp_f32 v104, v104 clamp
    v_cvt_pk_bf16_f32 v243, v102, v103
    v_exp_f32 v105, v105 clamp
    s_nop 0
    v_mfma_f32_32x32x16_bf16 a[108:123], a[224:227], v[240:243], a[108:123]
    ds_read_b128 a[224:227], v56 offset:28160
    v_cvt_pk_bf16_f32 v244, v104, v105
    v_exp_f32 v106, v106 clamp
    v_exp_f32 v107, v107 clamp
    s_nop 0
L_pad83:
    s_cbranch_execz L_wret
    v_exp_f32 v108, v108 clamp
    v_cvt_pk_bf16_f32 v245, v106, v107
    v_exp_f32 v109, v109 clamp
    v_exp_f32 v110, v110 clamp
    v_cvt_pk_bf16_f32 v246, v108, v109
    v_exp_f32 v111, v111 clamp
    v_exp_f32 v112, v112 clamp
    v_cvt_pk_bf16_f32 v247, v110, v111
    v_mfma_f32_32x32x16_bf16 v[96:111], a[84:87], a[176:179], v[64:79]
    v_exp_f32 v113, v113 clamp
    v_exp_f32 v114, v114 clamp
    v_cvt_pk_bf16_f32 v248, v112, v113
    v_accvgpr_write_b32 a253, v6
    v_mfma_f32_32x32x16_bf16 a[108:123], a[228:231], v[244:247], a[108:123]
    ds_read_b128 a[228:231], v56 offset:29440
    v_exp_f32 v115, v115 clamp
    v_exp_f32 v116, v116 clamp
    v_cvt_pk_bf16_f32 v249, v114, v115
    v_mfma_f32_32x32x16_bf16 v[96:111], a[88:91], a[180:183], v[96:111]
    v_exp_f32 v117, v117 clamp
    v_exp_f32 v118, v118 clamp
    v_cvt_pk_bf16_f32 v250, v116, v117
    v_exp_f32 v119, v119 clamp
    v_exp_f32 v120, v120 clamp
    v_cvt_pk_bf16_f32 v251, v118, v119
    v_exp_f32 v121, v121 clamp
    s_nop 0
    v_mfma_f32_32x32x16_bf16 a[108:123], a[232:235], v[248:251], a[108:123]
    ds_read_b128 a[232:235], v56 offset:33280
    v_cvt_pk_bf16_f32 v252, v120, v121
    v_exp_f32 v122, v122 clamp
    v_exp_f32 v123, v123 clamp
    v_exp_f32 v124, v124 clamp
    v_cvt_pk_bf16_f32 v253, v122, v123
    v_exp_f32 v125, v125 clamp
    v_exp_f32 v126, v126 clamp
    v_cvt_pk_bf16_f32 v254, v124, v125
    v_exp_f32 v127, v127 clamp
    v_exp_f32 v80, v80 clamp
    v_cvt_pk_bf16_f32 v255, v126, v127
    v_mfma_f32_32x32x16_bf16 v[112:127], a[96:99], a[176:179], v[64:79]
    v_exp_f32 v81, v81 clamp
    v_exp_f32 v82, v82 clamp
    v_cvt_pk_bf16_f32 v240, v80, v81
    v_mov_b32 v5, 0x3f80
    v_mfma_f32_32x32x16_bf16 a[108:123], a[236:239], v[252:255], a[108:123]
    ds_read_b128 a[236:239], v56 offset:34560
    v_exp_f32 v83, v83 clamp
    v_exp_f32 v84, v84 clamp
    v_cvt_pk_bf16_f32 v241, v82, v83
    v_mfma_f32_32x32x16_bf16 v[112:127], a[100:103], a[180:183], v[112:127]
    v_exp_f32 v85, v85 clamp
    v_exp_f32 v86, v86 clamp
    v_cvt_pk_bf16_f32 v242, v84, v85
    v_exp_f32 v87, v87 clamp
    v_exp_f32 v88, v88 clamp
    v_cvt_pk_bf16_f32 v243, v86, v87
    v_exp_f32 v89, v89 clamp
    s_nop 0
    v_mfma_f32_32x32x16_bf16 a[108:123], a[240:243], v[240:243], a[108:123]
    ds_read_b128 a[240:243], v56 offset:38400
    v_cvt_pk_bf16_f32 v244, v88, v89
    v_exp_f32 v90, v90 clamp
    v_exp_f32 v91, v91 clamp
    s_nop 0
L_pad84:
    s_cbranch_execz L_wret
    v_exp_f32 v92, v92 clamp
    v_cvt_pk_bf16_f32 v245, v90, v91
    v_exp_f32 v93, v93 clamp
    v_exp_f32 v94, v94 clamp
    v_cvt_pk_bf16_f32 v246, v92, v93
    v_exp_f32 v95, v95 clamp
    v_bfi_b32 v112, v224, v112, v96
    v_cvt_pk_bf16_f32 v247, v94, v95
    v_exp_f32 v112, v112 clamp
    s_nop 0
    v_mfma_f32_32x32x16_bf16 a[108:123], a[124:127], v[244:247], a[108:123]
    ds_read_b128 a[124:127], v56 offset:39680
    v_bfi_b32 v113, v225, v113, v97
    v_exp_f32 v113, v113 clamp
    v_bfi_b32 v114, v226, v114, v98
    v_cvt_pk_bf16_f32 v240, v112, v113
    v_bfi_b32 v248, v8, 0, v240
    v_and_b32 v240, v8, v240
    v_exp_f32 v114, v114 clamp
    v_bfi_b32 v115, v227, v115, v99
    v_exp_f32 v115, v115 clamp
    v_bfi_b32 v116, v228, v116, v100
    v_cvt_pk_bf16_f32 v241, v114, v115
    v_bfi_b32 v249, v9, 0, v241
    v_and_b32 v241, v9, v241
    v_exp_f32 v116, v116 clamp
    v_bfi_b32 v117, v229, v117, v101
    v_exp_f32 v117, v117 clamp
    v_bfi_b32 v118, v230, v118, v102
    v_cvt_pk_bf16_f32 v242, v116, v117
    v_bfi_b32 v250, v10, 0, v242
    v_and_b32 v242, v10, v242
    v_exp_f32 v118, v118 clamp
    v_bfi_b32 v119, v231, v119, v103
    v_exp_f32 v119, v119 clamp
    v_bfi_b32 v120, v232, v120, v104
    v_cvt_pk_bf16_f32 v243, v118, v119
    v_bfi_b32 v251, v11, 0, v243
    v_and_b32 v243, v11, v243
    v_exp_f32 v120, v120 clamp
    v_mfma_f32_32x32x16_bf16 a[108:123], a[128:131], v[248:251], a[108:123]
    ds_read_b128 a[128:131], v56 offset:2560
    v_bfi_b32 v121, v233, v121, v105
    v_exp_f32 v121, v121 clamp
    v_bfi_b32 v122, v234, v122, v106
    v_cvt_pk_bf16_f32 v244, v120, v121
    v_mfma_f32_32x32x16_bf16 a[108:123], a[136:139], v[240:243], a[108:123]
    ds_read_b128 a[136:139], v56 offset:43520
    v_bfi_b32 v252, v12, 0, v244
    v_and_b32 v244, v12, v244
    v_exp_f32 v122, v122 clamp
    v_bfi_b32 v123, v235, v123, v107
    v_exp_f32 v123, v123 clamp
    v_bfi_b32 v124, v236, v124, v108
    v_cvt_pk_bf16_f32 v245, v122, v123
    v_bfi_b32 v253, v13, 0, v245
    v_and_b32 v245, v13, v245
    v_exp_f32 v124, v124 clamp
    v_bfi_b32 v125, v237, v125, v109
    v_exp_f32 v125, v125 clamp
    v_bfi_b32 v126, v238, v126, v110
    v_cvt_pk_bf16_f32 v246, v124, v125
    v_bfi_b32 v254, v14, 0, v246
    v_and_b32 v246, v14, v246
    v_exp_f32 v126, v126 clamp
    v_bfi_b32 v127, v239, v127, v111
    v_exp_f32 v127, v127 clamp
    v_mov_b32 v64, v45
L_pad85:
    s_cbranch_execz L_wret
    v_cvt_pk_bf16_f32 v247, v126, v127
    v_bfi_b32 v255, v15, 0, v247
    v_and_b32 v247, v15, v247
    v_mov_b32 v65, v45
    v_mfma_f32_32x32x16_bf16 a[108:123], a[132:135], v[252:255], a[108:123]
    ds_read_b128 a[132:135], v56 offset:3840
    v_mov_b32 v66, v45
    v_mov_b32 v67, v45
    v_mov_b32 v68, v45
    v_mov_b32 v69, v45
    v_mov_b32 v70, v45
    v_mfma_f32_32x32x16_bf16 a[108:123], a[140:143], v[244:247], a[108:123]
    ds_read_b128 a[140:143], v56 offset:44800
    v_mov_b32 v71, v45
    v_mov_b32 v72, v45
    v_mov_b32 v73, v45
    v_mov_b32 v74, v45
    v_mov_b32 v75, v45
    v_mov_b32 v76, v45
    v_mov_b32 v77, v45
    v_mov_b32 v78, v45
    v_mov_b32 v79, v45
    v_cmp_eq_u32 vcc, 4, v3
    s_nop 0
    v_mfma_f32_32x32x16_bf16 v[80:95], a[8:11], a[184:187], v[64:79]
    v_cndmask_b32 v6, 0, v5, vcc
    v_mov_b32 v5, 0x3f800000
    v_cmp_eq_u32 vcc, 5, v3
    v_accvgpr_read_b32 v212, a108
    v_accvgpr_read_b32 v213, a109
    v_mfma_f32_32x32x16_bf16 v[80:95], a[4:7], a[188:191], v[80:95]
    v_accvgpr_read_b32 v214, a110
    v_accvgpr_read_b32 v215, a111
    v_accvgpr_read_b32 v216, a112
    v_accvgpr_read_b32 v217, a113
    v_accvgpr_read_b32 v218, a114
    v_accvgpr_read_b32 v219, a115
    v_mfma_f32_32x32x16_bf16 v[96:111], a[20:23], a[184:187], v[64:79]
    v_accvgpr_read_b32 v220, a116
    v_accvgpr_read_b32 v221, a117
    v_accvgpr_read_b32 v222, a118
    v_rcp_f32 v222, v222
    s_waitcnt lgkmcnt(0)
    s_barrier
    v_mfma_f32_32x32x16_bf16 v[96:111], a[16:19], a[188:191], v[96:111]
    s_add_u32 m0, s52, 0xc000
    s_add_u32 s83, s4, s88
    buffer_load_dwordx4 v21, s[20:23], s83 offen lds
    v_mul_f32 v222, v222, v47
    v_mfma_f32_32x32x16_bf16 v[112:127], a[32:35], a[184:187], v[64:79]
    v_mul_f32 v212, v212, v222
    v_mul_f32 v213, v213, v222
    v_mul_f32 v214, v214, v222
    v_mul_f32 v215, v215, v222
    v_mul_f32 v216, v216, v222
    v_mul_f32 v217, v217, v222
    v_mfma_f32_32x32x16_bf16 v[112:127], a[28:31], a[188:191], v[112:127]
    v_mul_f32 v218, v218, v222
    v_mul_f32 v219, v219, v222
    v_mul_f32 v220, v220, v222
    v_mul_f32 v221, v221, v222
    v_cvt_pk_bf16_f32 v200, v212, v213
    buffer_load_dwordx4 v22, s[20:23], s83 offen offset:1024 lds
    v_cvt_pk_bf16_f32 v201, v214, v215
    v_cvt_pk_bf16_f32 v202, v216, v217
    v_cvt_pk_bf16_f32 v203, v218, v219
    v_cvt_pk_bf16_f32 v220, v220, v221
    v_cndmask_b32 v208, 0, v220, s[92:93]
    v_exp_f32 v80, v80 clamp
    v_exp_f32 v81, v81 clamp
    v_exp_f32 v82, v82 clamp
    v_cvt_pk_bf16_f32 v248, v80, v81
    v_exp_f32 v83, v83 clamp
    v_exp_f32 v84, v84 clamp
    buffer_load_dwordx4 v23, s[20:23], s83 offen offset:2048 lds
    v_cvt_pk_bf16_f32 v249, v82, v83
    v_exp_f32 v85, v85 clamp
    v_exp_f32 v86, v86 clamp
    v_cvt_pk_bf16_f32 v250, v84, v85
    v_exp_f32 v87, v87 clamp
    v_exp_f32 v88, v88 clamp
    s_nop 0
L_pad86:
    s_cbranch_execz L_wret
    v_cvt_pk_bf16_f32 v251, v86, v87
    v_exp_f32 v89, v89 clamp
    s_nop 0
    v_mfma_f32_32x32x16_bf16 a[108:123], a[192:195], v[248:251], 0
    s_add_u32 m0, s52, 0xcc00
    s_add_u32 s84, s83, 0x4800
    buffer_load_dwordx4 v21, s[20:23], s84 offen lds
    ds_read_b64_tr_b16 a[192:193], v32 offset:27712
    ds_read_b64_tr_b16 a[194:195], v32 offset:29248
    v_cvt_pk_bf16_f32 v252, v88, v89
    v_exp_f32 v90, v90 clamp
    v_exp_f32 v91, v91 clamp
    v_exp_f32 v92, v92 clamp
    v_cvt_pk_bf16_f32 v253, v90, v91
    v_exp_f32 v93, v93 clamp
    v_exp_f32 v94, v94 clamp
    v_cvt_pk_bf16_f32 v254, v92, v93
    v_exp_f32 v95, v95 clamp
    buffer_load_dwordx4 v22, s[20:23], s84 offen offset:1024 lds
    v_cvt_pk_bf16_f32 v255, v94, v95
    v_mfma_f32_32x32x16_bf16 v[80:95], a[44:47], a[184:187], v[64:79]
    v_exp_f32 v96, v96 clamp
    v_exp_f32 v97, v97 clamp
    v_exp_f32 v98, v98 clamp
    v_mfma_f32_32x32x16_bf16 a[108:123], a[196:199], v[252:255], a[108:123]
    ds_read_b64_tr_b16 a[196:197], v32 offset:27776
    ds_read_b64_tr_b16 a[198:199], v32 offset:29312
    v_cvt_pk_bf16_f32 v240, v96, v97
    v_exp_f32 v99, v99 clamp
    v_cndmask_b32 v6, v6, v5, vcc
    v_mfma_f32_32x32x16_bf16 v[80:95], a[40:43], a[188:191], v[80:95]
    buffer_load_dwordx4 v23, s[20:23], s84 offen offset:2048 lds
    v_cvt_pk_bf16_f32 v241, v98, v99
    v_exp_f32 v100, v100 clamp
    v_exp_f32 v101, v101 clamp
    v_exp_f32 v102, v102 clamp
    v_cvt_pk_bf16_f32 v242, v100, v101
    v_exp_f32 v103, v103 clamp
    v_exp_f32 v104, v104 clamp
    v_cvt_pk_bf16_f32 v243, v102, v103
    v_exp_f32 v105, v105 clamp
    s_nop 0
    v_mfma_f32_32x32x16_bf16 a[108:123], a[200:203], v[240:243], a[108:123]
    s_mov_b32 s85, 0x4000
    buffer_store_dwordx4 v[200:203], v24, s[32:35], s85 offen offset:2048 sc1
    ds_read_b64_tr_b16 a[200:201], v32 offset:30720
    ds_read_b64_tr_b16 a[202:203], v32 offset:32256
    v_cvt_pk_bf16_f32 v244, v104, v105
    v_exp_f32 v106, v106 clamp
    v_exp_f32 v107, v107 clamp
    v_exp_f32 v108, v108 clamp
    v_cvt_pk_bf16_f32 v245, v106, v107
    v_exp_f32 v109, v109 clamp
    v_exp_f32 v110, v110 clamp
    v_cvt_pk_bf16_f32 v246, v108, v109
    v_exp_f32 v111, v111 clamp
    v_exp_f32 v112, v112 clamp
    v_cvt_pk_bf16_f32 v247, v110, v111
    v_mfma_f32_32x32x16_bf16 v[96:111], a[56:59], a[184:187], v[64:79]
    v_exp_f32 v113, v113 clamp
    v_exp_f32 v114, v114 clamp
    v_cvt_pk_bf16_f32 v248, v112, v113
    v_accvgpr_write_b32 a254, v6
    v_mfma_f32_32x32x16_bf16 a[108:123], a[204:207], v[244:247], a[108:123]
    ds_read_b64_tr_b16 a[204:205], v32 offset:30784
L_pad87:
    s_cbranch_execz L_wret
    ds_read_b64_tr_b16 a[206:207], v32 offset:32320
    v_exp_f32 v115, v115 clamp
    v_exp_f32 v116, v116 clamp
    v_mfma_f32_32x32x16_bf16 v[96:111], a[52:55], a[188:191], v[96:111]
    v_cvt_pk_bf16_f32 v249, v114, v115
    v_exp_f32 v117, v117 clamp
    v_exp_f32 v118, v118 clamp
    v_cvt_pk_bf16_f32 v250, v116, v117
    v_exp_f32 v119, v119 clamp
    v_exp_f32 v120, v120 clamp
    v_cvt_pk_bf16_f32 v251, v118, v119
    v_exp_f32 v121, v121 clamp
    s_nop 0
    v_mfma_f32_32x32x16_bf16 a[108:123], a[208:211], v[248:251], a[108:123]
    ds_read_b64_tr_b16 a[208:209], v32 offset:24576
    ds_read_b64_tr_b16 a[210:211], v32 offset:26112
    v_cvt_pk_bf16_f32 v252, v120, v121
    v_exp_f32 v122, v122 clamp
    v_exp_f32 v123, v123 clamp
    v_exp_f32 v124, v124 clamp
    v_cvt_pk_bf16_f32 v253, v122, v123
    v_exp_f32 v125, v125 clamp
    v_exp_f32 v126, v126 clamp
    v_cvt_pk_bf16_f32 v254, v124, v125
    v_exp_f32 v127, v127 clamp
    v_exp_f32 v80, v80 clamp
    v_cvt_pk_bf16_f32 v255, v126, v127
    v_mfma_f32_32x32x16_bf16 v[112:127], a[68:71], a[184:187], v[64:79]
    v_exp_f32 v81, v81 clamp
    v_exp_f32 v82, v82 clamp
    v_cvt_pk_bf16_f32 v240, v80, v81
    v_mov_b32 v5, 0x3f80
    v_mfma_f32_32x32x16_bf16 a[108:123], a[212:215], v[252:255], a[108:123]
    s_add_u32 m0, s52, 0x12000
    s_add_u32 s83, s5, s87
    buffer_load_dwordx4 v21, s[8:11], s83 offen lds
    ds_read_b64_tr_b16 a[212:213], v32 offset:24640
    v_mfma_f32_32x32x16_bf16 v[112:127], a[64:67], a[188:191], v[112:127]
    ds_read_b64_tr_b16 a[214:215], v32 offset:26176
    v_exp_f32 v83, v83 clamp
    v_exp_f32 v84, v84 clamp
    v_cvt_pk_bf16_f32 v241, v82, v83
    s_waitcnt lgkmcnt(2)
    v_mfma_f32_32x32x16_bf16 a[32:47], a[208:211], v[136:139], 0
    ds_read_b64_tr_b16 a[208:209], v32 offset:30848
    ds_read_b64_tr_b16 a[210:211], v32 offset:32384
    v_exp_f32 v85, v85 clamp
    buffer_load_dwordx4 v22, s[8:11], s83 offen offset:1024 lds
    v_cvt_pk_bf16_f32 v242, v84, v85
    v_exp_f32 v86, v86 clamp
    v_exp_f32 v87, v87 clamp
    v_exp_f32 v88, v88 clamp
    v_cvt_pk_bf16_f32 v243, v86, v87
    v_exp_f32 v89, v89 clamp
    s_nop 0
    v_mfma_f32_32x32x16_bf16 a[108:123], a[216:219], v[240:243], a[108:123]
    ds_read_b64_tr_b16 a[216:217], v32 offset:24704
    ds_read_b64_tr_b16 a[218:219], v32 offset:26240
    v_cvt_pk_bf16_f32 v244, v88, v89
    buffer_load_dwordx4 v23, s[8:11], s83 offen offset:2048 lds
    s_waitcnt lgkmcnt(4)
    v_mfma_f32_32x32x16_bf16 a[48:63], a[212:215], v[136:139], 0
    ds_read_b64_tr_b16 a[212:213], v32 offset:33792
    ds_read_b64_tr_b16 a[214:215], v32 offset:35328
    v_exp_f32 v90, v90 clamp
    v_exp_f32 v91, v91 clamp
L_pad88:
    s_cbranch_execz L_wret
    v_exp_f32 v92, v92 clamp
    v_cvt_pk_bf16_f32 v245, v90, v91
    v_exp_f32 v93, v93 clamp
    v_exp_f32 v94, v94 clamp
    s_add_u32 m0, s52, 0x12c00
    s_add_u32 s84, s70, s87
    buffer_load_dwordx4 v21, s[8:11], s84 offen lds
    v_cvt_pk_bf16_f32 v246, v92, v93
    v_exp_f32 v95, v95 clamp
    v_exp_f32 v96, v96 clamp
    v_cvt_pk_bf16_f32 v247, v94, v95
    v_mfma_f32_32x32x16_bf16 v[80:95], a[80:83], a[184:187], v[64:79]
    v_exp_f32 v97, v97 clamp
    v_exp_f32 v98, v98 clamp
    v_cvt_pk_bf16_f32 v248, v96, v97
    v_cmp_eq_u32 vcc, 6, v3
    v_mfma_f32_32x32x16_bf16 a[108:123], a[220:223], v[244:247], a[108:123]
    buffer_load_dwordx4 v22, s[8:11], s84 offen offset:1024 lds
    ds_read_b64_tr_b16 a[220:221], v32 offset:27648
    ds_read_b64_tr_b16 a[222:223], v32 offset:29184
    v_cndmask_b32 v6, 0, v5, vcc
    v_mfma_f32_32x32x16_bf16 v[80:95], a[76:79], a[188:191], v[80:95]
    v_exp_f32 v99, v99 clamp
    v_exp_f32 v100, v100 clamp
    v_cvt_pk_bf16_f32 v249, v98, v99
    v_mov_b32 v5, 0x3f800000
    s_waitcnt lgkmcnt(2)
    v_mfma_f32_32x32x16_bf16 a[64:79], a[216:219], v[136:139], 0
    ds_read_b64_tr_b16 a[216:217], v32 offset:33856
    ds_read_b64_tr_b16 a[218:219], v32 offset:35392
    buffer_load_dwordx4 v23, s[8:11], s84 offen offset:2048 lds
    v_exp_f32 v101, v101 clamp
    v_exp_f32 v102, v102 clamp
    v_cvt_pk_bf16_f32 v250, v100, v101
    v_exp_f32 v103, v103 clamp
    v_exp_f32 v104, v104 clamp
    v_cvt_pk_bf16_f32 v251, v102, v103
    v_exp_f32 v105, v105 clamp
    s_nop 0
    v_mfma_f32_32x32x16_bf16 a[108:123], a[224:227], v[248:251], a[108:123]
    v_cvt_pk_bf16_f32 v252, v104, v105
    buffer_load_dword v27, v26, s[28:31], 0 offen sc1
    v_exp_f32 v106, v106 clamp
    v_cmp_eq_u32 vcc, 7, v3
    s_waitcnt lgkmcnt(2)
    v_mfma_f32_32x32x16_bf16 a[32:47], a[220:223], v[140:143], a[32:47]
    ds_read_b64_tr_b16 a[220:221], v32 offset:33920
    ds_read_b64_tr_b16 a[222:223], v32 offset:35456
    v_exp_f32 v107, v107 clamp
    v_exp_f32 v108, v108 clamp
    v_mfma_f32_32x32x16_bf16 a[48:63], a[192:195], v[140:143], a[48:63]
    ds_read_b64_tr_b16 a[192:193], v32 offset:36864
    ds_read_b64_tr_b16 a[194:195], v32 offset:38400
    v_cvt_pk_bf16_f32 v253, v106, v107
    v_exp_f32 v109, v109 clamp
    v_cndmask_b32 v6, v6, v5, vcc
    v_mfma_f32_32x32x16_bf16 a[64:79], a[196:199], v[140:143], a[64:79]
    ds_read_b64_tr_b16 a[196:197], v32 offset:36928
    ds_read_b64_tr_b16 a[198:199], v32 offset:38464
    v_cvt_pk_bf16_f32 v254, v108, v109
    v_exp_f32 v110, v110 clamp
    v_accvgpr_write_b32 a255, v6
    v_mfma_f32_32x32x16_bf16 a[32:47], a[200:203], v[144:147], a[32:47]
    ds_read_b64_tr_b16 a[200:201], v32 offset:36992
    ds_read_b64_tr_b16 a[202:203], v32 offset:38528
    v_exp_f32 v111, v111 clamp
    v_exp_f32 v112, v112 clamp
    v_mfma_f32_32x32x16_bf16 a[48:63], a[204:207], v[144:147], a[48:63]
L_pad89:
    s_cbranch_execz L_wret
    ds_read_b64_tr_b16 a[204:205], v32 offset:39936
    ds_read_b64_tr_b16 a[206:207], v32 offset:41472
    v_cvt_pk_bf16_f32 v255, v110, v111
    v_exp_f32 v113, v113 clamp
    s_nop 0
    v_mfma_f32_32x32x16_bf16 a[108:123], a[228:231], v[252:255], a[108:123]
    v_cvt_pk_bf16_f32 v240, v112, v113
    v_exp_f32 v114, v114 clamp
    v_exp_f32 v115, v115 clamp
    v_mfma_f32_32x32x16_bf16 v[96:111], a[92:95], a[184:187], v[64:79]
    v_cvt_pk_bf16_f32 v241, v114, v115
    v_exp_f32 v116, v116 clamp
    v_exp_f32 v117, v117 clamp
    v_mfma_f32_32x32x16_bf16 v[96:111], a[88:91], a[188:191], v[96:111]
    v_cvt_pk_bf16_f32 v242, v116, v117
    v_exp_f32 v118, v118 clamp
    v_exp_f32 v119, v119 clamp
    v_mfma_f32_32x32x16_bf16 a[64:79], a[208:211], v[144:147], a[64:79]
    ds_read_b64_tr_b16 a[208:209], v32 offset:40000
    ds_read_b64_tr_b16 a[210:211], v32 offset:41536
    v_cvt_pk_bf16_f32 v243, v118, v119
    v_exp_f32 v120, v120 clamp
    s_nop 0
    v_mfma_f32_32x32x16_bf16 a[108:123], a[232:235], v[240:243], a[108:123]
    v_exp_f32 v121, v121 clamp
    v_exp_f32 v122, v122 clamp
    v_cvt_pk_bf16_f32 v244, v120, v121
    v_mfma_f32_32x32x16_bf16 a[32:47], a[212:215], v[148:151], a[32:47]
    ds_read_b64_tr_b16 a[212:213], v32 offset:40064
    ds_read_b64_tr_b16 a[214:215], v32 offset:41600
    v_exp_f32 v123, v123 clamp
    v_exp_f32 v124, v124 clamp
    s_waitcnt lgkmcnt(4)
    v_mfma_f32_32x32x16_bf16 a[48:63], a[216:219], v[148:151], a[48:63]
    ds_read_b64_tr_b16 a[216:217], v32 offset:43008
    ds_read_b64_tr_b16 a[218:219], v32 offset:44544
    v_cvt_pk_bf16_f32 v245, v122, v123
    v_exp_f32 v125, v125 clamp
    v_mfma_f32_32x32x16_bf16 a[64:79], a[220:223], v[148:151], a[64:79]
    ds_read_b64_tr_b16 a[220:221], v32 offset:43072
    ds_read_b64_tr_b16 a[222:223], v32 offset:44608
    v_cvt_pk_bf16_f32 v246, v124, v125
    v_exp_f32 v126, v126 clamp
    v_mfma_f32_32x32x16_bf16 a[32:47], a[192:195], v[152:155], a[32:47]
    ds_read_b64_tr_b16 a[192:193], v32 offset:43136
    ds_read_b64_tr_b16 a[194:195], v32 offset:44672
    v_exp_f32 v127, v127 clamp
    v_exp_f32 v80, v80 clamp
    v_mfma_f32_32x32x16_bf16 a[48:63], a[196:199], v[152:155], a[48:63]
    ds_read_b64_tr_b16 a[196:197], v32 offset:46080
    ds_read_b64_tr_b16 a[198:199], v32 offset:47616
    v_cvt_pk_bf16_f32 v247, v126, v127
    v_exp_f32 v81, v81 clamp
    s_nop 0
    v_mfma_f32_32x32x16_bf16 a[108:123], a[236:239], v[244:247], a[108:123]
    v_cvt_pk_bf16_f32 v248, v80, v81
    v_exp_f32 v82, v82 clamp
    v_exp_f32 v83, v83 clamp
    v_mfma_f32_32x32x16_bf16 v[112:127], a[104:107], a[184:187], v[64:79]
    v_cvt_pk_bf16_f32 v249, v82, v83
    v_exp_f32 v84, v84 clamp
    v_exp_f32 v85, v85 clamp
    v_mfma_f32_32x32x16_bf16 v[112:127], a[100:103], a[188:191], v[112:127]
    v_cvt_pk_bf16_f32 v250, v84, v85
    v_exp_f32 v86, v86 clamp
    s_nop 0
L_pad90:
    s_cbranch_execz L_wret
    v_exp_f32 v87, v87 clamp
    v_mfma_f32_32x32x16_bf16 a[64:79], a[200:203], v[152:155], a[64:79]
    ds_read_b64_tr_b16 a[200:201], v32 offset:46144
    ds_read_b64_tr_b16 a[202:203], v32 offset:47680
    v_cvt_pk_bf16_f32 v251, v86, v87
    v_exp_f32 v88, v88 clamp
    s_nop 0
    v_mfma_f32_32x32x16_bf16 a[108:123], a[240:243], v[248:251], a[108:123]
    v_exp_f32 v89, v89 clamp
    v_exp_f32 v90, v90 clamp
    v_cvt_pk_bf16_f32 v252, v88, v89
    v_bfi_b32 v112, v224, v112, v96
    v_mfma_f32_32x32x16_bf16 a[32:47], a[204:207], v[156:159], a[32:47]
    ds_read_b64_tr_b16 a[204:205], v32 offset:46208
    ds_read_b64_tr_b16 a[206:207], v32 offset:47744
    v_exp_f32 v91, v91 clamp
    v_exp_f32 v92, v92 clamp
    s_waitcnt lgkmcnt(4)
    v_mfma_f32_32x32x16_bf16 a[48:63], a[208:211], v[156:159], a[48:63]
    v_cvt_pk_bf16_f32 v253, v90, v91
    v_exp_f32 v93, v93 clamp
    v_exp_f32 v94, v94 clamp
    v_cvt_pk_bf16_f32 v254, v92, v93
    v_mfma_f32_32x32x16_bf16 a[64:79], a[212:215], v[156:159], a[64:79]
    v_exp_f32 v95, v95 clamp
    v_exp_f32 v112, v112 clamp
    v_cvt_pk_bf16_f32 v255, v94, v95
    v_bfi_b32 v113, v225, v113, v97
    v_mfma_f32_32x32x16_bf16 a[32:47], a[216:219], v[160:163], a[32:47]
    s_barrier
    s_add_u32 m0, s52, 0x18000
    s_add_u32 s83, s6, s87
    buffer_load_dwordx4 v21, s[20:23], s83 offen lds
    v_mfma_f32_32x32x16_bf16 a[108:123], a[124:127], v[252:255], a[108:123]
    ds_read_b64_tr_b16 a[208:209], v30 offset:0
    ds_read_b64_tr_b16 a[210:211], v30 offset:1536
    ds_read_b64_tr_b16 a[212:213], v30 offset:64
    ds_read_b64_tr_b16 a[214:215], v30 offset:1600
    ds_read_b64_tr_b16 a[216:217], v30 offset:128
    ds_read_b64_tr_b16 a[218:219], v30 offset:1664
    v_mfma_f32_32x32x16_bf16 a[48:63], a[220:223], v[160:163], a[48:63]
    ds_read_b64_tr_b16 a[220:221], v30 offset:3072
    ds_read_b64_tr_b16 a[222:223], v30 offset:4608
    v_exp_f32 v113, v113 clamp
    v_bfi_b32 v114, v226, v114, v98
    v_cvt_pk_bf16_f32 v248, v112, v113
    v_mfma_f32_32x32x16_bf16 a[64:79], a[192:195], v[160:163], a[64:79]
    buffer_load_dwordx4 v22, s[20:23], s83 offen offset:1024 lds
    ds_read_b64_tr_b16 a[192:193], v30 offset:3136
    ds_read_b64_tr_b16 a[194:195], v30 offset:4672
    v_bfi_b32 v240, v8, 0, v248
    v_mfma_f32_32x32x16_bf16 a[32:47], a[196:199], v[164:167], a[32:47]
    ds_read_b64_tr_b16 a[196:197], v30 offset:3200
    ds_read_b64_tr_b16 a[198:199], v30 offset:4736
    v_and_b32 v248, v8, v248
    v_exp_f32 v114, v114 clamp
    v_bfi_b32 v115, v227, v115, v99
    s_waitcnt lgkmcnt(12)
    v_mfma_f32_32x32x16_bf16 a[48:63], a[200:203], v[164:167], a[48:63]
    ds_read_b64_tr_b16 a[200:201], v30 offset:6144
    ds_read_b64_tr_b16 a[202:203], v30 offset:7680
    buffer_load_dwordx4 v23, s[20:23], s83 offen offset:2048 lds
    v_bfi_b32 v116, v228, v116, v100
    v_mfma_f32_32x32x16_bf16 a[64:79], a[204:207], v[164:167], a[64:79]
    ds_read_b64_tr_b16 a[204:205], v30 offset:6208
    ds_read_b64_tr_b16 a[206:207], v30 offset:7744
    s_nop 0
L_pad91:
    s_cbranch_execz L_wret
    v_exp_f32 v115, v115 clamp
    v_exp_f32 v116, v116 clamp
    s_waitcnt lgkmcnt(8)
    v_mfma_f32_32x32x16_bf16 a[32:47], a[208:211], v[168:171], a[32:47]
    ds_read_b64_tr_b16 a[208:209], v30 offset:6272
    ds_read_b64_tr_b16 a[210:211], v30 offset:7808
    v_cvt_pk_bf16_f32 v249, v114, v115
    v_bfi_b32 v241, v9, 0, v249
    v_and_b32 v249, v9, v249
    v_bfi_b32 v117, v229, v117, v101
    v_mfma_f32_32x32x16_bf16 a[48:63], a[212:215], v[168:171], a[48:63]
    s_add_u32 m0, s52, 0x18c00
    s_add_u32 s84, s83, 0x4800
    buffer_load_dwordx4 v21, s[20:23], s84 offen lds
    ds_read_b64_tr_b16 a[212:213], v30 offset:9216
    v_mfma_f32_32x32x16_bf16 a[64:79], a[216:219], v[168:171], a[64:79]
    ds_read_b64_tr_b16 a[214:215], v30 offset:10752
    ds_read_b64_tr_b16 a[216:217], v30 offset:9280
    ds_read_b64_tr_b16 a[218:219], v30 offset:10816
    v_exp_f32 v117, v117 clamp
    v_bfi_b32 v118, v230, v118, v102
    v_mfma_f32_32x32x16_bf16 a[32:47], a[220:223], v[172:175], a[32:47]
    ds_read_b64_tr_b16 a[220:221], v30 offset:9344
    ds_read_b64_tr_b16 a[222:223], v30 offset:10880
    v_cvt_pk_bf16_f32 v250, v116, v117
    v_bfi_b32 v242, v10, 0, v250
    v_and_b32 v250, v10, v250
    v_bfi_b32 v119, v231, v119, v103
    s_waitcnt lgkmcnt(8)
    v_mfma_f32_32x32x16_bf16 a[48:63], a[192:195], v[172:175], a[48:63]
    buffer_load_dwordx4 v22, s[20:23], s84 offen offset:1024 lds
    ds_read_b64_tr_b16 a[192:193], v30 offset:12288
    ds_read_b64_tr_b16 a[194:195], v30 offset:13824
    v_bfi_b32 v120, v232, v120, v104
    v_mfma_f32_32x32x16_bf16 a[64:79], a[196:199], v[172:175], a[64:79]
    ds_read_b64_tr_b16 a[196:197], v30 offset:12352
    ds_read_b64_tr_b16 a[198:199], v30 offset:13888
    v_exp_f32 v118, v118 clamp
    v_exp_f32 v119, v119 clamp
    v_mfma_f32_32x32x16_bf16 a[32:47], a[200:203], v[176:179], a[32:47]
    ds_read_b64_tr_b16 a[200:201], v30 offset:12416
    ds_read_b64_tr_b16 a[202:203], v30 offset:13952
    v_cvt_pk_bf16_f32 v251, v118, v119
    buffer_load_dwordx4 v23, s[20:23], s84 offen offset:2048 lds
    v_mfma_f32_32x32x16_bf16 a[48:63], a[204:207], v[176:179], a[48:63]
    ds_read_b64_tr_b16 a[204:205], v30 offset:15360
    ds_read_b64_tr_b16 a[206:207], v30 offset:16896
    v_bfi_b32 v243, v11, 0, v251
    v_and_b32 v251, v11, v251
    v_exp_f32 v120, v120 clamp
    v_mfma_f32_32x32x16_bf16 a[108:123], a[128:131], v[240:243], a[108:123]
    v_bfi_b32 v121, v233, v121, v105
    v_exp_f32 v121, v121 clamp
    v_bfi_b32 v122, v234, v122, v106
    v_cvt_pk_bf16_f32 v252, v120, v121
    v_bfi_b32 v244, v12, 0, v252
    v_mfma_f32_32x32x16_bf16 a[108:123], a[136:139], v[248:251], a[108:123]
    v_and_b32 v252, v12, v252
    v_exp_f32 v122, v122 clamp
    v_bfi_b32 v123, v235, v123, v107
    v_exp_f32 v123, v123 clamp
    s_waitcnt lgkmcnt(4)
    v_mfma_f32_32x32x16_bf16 a[64:79], a[208:211], v[176:179], a[64:79]
    ds_read_b64_tr_b16 a[208:209], v30 offset:15424
    ds_read_b64_tr_b16 a[210:211], v30 offset:16960
    v_cvt_pk_bf16_f32 v253, v122, v123
    v_bfi_b32 v245, v13, 0, v253
L_pad92:
    s_cbranch_execz L_wret
    v_and_b32 v253, v13, v253
    v_bfi_b32 v124, v236, v124, v108
    v_mfma_f32_32x32x16_bf16 a[32:47], a[212:215], v[180:183], a[32:47]
    ds_read_b64_tr_b16 a[212:213], v30 offset:15488
    ds_read_b64_tr_b16 a[214:215], v30 offset:17024
    v_exp_f32 v124, v124 clamp
    v_bfi_b32 v125, v237, v125, v109
    v_bfi_b32 v126, v238, v126, v110
    v_mfma_f32_32x32x16_bf16 a[48:63], a[216:219], v[180:183], a[48:63]
    ds_read_b64_tr_b16 a[216:217], v30 offset:18432
    ds_read_b64_tr_b16 a[218:219], v30 offset:19968
    v_exp_f32 v125, v125 clamp
    v_exp_f32 v126, v126 clamp
    v_mfma_f32_32x32x16_bf16 a[64:79], a[220:223], v[180:183], a[64:79]
    ds_read_b64_tr_b16 a[220:221], v30 offset:18496
    ds_read_b64_tr_b16 a[222:223], v30 offset:20032
    v_cvt_pk_bf16_f32 v254, v124, v125
    v_bfi_b32 v246, v14, 0, v254
    v_and_b32 v254, v14, v254
    v_bfi_b32 v127, v239, v127, v111
    v_mfma_f32_32x32x16_bf16 a[32:47], a[192:195], v[184:187], a[32:47]
    ds_read_b64_tr_b16 a[192:193], v30 offset:18560
    ds_read_b64_tr_b16 a[194:195], v30 offset:20096
    v_exp_f32 v127, v127 clamp
    v_mfma_f32_32x32x16_bf16 a[48:63], a[196:199], v[184:187], a[48:63]
    ds_read_b64_tr_b16 a[196:197], v30 offset:21504
    ds_read_b64_tr_b16 a[198:199], v30 offset:23040
    v_cvt_pk_bf16_f32 v255, v126, v127
    v_bfi_b32 v247, v15, 0, v255
    v_and_b32 v255, v15, v255
    s_nop 0
    v_mfma_f32_32x32x16_bf16 a[108:123], a[132:135], v[244:247], a[108:123]
    v_mfma_f32_32x32x16_bf16 a[108:123], a[140:143], v[252:255], a[108:123]
    s_waitcnt lgkmcnt(4)
    v_mfma_f32_32x32x16_bf16 a[64:79], a[200:203], v[184:187], a[64:79]
    ds_read_b64_tr_b16 a[200:201], v30 offset:21568
    ds_read_b64_tr_b16 a[202:203], v30 offset:23104
    v_mfma_f32_32x32x16_bf16 a[32:47], a[204:207], v[188:191], a[32:47]
    ds_read_b64_tr_b16 a[204:205], v30 offset:21632
    ds_read_b64_tr_b16 a[206:207], v30 offset:23168
    v_mfma_f32_32x32x16_bf16 a[48:63], a[208:211], v[188:191], a[48:63]
    v_mfma_f32_32x32x16_bf16 a[64:79], a[212:215], v[188:191], a[64:79]
    v_mfma_f32_32x32x16_bf16 a[32:47], a[216:219], v[192:195], a[32:47]
    s_barrier
    s_add_u32 m0, s52, 0x1e000
    s_add_u32 s83, s3, s73
    buffer_load_dwordx4 v21, s[20:23], s83 offen lds
    v_mfma_f32_32x32x16_bf16 a[48:63], a[220:223], v[192:195], a[48:63]
    ds_read_b64_tr_b16 a[208:209], v30 offset:24576
    ds_read_b64_tr_b16 a[210:211], v30 offset:26112
    ds_read_b64_tr_b16 a[212:213], v30 offset:24640
    ds_read_b64_tr_b16 a[214:215], v30 offset:26176
    ds_read_b64_tr_b16 a[216:217], v30 offset:24704
    ds_read_b64_tr_b16 a[218:219], v30 offset:26240
    s_waitcnt lgkmcnt(6)
    v_mfma_f32_32x32x16_bf16 a[64:79], a[192:195], v[192:195], a[64:79]
    ds_read_b64_tr_b16 a[220:221], v30 offset:27648
    ds_read_b64_tr_b16 a[222:223], v30 offset:29184
    ds_read_b64_tr_b16 a[192:193], v30 offset:27712
    ds_read_b64_tr_b16 a[194:195], v30 offset:29248
    v_accvgpr_read_b32 v212, a108
    v_accvgpr_read_b32 v213, a109
    v_mfma_f32_32x32x16_bf16 a[32:47], a[196:199], v[196:199], a[32:47]
    buffer_load_dwordx4 v22, s[20:23], s83 offen offset:1024 lds
    ds_read_b64_tr_b16 a[196:197], v30 offset:27776
    ds_read_b64_tr_b16 a[198:199], v30 offset:29312
    v_accvgpr_read_b32 v214, a110
    s_nop 0
L_pad93:
    s_cbranch_execz L_wret
    v_mfma_f32_32x32x16_bf16 a[48:63], a[200:203], v[196:199], a[48:63]
    ds_read_b64_tr_b16 a[200:201], v30 offset:30720
    ds_read_b64_tr_b16 a[202:203], v30 offset:32256
    v_accvgpr_read_b32 v215, a111
    v_accvgpr_read_b32 v216, a112
    v_accvgpr_read_b32 v217, a113
    v_accvgpr_read_b32 v218, a114
    v_mfma_f32_32x32x16_bf16 a[64:79], a[204:207], v[196:199], a[64:79]
    ds_read_b64_tr_b16 a[204:205], v30 offset:30784
    ds_read_b64_tr_b16 a[206:207], v30 offset:32320
    v_accvgpr_read_b32 v219, a115
    buffer_load_dwordx4 v23, s[20:23], s83 offen offset:2048 lds
    s_waitcnt lgkmcnt(11)
    v_mfma_f32_32x32x16_bf16 a[80:95], a[208:211], v[136:139], 0
    ds_read_b64_tr_b16 a[208:209], v30 offset:30848
    ds_read_b64_tr_b16 a[210:211], v30 offset:32384
    v_accvgpr_read_b32 v220, a116
    v_accvgpr_read_b32 v221, a117
    v_accvgpr_read_b32 v222, a118
    v_mfma_f32_32x32x16_bf16 a[96:111], a[212:215], v[136:139], 0
    ds_read_b64_tr_b16 a[212:213], v30 offset:33792
    ds_read_b64_tr_b16 a[214:215], v30 offset:35328
    v_rcp_f32 v222, v222
    s_waitcnt lgkmcnt(8)
    v_mfma_f32_32x32x16_bf16 v[112:127], a[216:219], v[136:139], 0
    s_add_u32 m0, s52, 0x1ec00
    s_add_u32 s84, s83, 0x4800
    buffer_load_dwordx4 v21, s[20:23], s84 offen lds
    ds_read_b64_tr_b16 a[216:217], v30 offset:33856
    v_mfma_f32_32x32x16_bf16 a[80:95], a[220:223], v[140:143], a[80:95]
    ds_read_b64_tr_b16 a[218:219], v30 offset:35392
    ds_read_b64_tr_b16 a[220:221], v30 offset:33920
    ds_read_b64_tr_b16 a[222:223], v30 offset:35456
    v_mul_f32 v222, v222, v47
    v_mul_f32 v212, v212, v222
    v_mul_f32 v213, v213, v222
    v_mfma_f32_32x32x16_bf16 a[96:111], a[192:195], v[140:143], a[96:111]
    ds_read_b64_tr_b16 a[192:193], v30 offset:36864
    ds_read_b64_tr_b16 a[194:195], v30 offset:38400
    v_mul_f32 v214, v214, v222
    v_mul_f32 v215, v215, v222
    v_mul_f32 v216, v216, v222
    v_mul_f32 v217, v217, v222
    v_mfma_f32_32x32x16_bf16 v[112:127], a[196:199], v[140:143], v[112:127]
    buffer_load_dwordx4 v22, s[20:23], s84 offen offset:1024 lds
    ds_read_b64_tr_b16 a[196:197], v30 offset:36928
    ds_read_b64_tr_b16 a[198:199], v30 offset:38464
    v_mul_f32 v218, v218, v222
    s_waitcnt lgkmcnt(8)
    v_mfma_f32_32x32x16_bf16 a[80:95], a[200:203], v[144:147], a[80:95]
    ds_read_b64_tr_b16 a[200:201], v30 offset:36992
    ds_read_b64_tr_b16 a[202:203], v30 offset:38528
    v_mul_f32 v219, v219, v222
    v_mul_f32 v220, v220, v222
    v_mul_f32 v221, v221, v222
    v_cvt_pk_bf16_f32 v204, v212, v213
    v_mfma_f32_32x32x16_bf16 a[96:111], a[204:207], v[144:147], a[96:111]
    ds_read_b64_tr_b16 a[204:205], v30 offset:39936
    ds_read_b64_tr_b16 a[206:207], v30 offset:41472
    buffer_load_dwordx4 v23, s[20:23], s84 offen offset:2048 lds
    v_cvt_pk_bf16_f32 v205, v214, v215
    v_mfma_f32_32x32x16_bf16 v[112:127], a[208:211], v[144:147], v[112:127]
    ds_read_b64_tr_b16 a[208:209], v30 offset:40000
    ds_read_b64_tr_b16 a[210:211], v30 offset:41536
    v_cvt_pk_bf16_f32 v206, v216, v217
    v_cvt_pk_bf16_f32 v207, v218, v219
    v_cvt_pk_bf16_f32 v220, v220, v221
    v_cndmask_b32 v209, 0, v220, s[92:93]
    v_mfma_f32_32x32x16_bf16 a[80:95], a[212:215], v[148:151], a[80:95]
    ds_read_b64_tr_b16 a[212:213], v30 offset:40064
    ds_read_b64_tr_b16 a[214:215], v30 offset:41600
L_pad94:
    s_cbranch_execz L_wret
    s_waitcnt lgkmcnt(8)
    v_mfma_f32_32x32x16_bf16 a[96:111], a[216:219], v[148:151], a[96:111]
    s_mov_b32 s85, 0x4000
    buffer_store_dwordx4 v[204:207], v24, s[32:35], s85 offen offset:3072 sc1
    ds_read_b64_tr_b16 a[216:217], v30 offset:43008
    ds_read_b64_tr_b16 a[218:219], v30 offset:44544
    v_mfma_f32_32x32x16_bf16 v[112:127], a[220:223], v[148:151], v[112:127]
    ds_read_b64_tr_b16 a[220:221], v30 offset:43072
    ds_read_b64_tr_b16 a[222:223], v30 offset:44608
    v_mfma_f32_32x32x16_bf16 a[80:95], a[192:195], v[152:155], a[80:95]
    ds_read_b64_tr_b16 a[192:193], v30 offset:43136
    ds_read_b64_tr_b16 a[194:195], v30 offset:44672
    v_mfma_f32_32x32x16_bf16 a[96:111], a[196:199], v[152:155], a[96:111]
    s_mov_b32 s85, 0x5000
    buffer_store_dwordx2 v[208:209], v24, s[32:35], s85 offen sc1
    ds_read_b64_tr_b16 a[196:197], v30 offset:46080
    ds_read_b64_tr_b16 a[198:199], v30 offset:47616
    s_waitcnt lgkmcnt(8)
    v_mfma_f32_32x32x16_bf16 v[112:127], a[200:203], v[152:155], v[112:127]
    ds_read_b64_tr_b16 a[200:201], v30 offset:46144
    ds_read_b64_tr_b16 a[202:203], v30 offset:47680
    v_mfma_f32_32x32x16_bf16 a[80:95], a[204:207], v[156:159], a[80:95]
    ds_read_b64_tr_b16 a[204:205], v30 offset:46208
    ds_read_b64_tr_b16 a[206:207], v30 offset:47744
    v_mfma_f32_32x32x16_bf16 a[96:111], a[208:211], v[156:159], a[96:111]
    v_mfma_f32_32x32x16_bf16 v[112:127], a[212:215], v[156:159], v[112:127]
    s_waitcnt lgkmcnt(5)
    v_mfma_f32_32x32x16_bf16 a[80:95], a[216:219], v[160:163], a[80:95]
    s_waitcnt vmcnt(22)
    s_barrier
    s_waitcnt vmcnt(14)
    v_cmp_le_u32 vcc, 2, v27
    s_nop 1
    s_cmp_eq_u64 vcc, -1
    s_cbranch_scc0 L_slow2
L_back2:
    v_mfma_f32_32x32x16_bf16 a[96:111], a[220:223], v[160:163], a[96:111]
    s_add_u32 m0, s52, 0
    s_add_u32 s83, s7, s87
    buffer_load_dwordx4 v21, s[12:15], s83 offen lds
    v_mov_b32 v16, 3
    v_mfma_f32_32x32x16_bf16 v[112:127], a[192:195], v[160:163], v[112:127]
    ds_read_b64_tr_b16 a[208:209], v31 offset:0
    ds_read_b64_tr_b16 a[210:211], v31 offset:1536
    ds_read_b64_tr_b16 a[212:213], v31 offset:64
    ds_read_b64_tr_b16 a[214:215], v31 offset:1600
    ds_read_b64_tr_b16 a[216:217], v31 offset:128
    ds_read_b64_tr_b16 a[218:219], v31 offset:1664
    s_waitcnt lgkmcnt(6)
    v_mfma_f32_32x32x16_bf16 a[80:95], a[196:199], v[164:167], a[80:95]
    ds_read_b64_tr_b16 a[220:221], v31 offset:3072
    ds_read_b64_tr_b16 a[222:223], v31 offset:4608
    ds_read_b64_tr_b16 a[192:193], v31 offset:3136
    ds_read_b64_tr_b16 a[194:195], v31 offset:4672
    ds_read_b64_tr_b16 a[196:197], v31 offset:3200
    ds_read_b64_tr_b16 a[198:199], v31 offset:4736
    v_mfma_f32_32x32x16_bf16 a[96:111], a[200:203], v[164:167], a[96:111]
    buffer_load_dwordx4 v22, s[12:15], s83 offen offset:1024 lds
    ds_read_b64_tr_b16 a[200:201], v31 offset:6144
    ds_read_b64_tr_b16 a[202:203], v31 offset:7680
    v_mfma_f32_32x32x16_bf16 v[112:127], a[204:207], v[164:167], v[112:127]
    ds_read_b64_tr_b16 a[204:205], v31 offset:6208
    ds_read_b64_tr_b16 a[206:207], v31 offset:7744
    s_waitcnt lgkmcnt(14)
    v_mfma_f32_32x32x16_bf16 a[80:95], a[208:211], v[168:171], a[80:95]
    buffer_load_dwordx4 v23, s[12:15], s83 offen offset:2048 lds
    ds_read_b64_tr_b16 a[208:209], v31 offset:6272
    ds_read_b64_tr_b16 a[210:211], v31 offset:7808
    s_waitcnt lgkmcnt(10)
    v_mfma_f32_32x32x16_bf16 a[96:111], a[212:215], v[168:171], a[96:111]
    ds_read_b64_tr_b16 a[212:213], v31 offset:9216
    ds_read_b64_tr_b16 a[214:215], v31 offset:10752
    s_nop 0
L_pad95:
    s_cbranch_execz L_wret
    v_mfma_f32_32x32x16_bf16 v[112:127], a[216:219], v[168:171], v[112:127]
    ds_read_b64_tr_b16 a[216:217], v31 offset:9280
    ds_read_b64_tr_b16 a[218:219], v31 offset:10816
    s_mov_b32 s72, 0x3000
    buffer_load_dwordx4 a[0:3], v25, s[32:35], s72 offen sc1
    v_mfma_f32_32x32x16_bf16 a[80:95], a[220:223], v[172:175], a[80:95]
    ds_read_b64_tr_b16 a[220:221], v31 offset:9344
    ds_read_b64_tr_b16 a[222:223], v31 offset:10880
    s_waitcnt lgkmcnt(8)
    v_mfma_f32_32x32x16_bf16 a[96:111], a[192:195], v[172:175], a[96:111]
    ds_read_b64_tr_b16 a[192:193], v31 offset:12288
    ds_read_b64_tr_b16 a[194:195], v31 offset:13824
    v_mfma_f32_32x32x16_bf16 v[112:127], a[196:199], v[172:175], v[112:127]
    s_add_u32 m0, s52, 0xc00
    s_add_u32 s84, s71, s87
    buffer_load_dwordx4 v21, s[12:15], s84 offen lds
    ds_read_b64_tr_b16 a[196:197], v31 offset:12352
    v_mfma_f32_32x32x16_bf16 a[80:95], a[200:203], v[176:179], a[80:95]
    ds_read_b64_tr_b16 a[198:199], v31 offset:13888
    ds_read_b64_tr_b16 a[200:201], v31 offset:12416
    ds_read_b64_tr_b16 a[202:203], v31 offset:13952
    v_mfma_f32_32x32x16_bf16 a[96:111], a[204:207], v[176:179], a[96:111]
    ds_read_b64_tr_b16 a[204:205], v31 offset:15360
    ds_read_b64_tr_b16 a[206:207], v31 offset:16896
    s_waitcnt lgkmcnt(8)
    v_mfma_f32_32x32x16_bf16 v[112:127], a[208:211], v[176:179], v[112:127]
    buffer_load_dwordx4 v22, s[12:15], s84 offen offset:1024 lds
    ds_read_b64_tr_b16 a[208:209], v31 offset:15424
    ds_read_b64_tr_b16 a[210:211], v31 offset:16960
    v_mfma_f32_32x32x16_bf16 a[80:95], a[212:215], v[180:183], a[80:95]
    ds_read_b64_tr_b16 a[212:213], v31 offset:15488
    ds_read_b64_tr_b16 a[214:215], v31 offset:17024
    v_mfma_f32_32x32x16_bf16 a[96:111], a[216:219], v[180:183], a[96:111]
    ds_read_b64_tr_b16 a[216:217], v31 offset:18432
    ds_read_b64_tr_b16 a[218:219], v31 offset:19968
    buffer_load_dwordx4 v23, s[12:15], s84 offen offset:2048 lds
    v_mfma_f32_32x32x16_bf16 v[112:127], a[220:223], v[180:183], v[112:127]
    ds_read_b64_tr_b16 a[220:221], v31 offset:18496
    ds_read_b64_tr_b16 a[222:223], v31 offset:20032
    s_waitcnt lgkmcnt(8)
    v_mfma_f32_32x32x16_bf16 a[80:95], a[192:195], v[184:187], a[80:95]
    ds_read_b64_tr_b16 a[192:193], v31 offset:18560
    ds_read_b64_tr_b16 a[194:195], v31 offset:20096
    v_mfma_f32_32x32x16_bf16 a[96:111], a[196:199], v[184:187], a[96:111]
    s_mov_b32 s72, 0x3000
    buffer_load_dwordx4 a[4:7], v25, s[32:35], s72 offen offset:1024 sc1
    ds_read_b64_tr_b16 a[196:197], v31 offset:21504
    ds_read_b64_tr_b16 a[198:199], v31 offset:23040
    v_mfma_f32_32x32x16_bf16 v[112:127], a[200:203], v[184:187], v[112:127]
    ds_read_b64_tr_b16 a[200:201], v31 offset:21568
    ds_read_b64_tr_b16 a[202:203], v31 offset:23104
    v_mfma_f32_32x32x16_bf16 a[80:95], a[204:207], v[188:191], a[80:95]
    ds_read_b64_tr_b16 a[204:205], v31 offset:21632
    ds_read_b64_tr_b16 a[206:207], v31 offset:23168
    s_mov_b32 s72, 0x3000
    buffer_load_dwordx4 a[8:11], v25, s[32:35], s72 offen offset:2048 sc1
    s_waitcnt lgkmcnt(8)
    v_mfma_f32_32x32x16_bf16 a[96:111], a[208:211], v[188:191], a[96:111]
    v_mfma_f32_32x32x16_bf16 v[112:127], a[212:215], v[188:191], v[112:127]
    v_mfma_f32_32x32x16_bf16 a[80:95], a[216:219], v[192:195], a[80:95]
    s_waitcnt vmcnt(9)
    buffer_store_dword v16, v29, s[28:31], 0 offen sc1
    s_barrier
    ds_read_b64_tr_b16 a[208:209], v31 offset:24576
    v_mfma_f32_32x32x16_bf16 a[96:111], a[220:223], v[192:195], a[96:111]
    ds_read_b64_tr_b16 a[210:211], v31 offset:26112
    s_add_u32 m0, s52, 0x6000
L_pad96:
    s_cbranch_execz L_wret
    s_add_u32 s83, s5, s88
    buffer_load_dwordx4 v21, s[8:11], s83 offen lds
    s_waitcnt lgkmcnt(2)
    v_mfma_f32_32x32x16_bf16 v[112:127], a[192:195], v[192:195], v[112:127]
    ds_read_b64_tr_b16 a[212:213], v31 offset:24640
    ds_read_b64_tr_b16 a[214:215], v31 offset:26176
    ds_read_b64_tr_b16 a[216:217], v31 offset:24704
    ds_read_b64_tr_b16 a[218:219], v31 offset:26240
    ds_read_b64_tr_b16 a[220:221], v31 offset:27648
    ds_read_b64_tr_b16 a[222:223], v31 offset:29184
    v_mfma_f32_32x32x16_bf16 a[80:95], a[196:199], v[196:199], a[80:95]
    ds_read_b64_tr_b16 a[192:193], v31 offset:27712
    ds_read_b64_tr_b16 a[194:195], v31 offset:29248
    ds_read_b64_tr_b16 a[196:197], v31 offset:27776
    ds_read_b64_tr_b16 a[198:199], v31 offset:29312
    v_mfma_f32_32x32x16_bf16 a[96:111], a[200:203], v[196:199], a[96:111]
    buffer_load_dwordx4 v22, s[8:11], s83 offen offset:1024 lds
    ds_read_b64_tr_b16 a[200:201], v31 offset:30720
    ds_read_b64_tr_b16 a[202:203], v31 offset:32256
    v_mfma_f32_32x32x16_bf16 v[112:127], a[204:207], v[196:199], v[112:127]
    ds_read_b64_tr_b16 a[204:205], v31 offset:30784
    ds_read_b64_tr_b16 a[206:207], v31 offset:32320
    s_waitcnt lgkmcnt(14)
    v_mfma_f32_32x32x16_bf16 a[32:47], a[208:211], v[128:131], a[32:47]
    ds_read_b64_tr_b16 a[208:209], v31 offset:30848
    ds_read_b64_tr_b16 a[210:211], v31 offset:32384
    buffer_load_dwordx4 v23, s[8:11], s83 offen offset:2048 lds
    s_waitcnt lgkmcnt(11)
    v_mfma_f32_32x32x16_bf16 a[48:63], a[212:215], v[128:131], a[48:63]
    ds_read_b64_tr_b16 a[212:213], v31 offset:33792
    ds_read_b64_tr_b16 a[214:215], v31 offset:35328
    v_mfma_f32_32x32x16_bf16 a[64:79], a[216:219], v[128:131], a[64:79]
    ds_read_b64_tr_b16 a[216:217], v31 offset:33856
    ds_read_b64_tr_b16 a[218:219], v31 offset:35392
    s_waitcnt lgkmcnt(8)
    v_mfma_f32_32x32x16_bf16 a[32:47], a[220:223], v[132:135], a[32:47]
    s_add_u32 m0, s52, 0x6c00
    s_add_u32 s84, s70, s88
    buffer_load_dwordx4 v21, s[8:11], s84 offen lds
    ds_read_b64_tr_b16 a[220:221], v31 offset:33920
    v_mfma_f32_32x32x16_bf16 a[48:63], a[192:195], v[132:135], a[48:63]
    ds_read_b64_tr_b16 a[222:223], v31 offset:35456
    ds_read_b64_tr_b16 a[192:193], v31 offset:36864
    ds_read_b64_tr_b16 a[194:195], v31 offset:38400
    v_mfma_f32_32x32x16_bf16 a[64:79], a[196:199], v[132:135], a[64:79]
    ds_read_b64_tr_b16 a[196:197], v31 offset:36928
    ds_read_b64_tr_b16 a[198:199], v31 offset:38464
    v_mfma_f32_32x32x16_bf16 a[32:47], a[200:203], v[200:203], a[32:47]
    buffer_load_dwordx4 v22, s[8:11], s84 offen offset:1024 lds
    ds_read_b64_tr_b16 a[200:201], v31 offset:36992
    ds_read_b64_tr_b16 a[202:203], v31 offset:38528
    s_waitcnt lgkmcnt(8)
    v_mfma_f32_32x32x16_bf16 a[48:63], a[204:207], v[200:203], a[48:63]
    ds_read_b64_tr_b16 a[204:205], v31 offset:39936
    ds_read_b64_tr_b16 a[206:207], v31 offset:41472
    v_mfma_f32_32x32x16_bf16 a[64:79], a[208:211], v[200:203], a[64:79]
    ds_read_b64_tr_b16 a[208:209], v31 offset:40000
    ds_read_b64_tr_b16 a[210:211], v31 offset:41536
    buffer_load_dwordx4 v23, s[8:11], s84 offen offset:2048 lds
    v_mfma_f32_32x32x16_bf16 a[32:47], a[212:215], v[204:207], a[32:47]
    ds_read_b64_tr_b16 a[212:213], v31 offset:40064
    ds_read_b64_tr_b16 a[214:215], v31 offset:41600
    v_mfma_f32_32x32x16_bf16 a[48:63], a[216:219], v[204:207], a[48:63]
    ds_read_b64_tr_b16 a[216:217], v31 offset:43008
    ds_read_b64_tr_b16 a[218:219], v31 offset:44544
    s_waitcnt lgkmcnt(8)
    v_mfma_f32_32x32x16_bf16 a[64:79], a[220:223], v[204:207], a[64:79]
    s_nop 0
L_pad97:
    s_cbranch_execz L_wret
    s_mov_b32 s72, 0x3000
    buffer_load_dwordx4 a[12:15], v25, s[32:35], s72 offen offset:3072 sc1
    ds_read_b64_tr_b16 a[220:221], v31 offset:43072
    ds_read_b64_tr_b16 a[222:223], v31 offset:44608
    v_mfma_f32_32x32x16_bf16 a[32:47], a[192:195], a[144:147], a[32:47]
    ds_read_b64_tr_b16 a[192:193], v31 offset:43136
    ds_read_b64_tr_b16 a[194:195], v31 offset:44672
    v_mfma_f32_32x32x16_bf16 a[48:63], a[196:199], a[144:147], a[48:63]
    ds_read_b64_tr_b16 a[196:197], v31 offset:46080
    ds_read_b64_tr_b16 a[198:199], v31 offset:47616
    s_mov_b32 s72, 0x4000
    buffer_load_dwordx4 a[16:19], v25, s[32:35], s72 offen sc1
    v_mfma_f32_32x32x16_bf16 a[64:79], a[200:203], a[144:147], a[64:79]
    ds_read_b64_tr_b16 a[200:201], v31 offset:46144
    ds_read_b64_tr_b16 a[202:203], v31 offset:47680
    s_waitcnt lgkmcnt(8)
    v_mfma_f32_32x32x16_bf16 a[32:47], a[204:207], a[148:151], a[32:47]
    ds_read_b64_tr_b16 a[204:205], v31 offset:46208
    ds_read_b64_tr_b16 a[206:207], v31 offset:47744
    v_mfma_f32_32x32x16_bf16 a[48:63], a[208:211], a[148:151], a[48:63]
    s_mov_b32 s72, 0x4000
    buffer_load_dwordx4 a[20:23], v25, s[32:35], s72 offen offset:1024 sc1
    v_mfma_f32_32x32x16_bf16 a[64:79], a[212:215], a[148:151], a[64:79]
    v_mfma_f32_32x32x16_bf16 a[32:47], a[216:219], a[152:155], a[32:47]
    s_barrier
    ds_read_b64_tr_b16 a[208:209], v32 offset:0
    ds_read_b64_tr_b16 a[210:211], v32 offset:1536
    buffer_load_dwordx4 a[24:27], v25, s[32:35], 0 offen sc1
    ds_read_b64_tr_b16 a[212:213], v32 offset:64
    s_waitcnt lgkmcnt(5)
    v_mfma_f32_32x32x16_bf16 a[48:63], a[220:223], a[152:155], a[48:63]
    ds_read_b64_tr_b16 a[214:215], v32 offset:1600
    ds_read_b64_tr_b16 a[216:217], v32 offset:128
    ds_read_b64_tr_b16 a[218:219], v32 offset:1664
    ds_read_b64_tr_b16 a[220:221], v32 offset:3072
    ds_read_b64_tr_b16 a[222:223], v32 offset:4608
    v_mfma_f32_32x32x16_bf16 a[64:79], a[192:195], a[152:155], a[64:79]
    ds_read_b64_tr_b16 a[192:193], v32 offset:3136
    ds_read_b64_tr_b16 a[194:195], v32 offset:4672
    buffer_load_dwordx4 a[28:31], v25, s[32:35], 0 offen offset:1024 sc1
    v_mfma_f32_32x32x16_bf16 a[32:47], a[196:199], a[156:159], a[32:47]
    ds_read_b64_tr_b16 a[196:197], v32 offset:3200
    ds_read_b64_tr_b16 a[198:199], v32 offset:4736
    v_mfma_f32_32x32x16_bf16 a[48:63], a[200:203], a[156:159], a[48:63]
    ds_read_b64_tr_b16 a[200:201], v32 offset:6144
    ds_read_b64_tr_b16 a[202:203], v32 offset:7680
    s_waitcnt lgkmcnt(12)
    v_mfma_f32_32x32x16_bf16 a[64:79], a[204:207], a[156:159], a[64:79]
    s_add_u32 m0, s52, 0xc000
    s_add_u32 s83, s6, s88
    buffer_load_dwordx4 v21, s[20:23], s83 offen lds
    ds_read_b64_tr_b16 a[204:205], v32 offset:6208
    v_mfma_f32_32x32x16_bf16 a[32:47], a[208:211], a[160:163], a[32:47]
    ds_read_b64_tr_b16 a[206:207], v32 offset:7744
    ds_read_b64_tr_b16 a[208:209], v32 offset:6272
    ds_read_b64_tr_b16 a[210:211], v32 offset:7808
    s_waitcnt lgkmcnt(8)
    v_mfma_f32_32x32x16_bf16 a[48:63], a[212:215], a[160:163], a[48:63]
    ds_read_b64_tr_b16 a[212:213], v32 offset:9216
    ds_read_b64_tr_b16 a[214:215], v32 offset:10752
    buffer_load_dword v27, v26, s[28:31], 0 offen sc1
    v_mfma_f32_32x32x16_bf16 a[64:79], a[216:219], a[160:163], a[64:79]
    ds_read_b64_tr_b16 a[216:217], v32 offset:9280
    ds_read_b64_tr_b16 a[218:219], v32 offset:10816
    buffer_load_dwordx4 v22, s[20:23], s83 offen offset:1024 lds
    v_mfma_f32_32x32x16_bf16 a[32:47], a[220:223], a[164:167], a[32:47]
    s_nop 0
L_pad98:
    s_cbranch_execz L_wret
    ds_read_b64_tr_b16 a[220:221], v32 offset:9344
    ds_read_b64_tr_b16 a[222:223], v32 offset:10880
    v_mfma_f32_32x32x16_bf16 a[48:63], a[192:195], a[164:167], a[48:63]
    ds_read_b64_tr_b16 a[192:193], v32 offset:12288
    ds_read_b64_tr_b16 a[194:195], v32 offset:13824
    s_waitcnt lgkmcnt(8)
    v_mfma_f32_32x32x16_bf16 a[64:79], a[196:199], a[164:167], a[64:79]
    buffer_load_dwordx4 v23, s[20:23], s83 offen offset:2048 lds
    ds_read_b64_tr_b16 a[196:197], v32 offset:12352
    ds_read_b64_tr_b16 a[198:199], v32 offset:13888
    v_mfma_f32_32x32x16_bf16 a[32:47], a[200:203], a[168:171], a[32:47]
    ds_read_b64_tr_b16 a[200:201], v32 offset:12416
    ds_read_b64_tr_b16 a[202:203], v32 offset:13952
    v_mfma_f32_32x32x16_bf16 a[48:63], a[204:207], a[168:171], a[48:63]
    ds_read_b64_tr_b16 a[204:205], v32 offset:15360
    ds_read_b64_tr_b16 a[206:207], v32 offset:16896
    v_mfma_f32_32x32x16_bf16 a[64:79], a[208:211], a[168:171], a[64:79]
    s_add_u32 m0, s52, 0xcc00
    s_add_u32 s84, s83, 0x4800
    buffer_load_dwordx4 v21, s[20:23], s84 offen lds
    ds_read_b64_tr_b16 a[208:209], v32 offset:15424
    s_waitcnt lgkmcnt(7)
    v_mfma_f32_32x32x16_bf16 a[32:47], a[212:215], a[172:175], a[32:47]
    ds_read_b64_tr_b16 a[210:211], v32 offset:16960
    ds_read_b64_tr_b16 a[212:213], v32 offset:15488
    ds_read_b64_tr_b16 a[214:215], v32 offset:17024
    v_mfma_f32_32x32x16_bf16 a[48:63], a[216:219], a[172:175], a[48:63]
    ds_read_b64_tr_b16 a[216:217], v32 offset:18432
    ds_read_b64_tr_b16 a[218:219], v32 offset:19968
    v_mfma_f32_32x32x16_bf16 a[64:79], a[220:223], a[172:175], a[64:79]
    buffer_load_dwordx4 v22, s[20:23], s84 offen offset:1024 lds
    ds_read_b64_tr_b16 a[220:221], v32 offset:18496
    ds_read_b64_tr_b16 a[222:223], v32 offset:20032
    v_mfma_f32_32x32x16_bf16 a[32:47], a[192:195], a[244:247], a[32:47]
    ds_read_b64_tr_b16 a[192:193], v32 offset:18560
    ds_read_b64_tr_b16 a[194:195], v32 offset:20096
    s_waitcnt lgkmcnt(10)
    v_mfma_f32_32x32x16_bf16 a[48:63], a[196:199], a[244:247], a[48:63]
    ds_read_b64_tr_b16 a[196:197], v32 offset:21504
    ds_read_b64_tr_b16 a[198:199], v32 offset:23040
    buffer_load_dwordx4 v23, s[20:23], s84 offen offset:2048 lds
    v_mfma_f32_32x32x16_bf16 a[64:79], a[200:203], a[244:247], a[64:79]
    ds_read_b64_tr_b16 a[200:201], v32 offset:21568
    ds_read_b64_tr_b16 a[202:203], v32 offset:23104
    v_mfma_f32_32x32x16_bf16 a[32:47], a[204:207], a[248:251], a[32:47]
    ds_read_b64_tr_b16 a[204:205], v32 offset:21632
    ds_read_b64_tr_b16 a[206:207], v32 offset:23168
    s_waitcnt lgkmcnt(8)
    v_mfma_f32_32x32x16_bf16 a[48:63], a[208:211], a[248:251], a[48:63]
    v_mfma_f32_32x32x16_bf16 a[64:79], a[212:215], a[248:251], a[64:79]
    s_waitcnt vmcnt(24)
    v_mfma_f32_32x32x16_bf16 a[32:47], a[216:219], a[0:3], a[32:47]
    s_barrier
    s_add_u32 m0, s52, 0x12000
    s_add_u32 s83, s4, s73
    buffer_load_dwordx4 v21, s[20:23], s83 offen lds
    v_mfma_f32_32x32x16_bf16 a[48:63], a[220:223], a[0:3], a[48:63]
    ds_read_b64_tr_b16 a[208:209], v32 offset:24576
    ds_read_b64_tr_b16 a[210:211], v32 offset:26112
    ds_read_b64_tr_b16 a[212:213], v32 offset:24640
    ds_read_b64_tr_b16 a[214:215], v32 offset:26176
    ds_read_b64_tr_b16 a[216:217], v32 offset:24704
    ds_read_b64_tr_b16 a[218:219], v32 offset:26240
    s_waitcnt lgkmcnt(6)
    v_mfma_f32_32x32x16_bf16 a[64:79], a[192:195], a[0:3], a[64:79]
    ds_read_b64_tr_b16 a[220:221], v32 offset:27648
    ds_read_b64_tr_b16 a[222:223], v32 offset:29184
    s_nop 0
L_pad99:
    s_cbranch_execz L_wret
    ds_read_b64_tr_b16 a[192:193], v32 offset:27712
    ds_read_b64_tr_b16 a[194:195], v32 offset:29248
    s_waitcnt vmcnt(21)
    v_mfma_f32_32x32x16_bf16 a[32:47], a[196:199], a[4:7], a[32:47]
    buffer_load_dwordx4 v22, s[20:23], s83 offen offset:1024 lds
    ds_read_b64_tr_b16 a[196:197], v32 offset:27776
    ds_read_b64_tr_b16 a[198:199], v32 offset:29312
    v_mfma_f32_32x32x16_bf16 a[48:63], a[200:203], a[4:7], a[48:63]
    ds_read_b64_tr_b16 a[200:201], v32 offset:30720
    ds_read_b64_tr_b16 a[202:203], v32 offset:32256
    v_mfma_f32_32x32x16_bf16 a[64:79], a[204:207], a[4:7], a[64:79]
    ds_read_b64_tr_b16 a[204:205], v32 offset:30784
    ds_read_b64_tr_b16 a[206:207], v32 offset:32320
    buffer_load_dwordx4 v23, s[20:23], s83 offen offset:2048 lds
    s_waitcnt lgkmcnt(10)
    v_mfma_f32_32x32x16_bf16 v[64:79], a[208:211], v[136:139], 0
    ds_read_b64_tr_b16 a[208:209], v32 offset:30848
    ds_read_b64_tr_b16 a[210:211], v32 offset:32384
    v_mfma_f32_32x32x16_bf16 v[80:95], a[212:215], v[136:139], 0
    ds_read_b64_tr_b16 a[212:213], v32 offset:33792
    ds_read_b64_tr_b16 a[214:215], v32 offset:35328
    v_mfma_f32_32x32x16_bf16 v[96:111], a[216:219], v[136:139], 0
    s_add_u32 m0, s52, 0x12c00
    s_add_u32 s84, s83, 0x4800
    buffer_load_dwordx4 v21, s[20:23], s84 offen lds
    ds_read_b64_tr_b16 a[216:217], v32 offset:33856
    s_waitcnt lgkmcnt(7)
    v_mfma_f32_32x32x16_bf16 v[64:79], a[220:223], v[140:143], v[64:79]
    ds_read_b64_tr_b16 a[218:219], v32 offset:35392
    ds_read_b64_tr_b16 a[220:221], v32 offset:33920
    ds_read_b64_tr_b16 a[222:223], v32 offset:35456
    v_mfma_f32_32x32x16_bf16 v[80:95], a[192:195], v[140:143], v[80:95]
    ds_read_b64_tr_b16 a[192:193], v32 offset:36864
    ds_read_b64_tr_b16 a[194:195], v32 offset:38400
    v_mfma_f32_32x32x16_bf16 v[96:111], a[196:199], v[140:143], v[96:111]
    buffer_load_dwordx4 v22, s[20:23], s84 offen offset:1024 lds
    ds_read_b64_tr_b16 a[196:197], v32 offset:36928
    ds_read_b64_tr_b16 a[198:199], v32 offset:38464
    v_mfma_f32_32x32x16_bf16 v[64:79], a[200:203], v[144:147], v[64:79]
    ds_read_b64_tr_b16 a[200:201], v32 offset:36992
    ds_read_b64_tr_b16 a[202:203], v32 offset:38528
    s_waitcnt lgkmcnt(10)
    v_mfma_f32_32x32x16_bf16 v[80:95], a[204:207], v[144:147], v[80:95]
    ds_read_b64_tr_b16 a[204:205], v32 offset:39936
    ds_read_b64_tr_b16 a[206:207], v32 offset:41472
    buffer_load_dwordx4 v23, s[20:23], s84 offen offset:2048 lds
    v_mfma_f32_32x32x16_bf16 v[96:111], a[208:211], v[144:147], v[96:111]
    ds_read_b64_tr_b16 a[208:209], v32 offset:40000
    ds_read_b64_tr_b16 a[210:211], v32 offset:41536
    v_mfma_f32_32x32x16_bf16 v[64:79], a[212:215], v[148:151], v[64:79]
    ds_read_b64_tr_b16 a[212:213], v32 offset:40064
    ds_read_b64_tr_b16 a[214:215], v32 offset:41600
    s_waitcnt lgkmcnt(8)
    v_mfma_f32_32x32x16_bf16 v[80:95], a[216:219], v[148:151], v[80:95]
    ds_read_b64_tr_b16 a[216:217], v32 offset:43008
    ds_read_b64_tr_b16 a[218:219], v32 offset:44544
    v_mfma_f32_32x32x16_bf16 v[96:111], a[220:223], v[148:151], v[96:111]
    ds_read_b64_tr_b16 a[220:221], v32 offset:43072
    ds_read_b64_tr_b16 a[222:223], v32 offset:44608
    v_mfma_f32_32x32x16_bf16 v[64:79], a[192:195], v[152:155], v[64:79]
    ds_read_b64_tr_b16 a[192:193], v32 offset:43136
    ds_read_b64_tr_b16 a[194:195], v32 offset:44672
    v_mfma_f32_32x32x16_bf16 v[80:95], a[196:199], v[152:155], v[80:95]
    ds_read_b64_tr_b16 a[196:197], v32 offset:46080
    ds_read_b64_tr_b16 a[198:199], v32 offset:47616
    s_waitcnt lgkmcnt(8)
    s_nop 0
L_pad100:
    s_cbranch_execz L_wret
    v_mfma_f32_32x32x16_bf16 v[96:111], a[200:203], v[152:155], v[96:111]
    s_waitcnt vmcnt(11)
    v_cmp_le_u32 vcc, 3, v27
    s_nop 1
    s_cmp_eq_u64 vcc, -1
    s_cbranch_scc0 L_slow3
L_back3:
    v_mfma_f32_32x32x16_bf16 v[64:79], a[204:207], v[156:159], v[64:79]
    s_mov_b32 s72, 0x4000
    buffer_load_dwordx4 a[112:115], v25, s[32:35], s72 offen offset:2048 sc1
    ds_read_b64_tr_b16 a[200:201], v32 offset:46144
    ds_read_b64_tr_b16 a[202:203], v32 offset:47680
    ds_read_b64_tr_b16 a[204:205], v32 offset:46208
    v_mfma_f32_32x32x16_bf16 v[80:95], a[208:211], v[156:159], v[80:95]
    ds_read_b64_tr_b16 a[206:207], v32 offset:47744
    v_mfma_f32_32x32x16_bf16 v[96:111], a[212:215], v[156:159], v[96:111]
    s_mov_b32 s72, 0x4000
    buffer_load_dwordx4 a[116:119], v25, s[32:35], s72 offen offset:3072 sc1
    s_waitcnt lgkmcnt(4)
    v_mfma_f32_32x32x16_bf16 v[64:79], a[216:219], v[160:163], v[64:79]
    s_barrier
    ds_read_b64_tr_b16 a[208:209], v30 offset:0
    ds_read_b64_tr_b16 a[210:211], v30 offset:1536
    ds_read_b64_tr_b16 a[212:213], v30 offset:64
    ds_read_b64_tr_b16 a[214:215], v30 offset:1600
    ds_read_b64_tr_b16 a[216:217], v30 offset:128
    v_mfma_f32_32x32x16_bf16 v[80:95], a[220:223], v[160:163], v[80:95]
    ds_read_b64_tr_b16 a[218:219], v30 offset:1664
    ds_read_b64_tr_b16 a[220:221], v30 offset:3072
    ds_read_b64_tr_b16 a[222:223], v30 offset:4608
    v_mfma_f32_32x32x16_bf16 v[96:111], a[192:195], v[160:163], v[96:111]
    s_mov_b32 s72, 0x5000
    buffer_load_dwordx2 v[210:211], v25, s[32:35], s72 offen sc1
    ds_read_b64_tr_b16 a[192:193], v30 offset:3136
    ds_read_b64_tr_b16 a[194:195], v30 offset:4672
    v_mfma_f32_32x32x16_bf16 v[64:79], a[196:199], v[164:167], v[64:79]
    s_add_u32 m0, s52, 0x18000
    s_add_u32 s83, s7, s88
    buffer_load_dwordx4 v21, s[12:15], s83 offen lds
    ds_read_b64_tr_b16 a[196:197], v30 offset:3200
    s_waitcnt lgkmcnt(11)
    v_mfma_f32_32x32x16_bf16 v[80:95], a[200:203], v[164:167], v[80:95]
    ds_read_b64_tr_b16 a[198:199], v30 offset:4736
    ds_read_b64_tr_b16 a[200:201], v30 offset:6144
    ds_read_b64_tr_b16 a[202:203], v30 offset:7680
    v_mfma_f32_32x32x16_bf16 v[96:111], a[204:207], v[164:167], v[96:111]
    ds_read_b64_tr_b16 a[204:205], v30 offset:6208
    ds_read_b64_tr_b16 a[206:207], v30 offset:7744
    s_waitcnt lgkmcnt(8)
    v_mfma_f32_32x32x16_bf16 a[32:47], a[208:211], a[8:11], a[32:47]
    buffer_load_dwordx4 v22, s[12:15], s83 offen offset:1024 lds
    ds_read_b64_tr_b16 a[208:209], v30 offset:6272
    ds_read_b64_tr_b16 a[210:211], v30 offset:7808
    v_mfma_f32_32x32x16_bf16 a[48:63], a[212:215], a[8:11], a[48:63]
    ds_read_b64_tr_b16 a[212:213], v30 offset:9216
    ds_read_b64_tr_b16 a[214:215], v30 offset:10752
    v_mfma_f32_32x32x16_bf16 a[64:79], a[216:219], a[8:11], a[64:79]
    ds_read_b64_tr_b16 a[216:217], v30 offset:9280
    ds_read_b64_tr_b16 a[218:219], v30 offset:10816
    buffer_load_dwordx4 v23, s[12:15], s83 offen offset:2048 lds
    v_mfma_f32_32x32x16_bf16 a[32:47], a[220:223], a[12:15], a[32:47]
    ds_read_b64_tr_b16 a[220:221], v30 offset:9344
    ds_read_b64_tr_b16 a[222:223], v30 offset:10880
    s_waitcnt lgkmcnt(8)
    v_mfma_f32_32x32x16_bf16 a[48:63], a[192:195], a[12:15], a[48:63]
    ds_read_b64_tr_b16 a[192:193], v30 offset:12288
    ds_read_b64_tr_b16 a[194:195], v30 offset:13824
    v_mfma_f32_32x32x16_bf16 a[64:79], a[196:199], a[12:15], a[64:79]
    s_add_u32 m0, s52, 0x18c00
    s_add_u32 s84, s71, s88
    s_nop 0
L_pad101:
    s_cbranch_execz L_wret
    buffer_load_dwordx4 v21, s[12:15], s84 offen lds
    ds_read_b64_tr_b16 a[196:197], v30 offset:12352
    v_mfma_f32_32x32x16_bf16 a[32:47], a[200:203], a[16:19], a[32:47]
    ds_read_b64_tr_b16 a[198:199], v30 offset:13888
    ds_read_b64_tr_b16 a[200:201], v30 offset:12416
    ds_read_b64_tr_b16 a[202:203], v30 offset:13952
    v_mfma_f32_32x32x16_bf16 a[48:63], a[204:207], a[16:19], a[48:63]
    ds_read_b64_tr_b16 a[204:205], v30 offset:15360
    ds_read_b64_tr_b16 a[206:207], v30 offset:16896
    s_waitcnt lgkmcnt(8)
    v_mfma_f32_32x32x16_bf16 a[64:79], a[208:211], a[16:19], a[64:79]
    buffer_load_dwordx4 v22, s[12:15], s84 offen offset:1024 lds
    ds_read_b64_tr_b16 a[208:209], v30 offset:15424
    ds_read_b64_tr_b16 a[210:211], v30 offset:16960
    v_mfma_f32_32x32x16_bf16 a[32:47], a[212:215], a[20:23], a[32:47]
    ds_read_b64_tr_b16 a[212:213], v30 offset:15488
    ds_read_b64_tr_b16 a[214:215], v30 offset:17024
    v_mfma_f32_32x32x16_bf16 a[48:63], a[216:219], a[20:23], a[48:63]
    ds_read_b64_tr_b16 a[216:217], v30 offset:18432
    ds_read_b64_tr_b16 a[218:219], v30 offset:19968
    buffer_load_dwordx4 v23, s[12:15], s84 offen offset:2048 lds
    v_mfma_f32_32x32x16_bf16 a[64:79], a[220:223], a[20:23], a[64:79]
    ds_read_b64_tr_b16 a[220:221], v30 offset:18496
    ds_read_b64_tr_b16 a[222:223], v30 offset:20032
    s_waitcnt lgkmcnt(8)
    v_mfma_f32_32x32x16_bf16 a[32:47], a[192:195], a[24:27], a[32:47]
    ds_read_b64_tr_b16 a[192:193], v30 offset:18560
    ds_read_b64_tr_b16 a[194:195], v30 offset:20096
    v_mfma_f32_32x32x16_bf16 a[48:63], a[196:199], a[24:27], a[48:63]
    ds_read_b64_tr_b16 a[196:197], v30 offset:21504
    ds_read_b64_tr_b16 a[198:199], v30 offset:23040
    v_mfma_f32_32x32x16_bf16 a[64:79], a[200:203], a[24:27], a[64:79]
    ds_read_b64_tr_b16 a[200:201], v30 offset:21568
    ds_read_b64_tr_b16 a[202:203], v30 offset:23104
    v_mfma_f32_32x32x16_bf16 a[32:47], a[204:207], a[28:31], a[32:47]
    ds_read_b64_tr_b16 a[204:205], v30 offset:21632
    ds_read_b64_tr_b16 a[206:207], v30 offset:23168
    s_waitcnt lgkmcnt(8)
    v_mfma_f32_32x32x16_bf16 a[48:63], a[208:211], a[28:31], a[48:63]
    ds_read_b64_tr_b16 a[208:209], v33 offset:0
    ds_read_b64_tr_b16 a[210:211], v33 offset:2304
    v_mfma_f32_32x32x16_bf16 a[64:79], a[212:215], a[28:31], a[64:79]
    ds_read_b64_tr_b16 a[212:213], v33 offset:64
    ds_read_b64_tr_b16 a[214:215], v33 offset:2368
    s_waitcnt vmcnt(8)
    v_mfma_f32_32x32x16_bf16 a[32:47], a[216:219], a[112:115], a[32:47]
    ds_read_b64_tr_b16 a[216:217], v33 offset:128
    ds_read_b64_tr_b16 a[218:219], v33 offset:2432
    v_mfma_f32_32x32x16_bf16 a[48:63], a[220:223], a[112:115], a[48:63]
    s_waitcnt lgkmcnt(2)
    v_mfma_f32_32x32x16_bf16 a[64:79], a[192:195], a[112:115], a[64:79]
    s_waitcnt vmcnt(7)
    v_mfma_f32_32x32x16_bf16 a[32:47], a[196:199], a[116:119], a[32:47]
    s_barrier
    s_add_u32 m0, s52, 0x1e000
    s_add_u32 s83, s5, s73
    buffer_load_dwordx4 v21, s[8:11], s83 offen lds
    v_mfma_f32_32x32x16_bf16 a[48:63], a[200:203], a[116:119], a[48:63]
    ds_read_b64_tr_b16 a[220:221], v30 offset:24576
    ds_read_b64_tr_b16 a[222:223], v30 offset:26112
    ds_read_b64_tr_b16 a[192:193], v30 offset:24640
    ds_read_b64_tr_b16 a[194:195], v30 offset:26176
    ds_read_b64_tr_b16 a[196:197], v30 offset:24704
    ds_read_b64_tr_b16 a[198:199], v30 offset:26240
    v_mfma_f32_32x32x16_bf16 a[64:79], a[204:207], a[116:119], a[64:79]
    ds_read_b64_tr_b16 a[200:201], v30 offset:27648
    ds_read_b64_tr_b16 a[202:203], v30 offset:29184
    s_nop 0
L_pad102:
    s_cbranch_execz L_wret
    ds_read_b64_tr_b16 a[204:205], v30 offset:27712
    ds_read_b64_tr_b16 a[206:207], v30 offset:29248
    s_waitcnt vmcnt(7)
    v_mfma_f32_32x32x16_bf16 a[32:47], a[208:211], v[208:211], a[32:47]
    buffer_load_dwordx4 v22, s[8:11], s83 offen offset:1024 lds
    ds_read_b64_tr_b16 a[208:209], v30 offset:27776
    ds_read_b64_tr_b16 a[210:211], v30 offset:29312
    v_mfma_f32_32x32x16_bf16 a[48:63], a[212:215], v[208:211], a[48:63]
    ds_read_b64_tr_b16 a[212:213], v30 offset:30720
    ds_read_b64_tr_b16 a[214:215], v30 offset:32256
    s_waitcnt lgkmcnt(14)
    v_mfma_f32_32x32x16_bf16 a[64:79], a[216:219], v[208:211], a[64:79]
    ds_read_b64_tr_b16 a[216:217], v30 offset:30784
    ds_read_b64_tr_b16 a[218:219], v30 offset:32320
    buffer_load_dwordx4 v23, s[8:11], s83 offen offset:2048 lds
    s_waitcnt lgkmcnt(10)
    v_mfma_f32_32x32x16_bf16 a[80:95], a[220:223], v[128:131], a[80:95]
    ds_read_b64_tr_b16 a[220:221], v30 offset:30848
    ds_read_b64_tr_b16 a[222:223], v30 offset:32384
    v_accvgpr_read_b32 v224, a32
    v_accvgpr_read_b32 v225, a33
    v_accvgpr_read_b32 v226, a34
    v_accvgpr_read_b32 v227, a35
    v_mfma_f32_32x32x16_bf16 a[96:111], a[192:195], v[128:131], a[96:111]
    ds_read_b64_tr_b16 a[192:193], v30 offset:33792
    ds_read_b64_tr_b16 a[194:195], v30 offset:35328
    v_accvgpr_read_b32 v228, a36
    v_accvgpr_read_b32 v229, a37
    v_accvgpr_read_b32 v230, a38
    v_accvgpr_read_b32 v231, a39
    v_mfma_f32_32x32x16_bf16 v[112:127], a[196:199], v[128:131], v[112:127]
    s_add_u32 m0, s52, 0x1ec00
    s_add_u32 s84, s70, s73
    buffer_load_dwordx4 v21, s[8:11], s84 offen lds
    ds_read_b64_tr_b16 a[196:197], v30 offset:33856
    s_waitcnt lgkmcnt(7)
    v_mfma_f32_32x32x16_bf16 a[80:95], a[200:203], v[132:135], a[80:95]
    ds_read_b64_tr_b16 a[198:199], v30 offset:35392
    ds_read_b64_tr_b16 a[200:201], v30 offset:33920
    ds_read_b64_tr_b16 a[202:203], v30 offset:35456
    v_accvgpr_read_b32 v232, a40
    v_accvgpr_read_b32 v233, a41
    v_accvgpr_read_b32 v234, a42
    v_mfma_f32_32x32x16_bf16 a[96:111], a[204:207], v[132:135], a[96:111]
    ds_read_b64_tr_b16 a[204:205], v30 offset:36864
    ds_read_b64_tr_b16 a[206:207], v30 offset:38400
    v_accvgpr_read_b32 v235, a43
    v_accvgpr_read_b32 v236, a44
    v_accvgpr_read_b32 v237, a45
    v_accvgpr_read_b32 v238, a46
    v_mfma_f32_32x32x16_bf16 v[112:127], a[208:211], v[132:135], v[112:127]
    buffer_load_dwordx4 v22, s[8:11], s84 offen offset:1024 lds
    ds_read_b64_tr_b16 a[208:209], v30 offset:36928
    ds_read_b64_tr_b16 a[210:211], v30 offset:38464
    v_accvgpr_read_b32 v239, a47
    v_mfma_f32_32x32x16_bf16 a[80:95], a[212:215], v[200:203], a[80:95]
    ds_read_b64_tr_b16 a[212:213], v30 offset:36992
    ds_read_b64_tr_b16 a[214:215], v30 offset:38528
    v_cvt_pk_bf16_f32 v240, v224, v225
    v_cvt_pk_bf16_f32 v241, v226, v227
    v_cvt_pk_bf16_f32 v242, v228, v229
    v_cvt_pk_bf16_f32 v243, v230, v231
    s_waitcnt lgkmcnt(10)
    v_mfma_f32_32x32x16_bf16 a[96:111], a[216:219], v[200:203], a[96:111]
    ds_read_b64_tr_b16 a[216:217], v30 offset:39936
    ds_read_b64_tr_b16 a[218:219], v30 offset:41472
    s_nop 0
L_pad103:
    s_cbranch_execz L_wret
    buffer_load_dwordx4 v23, s[8:11], s84 offen offset:2048 lds
    v_cvt_pk_bf16_f32 v244, v232, v233
    v_mfma_f32_32x32x16_bf16 v[112:127], a[220:223], v[200:203], v[112:127]
    ds_read_b64_tr_b16 a[220:221], v30 offset:40000
    ds_read_b64_tr_b16 a[222:223], v30 offset:41536
    v_cvt_pk_bf16_f32 v245, v234, v235
    v_cvt_pk_bf16_f32 v246, v236, v237
    v_cvt_pk_bf16_f32 v247, v238, v239
    v_accvgpr_read_b32 v224, a48
    v_mfma_f32_32x32x16_bf16 a[80:95], a[192:195], v[204:207], a[80:95]
    ds_read_b64_tr_b16 a[192:193], v30 offset:40064
    ds_read_b64_tr_b16 a[194:195], v30 offset:41600
    v_accvgpr_read_b32 v225, a49
    v_accvgpr_read_b32 v226, a50
    v_accvgpr_read_b32 v227, a51
    v_accvgpr_read_b32 v228, a52
    s_waitcnt lgkmcnt(8)
    v_mfma_f32_32x32x16_bf16 a[96:111], a[196:199], v[204:207], a[96:111]
    ds_read_b64_tr_b16 a[196:197], v30 offset:43008
    ds_read_b64_tr_b16 a[198:199], v30 offset:44544
    s_mov_b32 s76, 0
    buffer_store_dwordx4 v[240:243], v57, s[32:35], s76 offen sc1
    v_mfma_f32_32x32x16_bf16 v[112:127], a[200:203], v[204:207], v[112:127]
    ds_read_b64_tr_b16 a[200:201], v30 offset:43072
    ds_read_b64_tr_b16 a[202:203], v30 offset:44608
    v_accvgpr_read_b32 v229, a53
    v_accvgpr_read_b32 v230, a54
    v_accvgpr_read_b32 v231, a55
    v_accvgpr_read_b32 v232, a56
    v_mfma_f32_32x32x16_bf16 a[80:95], a[204:207], a[144:147], a[80:95]
    ds_read_b64_tr_b16 a[204:205], v30 offset:43136
    ds_read_b64_tr_b16 a[206:207], v30 offset:44672
    v_accvgpr_read_b32 v233, a57
    v_accvgpr_read_b32 v234, a58
    v_accvgpr_read_b32 v235, a59
    v_accvgpr_read_b32 v236, a60
    v_mfma_f32_32x32x16_bf16 a[96:111], a[208:211], a[144:147], a[96:111]
    ds_read_b64_tr_b16 a[208:209], v30 offset:46080
    ds_read_b64_tr_b16 a[210:211], v30 offset:47616
    buffer_store_dwordx4 v[244:247], v57, s[32:35], s76 offen offset:128 sc1
    v_accvgpr_read_b32 v237, a61
    s_waitcnt lgkmcnt(8)
    v_mfma_f32_32x32x16_bf16 v[112:127], a[212:215], a[144:147], v[112:127]
    ds_read_b64_tr_b16 a[212:213], v30 offset:46144
    ds_read_b64_tr_b16 a[214:215], v30 offset:47680
    v_accvgpr_read_b32 v238, a62
    v_accvgpr_read_b32 v239, a63
    v_cvt_pk_bf16_f32 v248, v224, v225
    v_cvt_pk_bf16_f32 v249, v226, v227
    v_mfma_f32_32x32x16_bf16 a[80:95], a[216:219], a[148:151], a[80:95]
    ds_read_b64_tr_b16 a[216:217], v30 offset:46208
    ds_read_b64_tr_b16 a[218:219], v30 offset:47744
    v_cvt_pk_bf16_f32 v250, v228, v229
    v_cvt_pk_bf16_f32 v251, v230, v231
    v_cvt_pk_bf16_f32 v252, v232, v233
    v_cvt_pk_bf16_f32 v253, v234, v235
    v_mfma_f32_32x32x16_bf16 a[96:111], a[220:223], a[148:151], a[96:111]
    v_cvt_pk_bf16_f32 v254, v236, v237
    v_cvt_pk_bf16_f32 v255, v238, v239
    s_mov_b32 s77, 0x2000
    buffer_store_dwordx4 v[248:251], v57, s[32:35], s77 offen sc1
    v_mfma_f32_32x32x16_bf16 v[112:127], a[192:195], a[148:151], v[112:127]
    v_accvgpr_read_b32 v224, a64
    v_accvgpr_read_b32 v225, a65
    v_accvgpr_read_b32 v226, a66
L_pad104:
    s_cbranch_execz L_wret
    v_accvgpr_read_b32 v227, a67
    v_accvgpr_read_b32 v228, a68
    v_accvgpr_read_b32 v229, a69
    s_waitcnt lgkmcnt(4)
    v_mfma_f32_32x32x16_bf16 a[80:95], a[196:199], a[152:155], a[80:95]
    s_barrier
    ds_read_b64_tr_b16 a[220:221], v31 offset:0
    ds_read_b64_tr_b16 a[222:223], v31 offset:1536
    ds_read_b64_tr_b16 a[192:193], v31 offset:64
    ds_read_b64_tr_b16 a[194:195], v31 offset:1600
    ds_read_b64_tr_b16 a[196:197], v31 offset:128
    v_mfma_f32_32x32x16_bf16 a[96:111], a[200:203], a[152:155], a[96:111]
    s_add_u32 m0, s52, 0
    s_add_u32 s83, s6, s73
    buffer_load_dwordx4 v21, s[20:23], s83 offen lds
    ds_read_b64_tr_b16 a[198:199], v31 offset:1664
    v_mfma_f32_32x32x16_bf16 v[112:127], a[204:207], a[152:155], v[112:127]
    ds_read_b64_tr_b16 a[200:201], v31 offset:3072
    ds_read_b64_tr_b16 a[202:203], v31 offset:4608
    ds_read_b64_tr_b16 a[204:205], v31 offset:3136
    ds_read_b64_tr_b16 a[206:207], v31 offset:4672
    v_accvgpr_read_b32 v230, a70
    v_accvgpr_read_b32 v231, a71
    v_mfma_f32_32x32x16_bf16 a[80:95], a[208:211], a[156:159], a[80:95]
    ds_read_b64_tr_b16 a[208:209], v31 offset:3200
    ds_read_b64_tr_b16 a[210:211], v31 offset:4736
    v_accvgpr_read_b32 v232, a72
    v_accvgpr_read_b32 v233, a73
    v_accvgpr_read_b32 v234, a74
    v_accvgpr_read_b32 v235, a75
    s_waitcnt lgkmcnt(12)
    v_mfma_f32_32x32x16_bf16 a[96:111], a[212:215], a[156:159], a[96:111]
    buffer_load_dwordx4 v22, s[20:23], s83 offen offset:1024 lds
    ds_read_b64_tr_b16 a[212:213], v31 offset:6144
    ds_read_b64_tr_b16 a[214:215], v31 offset:7680
    v_accvgpr_read_b32 v236, a76
    v_mfma_f32_32x32x16_bf16 v[112:127], a[216:219], a[156:159], v[112:127]
    ds_read_b64_tr_b16 a[216:217], v31 offset:6208
    ds_read_b64_tr_b16 a[218:219], v31 offset:7744
    v_accvgpr_read_b32 v237, a77
    v_accvgpr_read_b32 v238, a78
    v_accvgpr_read_b32 v239, a79
    v_cvt_pk_bf16_f32 v240, v224, v225
    s_waitcnt lgkmcnt(11)
    v_mfma_f32_32x32x16_bf16 a[80:95], a[220:223], a[160:163], a[80:95]
    ds_read_b64_tr_b16 a[220:221], v31 offset:6272
    ds_read_b64_tr_b16 a[222:223], v31 offset:7808
    buffer_load_dwordx4 v23, s[20:23], s83 offen offset:2048 lds
    v_cvt_pk_bf16_f32 v241, v226, v227
    v_mfma_f32_32x32x16_bf16 a[96:111], a[192:195], a[160:163], a[96:111]
    ds_read_b64_tr_b16 a[192:193], v31 offset:9216
    ds_read_b64_tr_b16 a[194:195], v31 offset:10752
    v_cvt_pk_bf16_f32 v242, v228, v229
    v_cvt_pk_bf16_f32 v243, v230, v231
    v_cvt_pk_bf16_f32 v244, v232, v233
    v_cvt_pk_bf16_f32 v245, v234, v235
    s_waitcnt lgkmcnt(8)
    v_mfma_f32_32x32x16_bf16 v[112:127], a[196:199], a[160:163], v[112:127]
    ds_read_b64_tr_b16 a[196:197], v31 offset:9280
    ds_read_b64_tr_b16 a[198:199], v31 offset:10816
    v_cvt_pk_bf16_f32 v246, v236, v237
    v_cvt_pk_bf16_f32 v247, v238, v239
    v_mfma_f32_32x32x16_bf16 a[80:95], a[200:203], a[164:167], a[80:95]
    s_add_u32 m0, s52, 0xc00
    s_add_u32 s84, s83, 0x4800
    buffer_load_dwordx4 v21, s[20:23], s84 offen lds
    ds_read_b64_tr_b16 a[200:201], v31 offset:9344
L_pad105:
    s_cbranch_execz L_wret
    v_mfma_f32_32x32x16_bf16 a[96:111], a[204:207], a[164:167], a[96:111]
    ds_read_b64_tr_b16 a[202:203], v31 offset:10880
    ds_read_b64_tr_b16 a[204:205], v31 offset:12288
    ds_read_b64_tr_b16 a[206:207], v31 offset:13824
    v_mfma_f32_32x32x16_bf16 v[112:127], a[208:211], a[164:167], v[112:127]
    ds_read_b64_tr_b16 a[208:209], v31 offset:12352
    ds_read_b64_tr_b16 a[210:211], v31 offset:13888
    s_waitcnt lgkmcnt(8)
    v_mfma_f32_32x32x16_bf16 a[80:95], a[212:215], a[168:171], a[80:95]
    buffer_load_dwordx4 v22, s[20:23], s84 offen offset:1024 lds
    ds_read_b64_tr_b16 a[212:213], v31 offset:12416
    ds_read_b64_tr_b16 a[214:215], v31 offset:13952
    v_mfma_f32_32x32x16_bf16 a[96:111], a[216:219], a[168:171], a[96:111]
    ds_read_b64_tr_b16 a[216:217], v31 offset:15360
    ds_read_b64_tr_b16 a[218:219], v31 offset:16896
    v_mfma_f32_32x32x16_bf16 v[112:127], a[220:223], a[168:171], v[112:127]
    ds_read_b64_tr_b16 a[220:221], v31 offset:15424
    ds_read_b64_tr_b16 a[222:223], v31 offset:16960
    buffer_load_dwordx4 v23, s[20:23], s84 offen offset:2048 lds
    v_mfma_f32_32x32x16_bf16 a[80:95], a[192:195], a[172:175], a[80:95]
    ds_read_b64_tr_b16 a[192:193], v31 offset:15488
    ds_read_b64_tr_b16 a[194:195], v31 offset:17024
    s_waitcnt lgkmcnt(8)
    v_mfma_f32_32x32x16_bf16 a[96:111], a[196:199], a[172:175], a[96:111]
    ds_read_b64_tr_b16 a[196:197], v31 offset:18432
    ds_read_b64_tr_b16 a[198:199], v31 offset:19968
    v_mfma_f32_32x32x16_bf16 v[112:127], a[200:203], a[172:175], v[112:127]
    ds_read_b64_tr_b16 a[200:201], v31 offset:18496
    ds_read_b64_tr_b16 a[202:203], v31 offset:20032
    buffer_store_dwordx4 v[252:255], v57, s[32:35], s77 offen offset:128 sc1
    v_mfma_f32_32x32x16_bf16 a[80:95], a[204:207], a[244:247], a[80:95]
    ds_read_b64_tr_b16 a[204:205], v31 offset:18560
    ds_read_b64_tr_b16 a[206:207], v31 offset:20096
    v_mfma_f32_32x32x16_bf16 a[96:111], a[208:211], a[244:247], a[96:111]
    ds_read_b64_tr_b16 a[208:209], v31 offset:21504
    ds_read_b64_tr_b16 a[210:211], v31 offset:23040
    s_waitcnt lgkmcnt(8)
    v_mfma_f32_32x32x16_bf16 v[112:127], a[212:215], a[244:247], v[112:127]
    ds_read_b64_tr_b16 a[212:213], v31 offset:21568
    ds_read_b64_tr_b16 a[214:215], v31 offset:23104
    s_mov_b32 s76, 0x4000
    buffer_store_dwordx4 v[240:243], v57, s[32:35], s76 offen sc1
    v_mfma_f32_32x32x16_bf16 a[80:95], a[216:219], a[248:251], a[80:95]
    ds_read_b64_tr_b16 a[216:217], v31 offset:21632
    ds_read_b64_tr_b16 a[218:219], v31 offset:23168
    v_mfma_f32_32x32x16_bf16 a[96:111], a[220:223], a[248:251], a[96:111]
    v_mfma_f32_32x32x16_bf16 v[112:127], a[192:195], a[248:251], v[112:127]
    buffer_store_dwordx4 v[244:247], v57, s[32:35], s76 offen offset:128 sc1
    s_waitcnt lgkmcnt(4)
    v_mfma_f32_32x32x16_bf16 a[80:95], a[196:199], a[0:3], a[80:95]
    s_barrier
    ds_read_b64_tr_b16 a[220:221], v31 offset:24576
    ds_read_b64_tr_b16 a[222:223], v31 offset:26112
    ds_read_b64_tr_b16 a[192:193], v31 offset:24640
    ds_read_b64_tr_b16 a[194:195], v31 offset:26176
    ds_read_b64_tr_b16 a[196:197], v31 offset:24704
    v_mfma_f32_32x32x16_bf16 a[96:111], a[200:203], a[0:3], a[96:111]
    ds_read_b64_tr_b16 a[198:199], v31 offset:26240
    ds_read_b64_tr_b16 a[200:201], v31 offset:27648
    ds_read_b64_tr_b16 a[202:203], v31 offset:29184
    v_mfma_f32_32x32x16_bf16 v[112:127], a[204:207], a[0:3], v[112:127]
    s_add_u32 m0, s52, 0x6000
    s_add_u32 s83, s7, s73
    buffer_load_dwordx4 v21, s[12:15], s83 offen lds
    ds_read_b64_tr_b16 a[204:205], v31 offset:27712
    v_mfma_f32_32x32x16_bf16 a[80:95], a[208:211], a[4:7], a[80:95]
    s_nop 0
L_pad106:
    s_cbranch_execz L_wret
    ds_read_b64_tr_b16 a[206:207], v31 offset:29248
    ds_read_b64_tr_b16 a[208:209], v31 offset:27776
    ds_read_b64_tr_b16 a[210:211], v31 offset:29312
    s_waitcnt lgkmcnt(12)
    v_mfma_f32_32x32x16_bf16 a[96:111], a[212:215], a[4:7], a[96:111]
    ds_read_b64_tr_b16 a[212:213], v31 offset:30720
    ds_read_b64_tr_b16 a[214:215], v31 offset:32256
    v_mfma_f32_32x32x16_bf16 v[112:127], a[216:219], a[4:7], v[112:127]
    buffer_load_dwordx4 v22, s[12:15], s83 offen offset:1024 lds
    ds_read_b64_tr_b16 a[216:217], v31 offset:30784
    ds_read_b64_tr_b16 a[218:219], v31 offset:32320
    s_waitcnt lgkmcnt(8)
    v_mfma_f32_32x32x16_bf16 v[64:79], a[220:223], v[168:171], v[64:79]
    ds_read_b64_tr_b16 a[220:221], v31 offset:30848
    ds_read_b64_tr_b16 a[222:223], v31 offset:32384
    v_mfma_f32_32x32x16_bf16 v[80:95], a[192:195], v[168:171], v[80:95]
    ds_read_b64_tr_b16 a[192:193], v31 offset:33792
    ds_read_b64_tr_b16 a[194:195], v31 offset:35328
    buffer_load_dwordx4 v23, s[12:15], s83 offen offset:2048 lds
    v_mfma_f32_32x32x16_bf16 v[96:111], a[196:199], v[168:171], v[96:111]
    ds_read_b64_tr_b16 a[196:197], v31 offset:33856
    ds_read_b64_tr_b16 a[198:199], v31 offset:35392
    v_mfma_f32_32x32x16_bf16 v[64:79], a[200:203], v[172:175], v[64:79]
    ds_read_b64_tr_b16 a[200:201], v31 offset:33920
    ds_read_b64_tr_b16 a[202:203], v31 offset:35456
    s_waitcnt lgkmcnt(8)
    v_mfma_f32_32x32x16_bf16 v[80:95], a[204:207], v[172:175], v[80:95]
    s_add_u32 m0, s52, 0x6c00
    s_add_u32 s84, s71, s73
    buffer_load_dwordx4 v21, s[12:15], s84 offen lds
    ds_read_b64_tr_b16 a[204:205], v31 offset:36864
    v_mfma_f32_32x32x16_bf16 v[96:111], a[208:211], v[172:175], v[96:111]
    ds_read_b64_tr_b16 a[206:207], v31 offset:38400
    ds_read_b64_tr_b16 a[208:209], v31 offset:36928
    ds_read_b64_tr_b16 a[210:211], v31 offset:38464
    v_mfma_f32_32x32x16_bf16 v[64:79], a[212:215], v[176:179], v[64:79]
    ds_read_b64_tr_b16 a[212:213], v31 offset:36992
    ds_read_b64_tr_b16 a[214:215], v31 offset:38528
    v_mfma_f32_32x32x16_bf16 v[80:95], a[216:219], v[176:179], v[80:95]
    buffer_load_dwordx4 v22, s[12:15], s84 offen offset:1024 lds
    ds_read_b64_tr_b16 a[216:217], v31 offset:39936
    ds_read_b64_tr_b16 a[218:219], v31 offset:41472
    s_waitcnt lgkmcnt(8)
    v_mfma_f32_32x32x16_bf16 v[96:111], a[220:223], v[176:179], v[96:111]
    ds_read_b64_tr_b16 a[220:221], v31 offset:40000
    ds_read_b64_tr_b16 a[222:223], v31 offset:41536
    v_mfma_f32_32x32x16_bf16 v[64:79], a[192:195], v[180:183], v[64:79]
    ds_read_b64_tr_b16 a[192:193], v31 offset:40064
    ds_read_b64_tr_b16 a[194:195], v31 offset:41600
    buffer_load_dwordx4 v23, s[12:15], s84 offen offset:2048 lds
    v_mfma_f32_32x32x16_bf16 v[80:95], a[196:199], v[180:183], v[80:95]
    ds_read_b64_tr_b16 a[196:197], v31 offset:43008
    ds_read_b64_tr_b16 a[198:199], v31 offset:44544
    v_mfma_f32_32x32x16_bf16 v[96:111], a[200:203], v[180:183], v[96:111]
    ds_read_b64_tr_b16 a[200:201], v31 offset:43072
    ds_read_b64_tr_b16 a[202:203], v31 offset:44608
    s_waitcnt lgkmcnt(8)
    v_mfma_f32_32x32x16_bf16 v[64:79], a[204:207], v[184:187], v[64:79]
    ds_read_b64_tr_b16 a[204:205], v31 offset:43136
    ds_read_b64_tr_b16 a[206:207], v31 offset:44672
    v_mfma_f32_32x32x16_bf16 v[80:95], a[208:211], v[184:187], v[80:95]
    ds_read_b64_tr_b16 a[208:209], v31 offset:46080
    ds_read_b64_tr_b16 a[210:211], v31 offset:47616
    v_mfma_f32_32x32x16_bf16 v[96:111], a[212:215], v[184:187], v[96:111]
    ds_read_b64_tr_b16 a[212:213], v31 offset:46144
    ds_read_b64_tr_b16 a[214:215], v31 offset:47680
    s_nop 0
L_pad107:
    s_cbranch_execz L_wret
    v_mfma_f32_32x32x16_bf16 v[64:79], a[216:219], v[188:191], v[64:79]
    ds_read_b64_tr_b16 a[216:217], v31 offset:46208
    ds_read_b64_tr_b16 a[218:219], v31 offset:47744
    s_waitcnt lgkmcnt(8)
    v_mfma_f32_32x32x16_bf16 v[80:95], a[220:223], v[188:191], v[80:95]
    v_mfma_f32_32x32x16_bf16 v[96:111], a[192:195], v[188:191], v[96:111]
    v_mfma_f32_32x32x16_bf16 v[64:79], a[196:199], v[192:195], v[64:79]
    s_waitcnt vmcnt(24)
    s_barrier
    v_mov_b32 v16, 6
    s_waitcnt vmcnt(6)
    buffer_store_dword v16, v61, s[28:31], 0 offen sc1
    v_mfma_f32_32x32x16_bf16 v[80:95], a[200:203], v[192:195], v[80:95]
    ds_read_b64_tr_b16 a[220:221], v32 offset:0
    ds_read_b64_tr_b16 a[222:223], v32 offset:1536
    ds_read_b64_tr_b16 a[192:193], v32 offset:64
    ds_read_b64_tr_b16 a[194:195], v32 offset:1600
    ds_read_b64_tr_b16 a[196:197], v32 offset:128
    ds_read_b64_tr_b16 a[198:199], v32 offset:1664
    s_waitcnt lgkmcnt(6)
    v_mfma_f32_32x32x16_bf16 v[96:111], a[204:207], v[192:195], v[96:111]
    ds_read_b64_tr_b16 a[200:201], v32 offset:3072
    ds_read_b64_tr_b16 a[202:203], v32 offset:4608
    ds_read_b64_tr_b16 a[204:205], v32 offset:3136
    ds_read_b64_tr_b16 a[206:207], v32 offset:4672
    v_mfma_f32_32x32x16_bf16 v[64:79], a[208:211], v[196:199], v[64:79]
    ds_read_b64_tr_b16 a[208:209], v32 offset:3200
    ds_read_b64_tr_b16 a[210:211], v32 offset:4736
    v_mfma_f32_32x32x16_bf16 v[80:95], a[212:215], v[196:199], v[80:95]
    ds_read_b64_tr_b16 a[212:213], v32 offset:6144
    ds_read_b64_tr_b16 a[214:215], v32 offset:7680
    v_mfma_f32_32x32x16_bf16 v[96:111], a[216:219], v[196:199], v[96:111]
    ds_read_b64_tr_b16 a[216:217], v32 offset:6208
    ds_read_b64_tr_b16 a[218:219], v32 offset:7744
    s_waitcnt lgkmcnt(11)
    v_mfma_f32_32x32x16_bf16 a[80:95], a[220:223], a[8:11], a[80:95]
    ds_read_b64_tr_b16 a[220:221], v32 offset:6272
    ds_read_b64_tr_b16 a[222:223], v32 offset:7808
    v_mfma_f32_32x32x16_bf16 a[96:111], a[192:195], a[8:11], a[96:111]
    ds_read_b64_tr_b16 a[192:193], v32 offset:9216
    ds_read_b64_tr_b16 a[194:195], v32 offset:10752
    s_waitcnt lgkmcnt(8)
    v_mfma_f32_32x32x16_bf16 v[112:127], a[196:199], a[8:11], v[112:127]
    ds_read_b64_tr_b16 a[196:197], v32 offset:9280
    ds_read_b64_tr_b16 a[198:199], v32 offset:10816
    v_mfma_f32_32x32x16_bf16 a[80:95], a[200:203], a[12:15], a[80:95]
    ds_read_b64_tr_b16 a[200:201], v32 offset:9344
    ds_read_b64_tr_b16 a[202:203], v32 offset:10880
    v_mfma_f32_32x32x16_bf16 a[96:111], a[204:207], a[12:15], a[96:111]
    ds_read_b64_tr_b16 a[204:205], v32 offset:12288
    ds_read_b64_tr_b16 a[206:207], v32 offset:13824
    v_mfma_f32_32x32x16_bf16 v[112:127], a[208:211], a[12:15], v[112:127]
    ds_read_b64_tr_b16 a[208:209], v32 offset:12352
    ds_read_b64_tr_b16 a[210:211], v32 offset:13888
    s_waitcnt lgkmcnt(8)
    v_mfma_f32_32x32x16_bf16 a[80:95], a[212:215], a[16:19], a[80:95]
    ds_read_b64_tr_b16 a[212:213], v32 offset:12416
    ds_read_b64_tr_b16 a[214:215], v32 offset:13952
    v_mfma_f32_32x32x16_bf16 a[96:111], a[216:219], a[16:19], a[96:111]
    ds_read_b64_tr_b16 a[216:217], v32 offset:15360
    ds_read_b64_tr_b16 a[218:219], v32 offset:16896
    v_mfma_f32_32x32x16_bf16 v[112:127], a[220:223], a[16:19], v[112:127]
    ds_read_b64_tr_b16 a[220:221], v32 offset:15424
    ds_read_b64_tr_b16 a[222:223], v32 offset:16960
    v_mfma_f32_32x32x16_bf16 a[80:95], a[192:195], a[20:23], a[80:95]
    ds_read_b64_tr_b16 a[192:193], v32 offset:15488
    ds_read_b64_tr_b16 a[194:195], v32 offset:17024
    s_waitcnt lgkmcnt(8)
    s_nop 0
L_pad108:
    s_cbranch_execz L_wret
    v_mfma_f32_32x32x16_bf16 a[96:111], a[196:199], a[20:23], a[96:111]
    ds_read_b64_tr_b16 a[196:197], v32 offset:18432
    ds_read_b64_tr_b16 a[198:199], v32 offset:19968
    v_mfma_f32_32x32x16_bf16 v[112:127], a[200:203], a[20:23], v[112:127]
    ds_read_b64_tr_b16 a[200:201], v32 offset:18496
    ds_read_b64_tr_b16 a[202:203], v32 offset:20032
    v_mfma_f32_32x32x16_bf16 a[80:95], a[204:207], a[24:27], a[80:95]
    ds_read_b64_tr_b16 a[204:205], v32 offset:18560
    ds_read_b64_tr_b16 a[206:207], v32 offset:20096
    v_mfma_f32_32x32x16_bf16 a[96:111], a[208:211], a[24:27], a[96:111]
    ds_read_b64_tr_b16 a[208:209], v32 offset:21504
    ds_read_b64_tr_b16 a[210:211], v32 offset:23040
    s_waitcnt lgkmcnt(8)
    v_mfma_f32_32x32x16_bf16 v[112:127], a[212:215], a[24:27], v[112:127]
    ds_read_b64_tr_b16 a[212:213], v32 offset:21568
    ds_read_b64_tr_b16 a[214:215], v32 offset:23104
    v_mfma_f32_32x32x16_bf16 a[80:95], a[216:219], a[28:31], a[80:95]
    ds_read_b64_tr_b16 a[216:217], v32 offset:21632
    ds_read_b64_tr_b16 a[218:219], v32 offset:23168
    v_mfma_f32_32x32x16_bf16 a[96:111], a[220:223], a[28:31], a[96:111]
    ds_read_b64_tr_b16 a[220:221], v34 offset:0
    ds_read_b64_tr_b16 a[222:223], v34 offset:2304
    v_mfma_f32_32x32x16_bf16 v[112:127], a[192:195], a[28:31], v[112:127]
    ds_read_b64_tr_b16 a[192:193], v34 offset:64
    ds_read_b64_tr_b16 a[194:195], v34 offset:2368
    s_waitcnt lgkmcnt(8)
    v_mfma_f32_32x32x16_bf16 a[80:95], a[196:199], a[112:115], a[80:95]
    ds_read_b64_tr_b16 a[196:197], v34 offset:128
    ds_read_b64_tr_b16 a[198:199], v34 offset:2432
    v_mfma_f32_32x32x16_bf16 a[96:111], a[200:203], a[112:115], a[96:111]
    v_mfma_f32_32x32x16_bf16 v[112:127], a[204:207], a[112:115], v[112:127]
    v_mfma_f32_32x32x16_bf16 a[80:95], a[208:211], a[116:119], a[80:95]
    s_waitcnt vmcnt(1)
    s_barrier
    ds_read_b64_tr_b16 a[200:201], v32 offset:24576
    ds_read_b64_tr_b16 a[202:203], v32 offset:26112
    ds_read_b64_tr_b16 a[204:205], v32 offset:27648
    ds_read_b64_tr_b16 a[206:207], v32 offset:29184
    s_waitcnt lgkmcnt(6)
    v_mfma_f32_32x32x16_bf16 a[96:111], a[212:215], a[116:119], a[96:111]
    ds_read_b64_tr_b16 a[208:209], v32 offset:30720
    ds_read_b64_tr_b16 a[210:211], v32 offset:32256
    ds_read_b64_tr_b16 a[212:213], v32 offset:33792
    ds_read_b64_tr_b16 a[214:215], v32 offset:35328
    v_mfma_f32_32x32x16_bf16 v[112:127], a[216:219], a[116:119], v[112:127]
    ds_read_b64_tr_b16 a[216:217], v32 offset:36864
    ds_read_b64_tr_b16 a[218:219], v32 offset:38400
    v_mfma_f32_32x32x16_bf16 a[80:95], a[220:223], v[208:211], a[80:95]
    ds_read_b64_tr_b16 a[220:221], v32 offset:39936
    ds_read_b64_tr_b16 a[222:223], v32 offset:41472
    v_mfma_f32_32x32x16_bf16 a[96:111], a[192:195], v[208:211], a[96:111]
    ds_read_b64_tr_b16 a[192:193], v32 offset:43008
    ds_read_b64_tr_b16 a[194:195], v32 offset:44544
    s_waitcnt lgkmcnt(11)
    v_mfma_f32_32x32x16_bf16 v[112:127], a[196:199], v[208:211], v[112:127]
    ds_read_b64_tr_b16 a[196:197], v32 offset:46080
    ds_read_b64_tr_b16 a[198:199], v32 offset:47616
    v_mfma_f32_32x32x16_bf16 v[64:79], a[200:203], v[128:131], v[64:79]
    ds_read_b64_tr_b16 a[200:201], v30 offset:0
    ds_read_b64_tr_b16 a[202:203], v30 offset:1536
    v_accvgpr_read_b32 v224, a80
    v_accvgpr_read_b32 v225, a81
    v_accvgpr_read_b32 v226, a82
    v_accvgpr_read_b32 v227, a83
    s_waitcnt lgkmcnt(8)
    v_mfma_f32_32x32x16_bf16 v[64:79], a[204:207], v[132:135], v[64:79]
    ds_read_b64_tr_b16 a[204:205], v30 offset:3072
L_pad109:
    s_cbranch_execz L_wret
    ds_read_b64_tr_b16 a[206:207], v30 offset:4608
    v_accvgpr_read_b32 v228, a84
    v_accvgpr_read_b32 v229, a85
    v_accvgpr_read_b32 v230, a86
    v_accvgpr_read_b32 v231, a87
    v_mfma_f32_32x32x16_bf16 v[64:79], a[208:211], v[200:203], v[64:79]
    ds_read_b64_tr_b16 a[208:209], v30 offset:6144
    ds_read_b64_tr_b16 a[210:211], v30 offset:7680
    v_accvgpr_read_b32 v232, a88
    v_accvgpr_read_b32 v233, a89
    v_accvgpr_read_b32 v234, a90
    v_accvgpr_read_b32 v235, a91
    v_mfma_f32_32x32x16_bf16 v[64:79], a[212:215], v[204:207], v[64:79]
    ds_read_b64_tr_b16 a[212:213], v30 offset:9216
    ds_read_b64_tr_b16 a[214:215], v30 offset:10752
    v_accvgpr_read_b32 v236, a92
    v_accvgpr_read_b32 v237, a93
    v_accvgpr_read_b32 v238, a94
    v_accvgpr_read_b32 v239, a95
    v_mfma_f32_32x32x16_bf16 v[64:79], a[216:219], a[144:147], v[64:79]
    ds_read_b64_tr_b16 a[216:217], v30 offset:12288
    ds_read_b64_tr_b16 a[218:219], v30 offset:13824
    v_cvt_pk_bf16_f32 v248, v224, v225
    v_cvt_pk_bf16_f32 v249, v226, v227
    v_cvt_pk_bf16_f32 v250, v228, v229
    v_cvt_pk_bf16_f32 v251, v230, v231
    s_waitcnt lgkmcnt(8)
    v_mfma_f32_32x32x16_bf16 v[64:79], a[220:223], a[148:151], v[64:79]
    ds_read_b64_tr_b16 a[220:221], v30 offset:15360
    ds_read_b64_tr_b16 a[222:223], v30 offset:16896
    v_cvt_pk_bf16_f32 v252, v232, v233
    v_cvt_pk_bf16_f32 v253, v234, v235
    v_cvt_pk_bf16_f32 v254, v236, v237
    v_cvt_pk_bf16_f32 v255, v238, v239
    v_mfma_f32_32x32x16_bf16 v[64:79], a[192:195], a[152:155], v[64:79]
    ds_read_b64_tr_b16 a[192:193], v30 offset:18432
    ds_read_b64_tr_b16 a[194:195], v30 offset:19968
    s_mov_b32 s76, 0x6000
    buffer_store_dwordx4 v[248:251], v57, s[32:35], s76 offen sc1
    v_mfma_f32_32x32x16_bf16 v[64:79], a[196:199], a[156:159], v[64:79]
    ds_read_b64_tr_b16 a[196:197], v30 offset:21504
    ds_read_b64_tr_b16 a[198:199], v30 offset:23040
    v_accvgpr_read_b32 v224, a96
    v_accvgpr_read_b32 v225, a97
    v_accvgpr_read_b32 v226, a98
    v_accvgpr_read_b32 v227, a99
    v_mfma_f32_32x32x16_bf16 v[64:79], a[200:203], a[160:163], v[64:79]
    ds_read_b64_tr_b16 a[200:201], v30 offset:24576
    ds_read_b64_tr_b16 a[202:203], v30 offset:26112
    v_accvgpr_read_b32 v228, a100
    v_accvgpr_read_b32 v229, a101
    v_accvgpr_read_b32 v230, a102
    v_accvgpr_read_b32 v231, a103
    s_waitcnt lgkmcnt(8)
    v_mfma_f32_32x32x16_bf16 v[64:79], a[204:207], a[164:167], v[64:79]
    ds_read_b64_tr_b16 a[204:205], v30 offset:27648
    ds_read_b64_tr_b16 a[206:207], v30 offset:29184
    buffer_store_dwordx4 v[252:255], v57, s[32:35], s76 offen offset:128 sc1
    v_accvgpr_read_b32 v232, a104
    v_mfma_f32_32x32x16_bf16 v[64:79], a[208:211], a[168:171], v[64:79]
    ds_read_b64_tr_b16 a[208:209], v30 offset:30720
    ds_read_b64_tr_b16 a[210:211], v30 offset:32256
    v_accvgpr_read_b32 v233, a105
    v_accvgpr_read_b32 v234, a106
    s_nop 0
L_pad110:
    s_cbranch_execz L_wret
    v_accvgpr_read_b32 v235, a107
    v_accvgpr_read_b32 v236, a108
    v_mfma_f32_32x32x16_bf16 v[64:79], a[212:215], a[172:175], v[64:79]
    ds_read_b64_tr_b16 a[212:213], v30 offset:33792
    ds_read_b64_tr_b16 a[214:215], v30 offset:35328
    v_accvgpr_read_b32 v237, a109
    v_accvgpr_read_b32 v238, a110
    v_accvgpr_read_b32 v239, a111
    v_cvt_pk_bf16_f32 v240, v224, v225
    v_mfma_f32_32x32x16_bf16 v[64:79], a[216:219], a[244:247], v[64:79]
    ds_read_b64_tr_b16 a[216:217], v30 offset:36864
    ds_read_b64_tr_b16 a[218:219], v30 offset:38400
    v_cvt_pk_bf16_f32 v241, v226, v227
    v_cvt_pk_bf16_f32 v242, v228, v229
    v_cvt_pk_bf16_f32 v243, v230, v231
    v_cvt_pk_bf16_f32 v244, v232, v233
    s_waitcnt lgkmcnt(8)
    v_mfma_f32_32x32x16_bf16 v[64:79], a[220:223], a[248:251], v[64:79]
    ds_read_b64_tr_b16 a[220:221], v30 offset:39936
    ds_read_b64_tr_b16 a[222:223], v30 offset:41472
    v_cvt_pk_bf16_f32 v245, v234, v235
    v_cvt_pk_bf16_f32 v246, v236, v237
    v_cvt_pk_bf16_f32 v247, v238, v239
    v_cvt_pk_bf16_f32 v248, v112, v113
    v_mfma_f32_32x32x16_bf16 v[64:79], a[192:195], a[0:3], v[64:79]
    ds_read_b64_tr_b16 a[192:193], v30 offset:43008
    ds_read_b64_tr_b16 a[194:195], v30 offset:44544
    s_mov_b32 s77, 0x8000
    buffer_store_dwordx4 v[240:243], v57, s[32:35], s77 offen sc1
    v_mfma_f32_32x32x16_bf16 v[64:79], a[196:199], a[4:7], v[64:79]
    ds_read_b64_tr_b16 a[196:197], v30 offset:46080
    ds_read_b64_tr_b16 a[198:199], v30 offset:47616
    v_cvt_pk_bf16_f32 v249, v114, v115
    v_cvt_pk_bf16_f32 v250, v116, v117
    v_cvt_pk_bf16_f32 v251, v118, v119
    v_cvt_pk_bf16_f32 v252, v120, v121
    v_mfma_f32_32x32x16_bf16 v[64:79], a[200:203], a[8:11], v[64:79]
    ds_read_b64_tr_b16 a[200:201], v35 offset:0
    ds_read_b64_tr_b16 a[202:203], v35 offset:2304
    v_cvt_pk_bf16_f32 v253, v122, v123
    v_cvt_pk_bf16_f32 v254, v124, v125
    v_cvt_pk_bf16_f32 v255, v126, v127
    s_waitcnt lgkmcnt(8)
    v_mfma_f32_32x32x16_bf16 v[64:79], a[204:207], a[12:15], v[64:79]
    ds_read_b64_tr_b16 a[204:205], v32 offset:24640
    ds_read_b64_tr_b16 a[206:207], v32 offset:26176
    buffer_store_dwordx4 v[244:247], v57, s[32:35], s77 offen offset:128 sc1
    v_mfma_f32_32x32x16_bf16 v[64:79], a[208:211], a[16:19], v[64:79]
    ds_read_b64_tr_b16 a[208:209], v32 offset:27712
    ds_read_b64_tr_b16 a[210:211], v32 offset:29248
    v_mfma_f32_32x32x16_bf16 v[64:79], a[212:215], a[20:23], v[64:79]
    ds_read_b64_tr_b16 a[212:213], v32 offset:30784
    ds_read_b64_tr_b16 a[214:215], v32 offset:32320
    v_mfma_f32_32x32x16_bf16 v[64:79], a[216:219], a[24:27], v[64:79]
    ds_read_b64_tr_b16 a[216:217], v32 offset:33856
    ds_read_b64_tr_b16 a[218:219], v32 offset:35392
    s_mov_b32 s76, 0xa000
    buffer_store_dwordx4 v[248:251], v57, s[32:35], s76 offen sc1
    s_waitcnt lgkmcnt(8)
    v_mfma_f32_32x32x16_bf16 v[64:79], a[220:223], a[28:31], v[64:79]
    ds_read_b64_tr_b16 a[220:221], v32 offset:36928
    ds_read_b64_tr_b16 a[222:223], v32 offset:38464
    v_mfma_f32_32x32x16_bf16 v[64:79], a[192:195], a[112:115], v[64:79]
    ds_read_b64_tr_b16 a[192:193], v32 offset:40000
    ds_read_b64_tr_b16 a[194:195], v32 offset:41536
L_pad111:
    s_cbranch_execz L_wret
    v_mfma_f32_32x32x16_bf16 v[64:79], a[196:199], a[116:119], v[64:79]
    ds_read_b64_tr_b16 a[196:197], v32 offset:43072
    ds_read_b64_tr_b16 a[198:199], v32 offset:44608
    buffer_store_dwordx4 v[252:255], v57, s[32:35], s76 offen offset:128 sc1
    v_mfma_f32_32x32x16_bf16 v[64:79], a[200:203], v[208:211], v[64:79]
    ds_read_b64_tr_b16 a[200:201], v32 offset:46144
    ds_read_b64_tr_b16 a[202:203], v32 offset:47680
    s_waitcnt lgkmcnt(8)
    v_mfma_f32_32x32x16_bf16 v[80:95], a[204:207], v[128:131], v[80:95]
    ds_read_b64_tr_b16 a[204:205], v30 offset:64
    ds_read_b64_tr_b16 a[206:207], v30 offset:1600
    v_mfma_f32_32x32x16_bf16 v[80:95], a[208:211], v[132:135], v[80:95]
    ds_read_b64_tr_b16 a[208:209], v30 offset:3136
    ds_read_b64_tr_b16 a[210:211], v30 offset:4672
    v_mfma_f32_32x32x16_bf16 v[80:95], a[212:215], v[200:203], v[80:95]
    ds_read_b64_tr_b16 a[212:213], v30 offset:6208
    ds_read_b64_tr_b16 a[214:215], v30 offset:7744
    v_cvt_pk_bf16_f32 v240, v64, v65
    v_cvt_pk_bf16_f32 v241, v66, v67
    v_cvt_pk_bf16_f32 v242, v68, v69
    v_cvt_pk_bf16_f32 v243, v70, v71
    v_mfma_f32_32x32x16_bf16 v[80:95], a[216:219], v[204:207], v[80:95]
    v_cvt_pk_bf16_f32 v244, v72, v73
    v_cvt_pk_bf16_f32 v245, v74, v75
    v_cvt_pk_bf16_f32 v246, v76, v77
    v_cvt_pk_bf16_f32 v247, v78, v79
    ds_read_b64_tr_b16 a[216:217], v30 offset:9280
    ds_read_b64_tr_b16 a[218:219], v30 offset:10816
    s_waitcnt lgkmcnt(8)
    v_mfma_f32_32x32x16_bf16 v[80:95], a[220:223], a[144:147], v[80:95]
    s_mov_b32 s76, 0xc000
    buffer_store_dwordx4 v[240:243], v57, s[32:35], s76 offen sc1
    ds_read_b64_tr_b16 a[220:221], v30 offset:12352
    ds_read_b64_tr_b16 a[222:223], v30 offset:13888
    v_mfma_f32_32x32x16_bf16 v[80:95], a[192:195], a[148:151], v[80:95]
    ds_read_b64_tr_b16 a[192:193], v30 offset:15424
    ds_read_b64_tr_b16 a[194:195], v30 offset:16960
    v_mfma_f32_32x32x16_bf16 v[80:95], a[196:199], a[152:155], v[80:95]
    ds_read_b64_tr_b16 a[196:197], v30 offset:18496
    ds_read_b64_tr_b16 a[198:199], v30 offset:20032
    v_mfma_f32_32x32x16_bf16 v[80:95], a[200:203], a[156:159], v[80:95]
    buffer_store_dwordx4 v[244:247], v57, s[32:35], s76 offen offset:128 sc1
    ds_read_b64_tr_b16 a[200:201], v30 offset:21568
    ds_read_b64_tr_b16 a[202:203], v30 offset:23104
    s_waitcnt lgkmcnt(9)
    v_mfma_f32_32x32x16_bf16 v[80:95], a[204:207], a[160:163], v[80:95]
    ds_read_b64_tr_b16 a[204:205], v30 offset:24640
    ds_read_b64_tr_b16 a[206:207], v30 offset:26176
    v_mfma_f32_32x32x16_bf16 v[80:95], a[208:211], a[164:167], v[80:95]
    ds_read_b64_tr_b16 a[208:209], v30 offset:27712
    ds_read_b64_tr_b16 a[210:211], v30 offset:29248
    v_mfma_f32_32x32x16_bf16 v[80:95], a[212:215], a[168:171], v[80:95]
    ds_read_b64_tr_b16 a[212:213], v30 offset:30784
    ds_read_b64_tr_b16 a[214:215], v30 offset:32320
    s_waitcnt lgkmcnt(8)
    v_mfma_f32_32x32x16_bf16 v[80:95], a[216:219], a[172:175], v[80:95]
    ds_read_b64_tr_b16 a[216:217], v30 offset:33856
    ds_read_b64_tr_b16 a[218:219], v30 offset:35392
    v_mfma_f32_32x32x16_bf16 v[80:95], a[220:223], a[244:247], v[80:95]
    ds_read_b64_tr_b16 a[220:221], v30 offset:36928
    ds_read_b64_tr_b16 a[222:223], v30 offset:38464
    v_mfma_f32_32x32x16_bf16 v[80:95], a[192:195], a[248:251], v[80:95]
    ds_read_b64_tr_b16 a[192:193], v30 offset:40000
    ds_read_b64_tr_b16 a[194:195], v30 offset:41536
    v_mfma_f32_32x32x16_bf16 v[80:95], a[196:199], a[0:3], v[80:95]
    s_nop 0
L_pad112:
    s_cbranch_execz L_wret
    ds_read_b64_tr_b16 a[196:197], v30 offset:43072
    ds_read_b64_tr_b16 a[198:199], v30 offset:44608
    s_waitcnt lgkmcnt(8)
    v_mfma_f32_32x32x16_bf16 v[80:95], a[200:203], a[4:7], v[80:95]
    ds_read_b64_tr_b16 a[200:201], v30 offset:46144
    ds_read_b64_tr_b16 a[202:203], v30 offset:47680
    v_mfma_f32_32x32x16_bf16 v[80:95], a[204:207], a[8:11], v[80:95]
    ds_read_b64_tr_b16 a[204:205], v35 offset:64
    ds_read_b64_tr_b16 a[206:207], v35 offset:2368
    v_mfma_f32_32x32x16_bf16 v[80:95], a[208:211], a[12:15], v[80:95]
    ds_read_b64_tr_b16 a[208:209], v32 offset:24704
    ds_read_b64_tr_b16 a[210:211], v32 offset:26240
    v_mfma_f32_32x32x16_bf16 v[80:95], a[212:215], a[16:19], v[80:95]
    ds_read_b64_tr_b16 a[212:213], v32 offset:27776
    ds_read_b64_tr_b16 a[214:215], v32 offset:29312
    s_waitcnt lgkmcnt(8)
    v_mfma_f32_32x32x16_bf16 v[80:95], a[216:219], a[20:23], v[80:95]
    ds_read_b64_tr_b16 a[216:217], v32 offset:30848
    ds_read_b64_tr_b16 a[218:219], v32 offset:32384
    v_mfma_f32_32x32x16_bf16 v[80:95], a[220:223], a[24:27], v[80:95]
    ds_read_b64_tr_b16 a[220:221], v32 offset:33920
    ds_read_b64_tr_b16 a[222:223], v32 offset:35456
    v_mfma_f32_32x32x16_bf16 v[80:95], a[192:195], a[28:31], v[80:95]
    ds_read_b64_tr_b16 a[192:193], v32 offset:36992
    ds_read_b64_tr_b16 a[194:195], v32 offset:38528
    v_mfma_f32_32x32x16_bf16 v[80:95], a[196:199], a[112:115], v[80:95]
    ds_read_b64_tr_b16 a[196:197], v32 offset:40064
    ds_read_b64_tr_b16 a[198:199], v32 offset:41600
    s_waitcnt lgkmcnt(8)
    v_mfma_f32_32x32x16_bf16 v[80:95], a[200:203], a[116:119], v[80:95]
    ds_read_b64_tr_b16 a[200:201], v32 offset:43136
    ds_read_b64_tr_b16 a[202:203], v32 offset:44672
    v_mfma_f32_32x32x16_bf16 v[80:95], a[204:207], v[208:211], v[80:95]
    ds_read_b64_tr_b16 a[204:205], v32 offset:46208
    ds_read_b64_tr_b16 a[206:207], v32 offset:47744
    v_mfma_f32_32x32x16_bf16 v[96:111], a[208:211], v[128:131], v[96:111]
    buffer_load_dword v58, v59, s[28:31], 0 offen sc1
    ds_read_b64_tr_b16 a[208:209], v30 offset:128
    ds_read_b64_tr_b16 a[210:211], v30 offset:1664
    v_mfma_f32_32x32x16_bf16 v[96:111], a[212:215], v[132:135], v[96:111]
    ds_read_b64_tr_b16 a[212:213], v30 offset:3200
    ds_read_b64_tr_b16 a[214:215], v30 offset:4736
    s_waitcnt lgkmcnt(8)
    v_mfma_f32_32x32x16_bf16 v[96:111], a[216:219], v[200:203], v[96:111]
    ds_read_b64_tr_b16 a[216:217], v30 offset:6272
    v_cvt_pk_bf16_f32 v248, v80, v81
    v_cvt_pk_bf16_f32 v249, v82, v83
    v_cvt_pk_bf16_f32 v250, v84, v85
    v_cvt_pk_bf16_f32 v251, v86, v87
    v_cvt_pk_bf16_f32 v252, v88, v89
    v_mfma_f32_32x32x16_bf16 v[96:111], a[220:223], v[204:207], v[96:111]
    v_cvt_pk_bf16_f32 v253, v90, v91
    v_cvt_pk_bf16_f32 v254, v92, v93
    v_cvt_pk_bf16_f32 v255, v94, v95
    ds_read_b64_tr_b16 a[218:219], v30 offset:7808
    ds_read_b64_tr_b16 a[220:221], v30 offset:9344
    ds_read_b64_tr_b16 a[222:223], v30 offset:10880
    v_mfma_f32_32x32x16_bf16 v[96:111], a[192:195], a[144:147], v[96:111]
    s_mov_b32 s77, 0xe000
    buffer_store_dwordx4 v[248:251], v57, s[32:35], s77 offen sc1
    ds_read_b64_tr_b16 a[192:193], v30 offset:12416
    ds_read_b64_tr_b16 a[194:195], v30 offset:13952
    v_mfma_f32_32x32x16_bf16 v[96:111], a[196:199], a[148:151], v[96:111]
    ds_read_b64_tr_b16 a[196:197], v30 offset:15488
    ds_read_b64_tr_b16 a[198:199], v30 offset:17024
    s_waitcnt lgkmcnt(8)
L_pad113:
    s_cbranch_execz L_wret
    v_mfma_f32_32x32x16_bf16 v[96:111], a[200:203], a[152:155], v[96:111]
    ds_read_b64_tr_b16 a[200:201], v30 offset:18560
    ds_read_b64_tr_b16 a[202:203], v30 offset:20096
    buffer_store_dwordx4 v[252:255], v57, s[32:35], s77 offen offset:128 sc1
    v_mfma_f32_32x32x16_bf16 v[96:111], a[204:207], a[156:159], v[96:111]
    ds_read_b64_tr_b16 a[204:205], v30 offset:21632
    ds_read_b64_tr_b16 a[206:207], v30 offset:23168
    v_mfma_f32_32x32x16_bf16 v[96:111], a[208:211], a[160:163], v[96:111]
    ds_read_b64_tr_b16 a[208:209], v30 offset:24704
    ds_read_b64_tr_b16 a[210:211], v30 offset:26240
    v_mfma_f32_32x32x16_bf16 v[96:111], a[212:215], a[164:167], v[96:111]
    ds_read_b64_tr_b16 a[212:213], v30 offset:27776
    ds_read_b64_tr_b16 a[214:215], v30 offset:29312
    s_waitcnt lgkmcnt(8)
    v_mfma_f32_32x32x16_bf16 v[96:111], a[216:219], a[168:171], v[96:111]
    ds_read_b64_tr_b16 a[216:217], v30 offset:30848
    ds_read_b64_tr_b16 a[218:219], v30 offset:32384
    v_mfma_f32_32x32x16_bf16 v[96:111], a[220:223], a[172:175], v[96:111]
    ds_read_b64_tr_b16 a[220:221], v30 offset:33920
    ds_read_b64_tr_b16 a[222:223], v30 offset:35456
    v_mfma_f32_32x32x16_bf16 v[96:111], a[192:195], a[244:247], v[96:111]
    ds_read_b64_tr_b16 a[192:193], v30 offset:36992
    ds_read_b64_tr_b16 a[194:195], v30 offset:38528
    v_mfma_f32_32x32x16_bf16 v[96:111], a[196:199], a[248:251], v[96:111]
    ds_read_b64_tr_b16 a[196:197], v30 offset:40064
    ds_read_b64_tr_b16 a[198:199], v30 offset:41600
    s_waitcnt lgkmcnt(8)
    v_mfma_f32_32x32x16_bf16 v[96:111], a[200:203], a[0:3], v[96:111]
    ds_read_b64_tr_b16 a[200:201], v30 offset:43136
    ds_read_b64_tr_b16 a[202:203], v30 offset:44672
    v_mfma_f32_32x32x16_bf16 v[96:111], a[204:207], a[4:7], v[96:111]
    ds_read_b64_tr_b16 a[204:205], v30 offset:46208
    ds_read_b64_tr_b16 a[206:207], v30 offset:47744
    v_mfma_f32_32x32x16_bf16 v[96:111], a[208:211], a[8:11], v[96:111]
    ds_read_b64_tr_b16 a[208:209], v35 offset:128
    ds_read_b64_tr_b16 a[210:211], v35 offset:2432
    v_mfma_f32_32x32x16_bf16 v[96:111], a[212:215], a[12:15], v[96:111]
    s_waitcnt lgkmcnt(6)
    v_mfma_f32_32x32x16_bf16 v[96:111], a[216:219], a[16:19], v[96:111]
    v_mfma_f32_32x32x16_bf16 v[96:111], a[220:223], a[20:23], v[96:111]
    v_mfma_f32_32x32x16_bf16 v[96:111], a[192:195], a[24:27], v[96:111]
    v_mfma_f32_32x32x16_bf16 v[96:111], a[196:199], a[28:31], v[96:111]
    s_waitcnt lgkmcnt(0)
    v_mfma_f32_32x32x16_bf16 v[96:111], a[200:203], a[112:115], v[96:111]
    v_mfma_f32_32x32x16_bf16 v[96:111], a[204:207], a[116:119], v[96:111]
    v_mfma_f32_32x32x16_bf16 v[96:111], a[208:211], v[208:211], v[96:111]
    s_nop 11
    v_cvt_pk_bf16_f32 v240, v96, v97
    v_cvt_pk_bf16_f32 v241, v98, v99
    v_cvt_pk_bf16_f32 v242, v100, v101
    v_cvt_pk_bf16_f32 v243, v102, v103
    v_cvt_pk_bf16_f32 v244, v104, v105
    v_cvt_pk_bf16_f32 v245, v106, v107
    v_cvt_pk_bf16_f32 v246, v108, v109
    v_cvt_pk_bf16_f32 v247, v110, v111
    s_mov_b32 s76, 0x10000
    buffer_store_dwordx4 v[240:243], v57, s[32:35], s76 offen sc1
    buffer_store_dwordx4 v[244:247], v57, s[32:35], s76 offen offset:128 sc1
    v_mov_b32 v16, 12
    s_waitcnt vmcnt(0)
    buffer_store_dword v16, v61, s[28:31], 0 offen sc1
    s_nop 0
    s_mov_b32 s96, 0x4000
    s_nop 7
L_tail:
    v_max_u32 v58, v58, v17
    s_mov_b32 s67, 0
    s_add_u32 s78, s65, 3
    v_cmp_lt_u32 vcc, s78, v58
    s_lshl_b32 s66, s78, 13
    s_sub_u32 s66, s66, 24576
    s_cmp_eq_u64 vcc, -1
L_pad114:
    s_cbranch_execz L_wret
    s_cbranch_scc0 L_tail_issued
    buffer_load_dwordx4 a[0:3], v62, s[32:35], s66 offen sc1
    s_add_u32 s66, s66, 1277952
    buffer_load_dwordx4 a[4:7], v62, s[32:35], s66 offen sc1
    s_mov_b32 s67, 1
    s_add_u32 s78, s65, 4
    v_cmp_lt_u32 vcc, s78, v58
    s_lshl_b32 s66, s78, 13
    s_sub_u32 s66, s66, 24576
    s_cmp_eq_u64 vcc, -1
    s_cbranch_scc0 L_tail_issued
    buffer_load_dwordx4 a[8:11], v62, s[32:35], s66 offen sc1
    s_add_u32 s66, s66, 1277952
    buffer_load_dwordx4 a[12:15], v62, s[32:35], s66 offen sc1
    s_mov_b32 s67, 2
    s_add_u32 s78, s65, 5
    v_cmp_lt_u32 vcc, s78, v58
    s_lshl_b32 s66, s78, 13
    s_sub_u32 s66, s66, 24576
    s_cmp_eq_u64 vcc, -1
    s_cbranch_scc0 L_tail_issued
    buffer_load_dwordx4 a[16:19], v62, s[32:35], s66 offen sc1
    s_add_u32 s66, s66, 1277952
    buffer_load_dwordx4 a[20:23], v62, s[32:35], s66 offen sc1
    s_mov_b32 s67, 3
    s_add_u32 s78, s65, 6
    v_cmp_lt_u32 vcc, s78, v58
    s_lshl_b32 s66, s78, 13
    s_sub_u32 s66, s66, 24576
    s_cmp_eq_u64 vcc, -1
    s_cbranch_scc0 L_tail_issued
    buffer_load_dwordx4 a[24:27], v62, s[32:35], s66 offen sc1
    s_add_u32 s66, s66, 1277952
    buffer_load_dwordx4 a[28:31], v62, s[32:35], s66 offen sc1
    s_mov_b32 s67, 4
    s_add_u32 s78, s65, 7
    v_cmp_lt_u32 vcc, s78, v58
    s_lshl_b32 s66, s78, 13
    s_sub_u32 s66, s66, 24576
    s_cmp_eq_u64 vcc, -1
    s_cbranch_scc0 L_tail_issued
    buffer_load_dwordx4 a[32:35], v62, s[32:35], s66 offen sc1
    s_add_u32 s66, s66, 1277952
    buffer_load_dwordx4 a[36:39], v62, s[32:35], s66 offen sc1
    s_mov_b32 s67, 5
    s_add_u32 s78, s65, 8
    v_cmp_lt_u32 vcc, s78, v58
    s_lshl_b32 s66, s78, 13
    s_sub_u32 s66, s66, 24576
    s_cmp_eq_u64 vcc, -1
    s_cbranch_scc0 L_tail_issued
    buffer_load_dwordx4 a[40:43], v62, s[32:35], s66 offen sc1
    s_add_u32 s66, s66, 1277952
    buffer_load_dwordx4 a[44:47], v62, s[32:35], s66 offen sc1
    s_mov_b32 s67, 6
    s_add_u32 s78, s65, 9
    v_cmp_lt_u32 vcc, s78, v58
    s_lshl_b32 s66, s78, 13
    s_sub_u32 s66, s66, 24576
    s_cmp_eq_u64 vcc, -1
    s_cbranch_scc0 L_tail_issued
    buffer_load_dwordx4 a[48:51], v62, s[32:35], s66 offen sc1
    s_add_u32 s66, s66, 1277952
    buffer_load_dwordx4 a[52:55], v62, s[32:35], s66 offen sc1
    s_mov_b32 s67, 7
    s_add_u32 s78, s65, 10
    v_cmp_lt_u32 vcc, s78, v58
    s_lshl_b32 s66, s78, 13
    s_sub_u32 s66, s66, 24576
    s_cmp_eq_u64 vcc, -1
    s_cbranch_scc0 L_tail_issued
    buffer_load_dwordx4 a[56:59], v62, s[32:35], s66 offen sc1
    s_add_u32 s66, s66, 1277952
    buffer_load_dwordx4 a[60:63], v62, s[32:35], s66 offen sc1
    s_mov_b32 s67, 8
    s_add_u32 s78, s65, 11
    v_cmp_lt_u32 vcc, s78, v58
    s_lshl_b32 s66, s78, 13
    s_sub_u32 s66, s66, 24576
    s_cmp_eq_u64 vcc, -1
    s_cbranch_scc0 L_tail_issued
    buffer_load_dwordx4 a[64:67], v62, s[32:35], s66 offen sc1
    s_add_u32 s66, s66, 1277952
    buffer_load_dwordx4 a[68:71], v62, s[32:35], s66 offen sc1
    s_mov_b32 s67, 9
L_tail_issued:
    buffer_load_dword v58, v59, s[28:31], 0 offen sc1
    s_waitcnt vmcnt(1)
    s_cmp_le_u32 s67, 0
    s_cbranch_scc1 L_tail_done
    v_mfma_f32_16x16x32_bf16 v[64:67], a[252:255], a[0:3], 0
L_pad115:
    s_cbranch_execz L_wret
    v_mfma_f32_16x16x32_bf16 v[64:67], a[252:255], a[4:7], v[64:67]
    s_nop 7
    v_mul_f32 v64, v64, v46
    v_mul_f32 v65, v65, v46
    v_mul_f32 v66, v66, v46
    v_mul_f32 v67, v67, v46
    v_cvt_pk_bf16_f32 v64, v64, v65
    v_cvt_pk_bf16_f32 v65, v66, v67
    buffer_store_dwordx2 v[64:65], v63, s[44:47], s97 offen
    s_add_u32 s97, s97, 64
    s_cmp_ge_u32 s97, 576
    s_cselect_b32 s97, 0, s97
    s_cmp_le_u32 s67, 1
    s_cbranch_scc1 L_tail_done
    v_mfma_f32_16x16x32_bf16 v[68:71], a[252:255], a[8:11], 0
    v_mfma_f32_16x16x32_bf16 v[68:71], a[252:255], a[12:15], v[68:71]
    s_nop 7
    v_mul_f32 v68, v68, v46
    v_mul_f32 v69, v69, v46
    v_mul_f32 v70, v70, v46
    v_mul_f32 v71, v71, v46
    v_cvt_pk_bf16_f32 v68, v68, v69
    v_cvt_pk_bf16_f32 v69, v70, v71
    buffer_store_dwordx2 v[68:69], v63, s[44:47], s97 offen
    s_add_u32 s97, s97, 64
    s_cmp_ge_u32 s97, 576
    s_cselect_b32 s97, 0, s97
    s_cmp_le_u32 s67, 2
    s_cbranch_scc1 L_tail_done
    v_mfma_f32_16x16x32_bf16 v[72:75], a[252:255], a[16:19], 0
    v_mfma_f32_16x16x32_bf16 v[72:75], a[252:255], a[20:23], v[72:75]
    s_nop 7
    v_mul_f32 v72, v72, v46
    v_mul_f32 v73, v73, v46
    v_mul_f32 v74, v74, v46
    v_mul_f32 v75, v75, v46
    v_cvt_pk_bf16_f32 v72, v72, v73
    v_cvt_pk_bf16_f32 v73, v74, v75
    buffer_store_dwordx2 v[72:73], v63, s[44:47], s97 offen
    s_add_u32 s97, s97, 64
    s_cmp_ge_u32 s97, 576
    s_cselect_b32 s97, 0, s97
    s_cmp_le_u32 s67, 3
    s_cbranch_scc1 L_tail_done
    v_mfma_f32_16x16x32_bf16 v[76:79], a[252:255], a[24:27], 0
    v_mfma_f32_16x16x32_bf16 v[76:79], a[252:255], a[28:31], v[76:79]
    s_nop 7
    v_mul_f32 v76, v76, v46
    v_mul_f32 v77, v77, v46
    v_mul_f32 v78, v78, v46
    v_mul_f32 v79, v79, v46
    v_cvt_pk_bf16_f32 v76, v76, v77
    v_cvt_pk_bf16_f32 v77, v78, v79
    buffer_store_dwordx2 v[76:77], v63, s[44:47], s97 offen
    s_add_u32 s97, s97, 64
    s_cmp_ge_u32 s97, 576
    s_cselect_b32 s97, 0, s97
    s_cmp_le_u32 s67, 4
    s_cbranch_scc1 L_tail_done
    v_mfma_f32_16x16x32_bf16 v[80:83], a[252:255], a[32:35], 0
    v_mfma_f32_16x16x32_bf16 v[80:83], a[252:255], a[36:39], v[80:83]
    s_nop 7
    v_mul_f32 v80, v80, v46
    v_mul_f32 v81, v81, v46
    v_mul_f32 v82, v82, v46
    v_mul_f32 v83, v83, v46
    v_cvt_pk_bf16_f32 v80, v80, v81
    v_cvt_pk_bf16_f32 v81, v82, v83
    buffer_store_dwordx2 v[80:81], v63, s[44:47], s97 offen
    s_add_u32 s97, s97, 64
    s_cmp_ge_u32 s97, 576
    s_cselect_b32 s97, 0, s97
    s_cmp_le_u32 s67, 5
    s_cbranch_scc1 L_tail_done
    v_mfma_f32_16x16x32_bf16 v[84:87], a[252:255], a[40:43], 0
    v_mfma_f32_16x16x32_bf16 v[84:87], a[252:255], a[44:47], v[84:87]
    s_nop 7
    v_mul_f32 v84, v84, v46
    v_mul_f32 v85, v85, v46
    v_mul_f32 v86, v86, v46
    v_mul_f32 v87, v87, v46
    v_cvt_pk_bf16_f32 v84, v84, v85
    v_cvt_pk_bf16_f32 v85, v86, v87
    buffer_store_dwordx2 v[84:85], v63, s[44:47], s97 offen
    s_add_u32 s97, s97, 64
    s_cmp_ge_u32 s97, 576
    s_cselect_b32 s97, 0, s97
    s_cmp_le_u32 s67, 6
    s_cbranch_scc1 L_tail_done
    v_mfma_f32_16x16x32_bf16 v[88:91], a[252:255], a[48:51], 0
    s_nop 0
L_pad116:
    s_cbranch_execz L_wret
    v_mfma_f32_16x16x32_bf16 v[88:91], a[252:255], a[52:55], v[88:91]
    s_nop 7
    v_mul_f32 v88, v88, v46
    v_mul_f32 v89, v89, v46
    v_mul_f32 v90, v90, v46
    v_mul_f32 v91, v91, v46
    v_cvt_pk_bf16_f32 v88, v88, v89
    v_cvt_pk_bf16_f32 v89, v90, v91
    buffer_store_dwordx2 v[88:89], v63, s[44:47], s97 offen
    s_add_u32 s97, s97, 64
    s_cmp_ge_u32 s97, 576
    s_cselect_b32 s97, 0, s97
    s_cmp_le_u32 s67, 7
    s_cbranch_scc1 L_tail_done
    v_mfma_f32_16x16x32_bf16 v[92:95], a[252:255], a[56:59], 0
    v_mfma_f32_16x16x32_bf16 v[92:95], a[252:255], a[60:63], v[92:95]
    s_nop 7
    v_mul_f32 v92, v92, v46
    v_mul_f32 v93, v93, v46
    v_mul_f32 v94, v94, v46
    v_mul_f32 v95, v95, v46
    v_cvt_pk_bf16_f32 v92, v92, v93
    v_cvt_pk_bf16_f32 v93, v94, v95
    buffer_store_dwordx2 v[92:93], v63, s[44:47], s97 offen
    s_add_u32 s97, s97, 64
    s_cmp_ge_u32 s97, 576
    s_cselect_b32 s97, 0, s97
    s_cmp_le_u32 s67, 8
    s_cbranch_scc1 L_tail_done
    v_mfma_f32_16x16x32_bf16 v[96:99], a[252:255], a[64:67], 0
    v_mfma_f32_16x16x32_bf16 v[96:99], a[252:255], a[68:71], v[96:99]
    s_nop 7
    v_mul_f32 v96, v96, v46
    v_mul_f32 v97, v97, v46
    v_mul_f32 v98, v98, v46
    v_mul_f32 v99, v99, v46
    v_cvt_pk_bf16_f32 v96, v96, v97
    v_cvt_pk_bf16_f32 v97, v98, v99
    buffer_store_dwordx2 v[96:97], v63, s[44:47], s97 offen
    s_add_u32 s97, s97, 64
    s_cmp_ge_u32 s97, 576
    s_cselect_b32 s97, 0, s97
L_tail_done:
    s_add_u32 s65, s65, s67
    s_cmp_ge_u32 s65, 9
    s_cbranch_scc1 L_tail_exit
    s_waitcnt vmcnt(0)
    s_sub_u32 s96, s96, 1
    s_cbranch_scc0 L_tail
L_tail_exit:
L_end:
    s_endpgm
L_slow0:
    s_mov_b32 s96, 0x8000
L_spin0:
    buffer_load_dword v58, v59, s[40:43], 0 offen sc1
    s_waitcnt vmcnt(0)
    v_cmp_le_u32 vcc, 16, v58
    s_nop 1
    s_cmp_eq_u64 vcc, -1
    s_cbranch_scc1 L_back0
    s_sub_u32 s96, s96, 1
    s_cbranch_scc0 L_spin0
    s_branch L_back0
L_slow1:
    s_mov_b32 s96, 0x8000
L_spin1:
    buffer_load_dword v27, v26, s[28:31], 0 offen sc1
    s_waitcnt vmcnt(0)
    v_cmp_le_u32 vcc, 1, v27
    s_nop 1
    s_cmp_eq_u64 vcc, -1
    s_cbranch_scc1 L_back1
    s_sub_u32 s96, s96, 1
    s_cbranch_scc0 L_spin1
    s_branch L_back1
L_slow2:
    s_mov_b32 s96, 0x8000
L_spin2:
    buffer_load_dword v27, v26, s[28:31], 0 offen sc1
    s_waitcnt vmcnt(0)
    v_cmp_le_u32 vcc, 2, v27
    s_nop 1
    s_cmp_eq_u64 vcc, -1
    s_cbranch_scc1 L_back2
    s_sub_u32 s96, s96, 1
    s_cbranch_scc0 L_spin2
    s_branch L_back2
L_slow3:
    s_mov_b32 s96, 0x8000
L_spin3:
    buffer_load_dword v27, v26, s[28:31], 0 offen sc1
    s_waitcnt vmcnt(0)
    v_cmp_le_u32 vcc, 3, v27
    s_nop 1
    s_cmp_eq_u64 vcc, -1
    s_cbranch_scc1 L_back3
    s_sub_u32 s96, s96, 1
    s_cbranch_scc0 L_spin3
    s_branch L_back3
.section .rodata,"a"
.p2align 6
.amdhsa_kernel gated_mix__sliding_block__dense_activation_silu__prompt_kernel
  .amdhsa_next_free_vgpr 512
  .amdhsa_next_free_sgpr 102
  .amdhsa_accum_offset 256
  .amdhsa_group_segment_fixed_size 0
  .amdhsa_kernarg_size 80
  .amdhsa_user_sgpr_count 2
  .amdhsa_user_sgpr_kernarg_segment_ptr 1
  .amdhsa_system_sgpr_workgroup_id_x 1
.end_amdhsa_kernel
```
